```python
import torch

def _softmax(x, axis=-1):
    return torch.softmax(x, dim=axis)
def _gelu(x):
    return torch.nn.functional.gelu(x, approximate="tanh")
def _silu(x):
    return torch.nn.functional.silu(x)
def _sigmoid(x):
    return torch.sigmoid(x)
def _layernorm(x, axis=-1, eps=1e-5):
    m = x.mean(dim=axis, keepdim=True)
    v = x.var(dim=axis, keepdim=True, unbiased=False)
    return (x - m) / torch.sqrt(v + eps)
def _scatter_add(tgt, idx, src, axis=0):
    return tgt.clone().index_add_(axis, idx, src)
def _segment_sum(src, seg, n):
    out = torch.zeros((n,) + src.shape[1:], dtype=src.dtype)
    return out.index_add_(0, seg, src)
def _pad(x, pw):
    flat = tuple(v for pair in reversed(pw) for v in pair)
    return torch.nn.functional.pad(x, flat)

kernel_name = 'gated_mix__grouped_kv_mqa__dense_activation_gelu__prompt'

def setup_inputs():

    _w = (lambda a: (lambda t: t.to(torch.bfloat16) if t.is_floating_point() else t)(torch.as_tensor(a)))
    def _A_setup():
        B, S, D, H = 1, 2048, 576, 32
        Dh = D // H
        return {
            "x": _w((lambda *s: torch.randn(*s, dtype=torch.bfloat16) * 0.05)(B, S, D)),
            "wq": _w((lambda *s: torch.randn(*s, dtype=torch.bfloat16) * 0.8)(D, H * Dh)),
            "wk": _w((lambda *s: torch.randn(*s, dtype=torch.bfloat16) * 0.8)(D, Dh)),
            "wv": _w((lambda *s: torch.randn(*s, dtype=torch.bfloat16) * 0.05)(D, Dh)),
            "wo": _w((lambda *s: torch.randn(*s, dtype=torch.bfloat16) * 0.05)(H * Dh, D)),
        }
    _A_in = _A_setup()

    def _B_setup():
        B, S, D, F = 1, 2048, 576, 4608
        return {
            "x": _w((lambda *s: torch.randn(*s, dtype=torch.bfloat16) * 0.05)(B, S, D)),
            "w1": _w((lambda *s: torch.randn(*s, dtype=torch.bfloat16) * 3.2)(D, F) * (D ** -0.5)),
            "b1": _w((lambda *s: torch.randn(*s, dtype=torch.bfloat16) * 3.2)(F) * 0.01),
            "w2": _w((lambda *s: torch.randn(*s, dtype=torch.bfloat16) * 0.05)(F, D) * (F ** -0.5)),
            "b2": _w((lambda *s: torch.randn(*s, dtype=torch.bfloat16) * 0.1)(D) * 0.01),
        }
    _B_in = _B_setup()

    return {
        "A_x": _A_in["x"],
        "A_wq": _A_in["wq"],
        "A_wk": _A_in["wk"],
        "A_wv": _A_in["wv"],
        "A_wo": _A_in["wo"],
        "B_x": _B_in["x"],
        "B_w1": _B_in["w1"],
        "B_b1": _B_in["b1"],
        "B_w2": _B_in["w2"],
        "B_b2": _B_in["b2"],
        "gate_w": _w((lambda *s: torch.randn(*s, dtype=torch.bfloat16) * 0.05)(576) * 16.0),
    }

def reference(A_x, A_wq, A_wk, A_wv, A_wo, B_x, B_w1, B_b1, B_w2, B_b2, gate_w):
    def _A_ref(x, wq, wk, wv, wo):
        B, S, D = x.shape
        H = 32
        Dh = D // H
        q = (lambda x, *d: x.permute(*d))((x @ wq).reshape(B, S, H, Dh), 0, 2, 1, 3)
        k = x @ wk
        v = x @ wv
        scores = torch.einsum("bhqd,bkd->bhqk", q, k) * (Dh ** -0.5)
        p = _softmax(scores, axis=-1)
        o = torch.einsum("bhqk,bkd->bhqd", p, v)
        return (lambda x, *d: x.permute(*d))(o, 0, 2, 1, 3).reshape(B, S, H * Dh) @ wo

    def _B_ref(x, w1, b1, w2, b2):
        h = torch.einsum("bsd,df->bsf", x, w1) + b1
        h = _gelu(h)
        return torch.einsum("bsf,fd->bsd", h, w2) + b2

    x = A_x
    g = _sigmoid((x * gate_w).sum(-1, keepdims=True))
    a = _A_ref(x, A_wq, A_wk, A_wv, A_wo)
    b = _B_ref(x, B_w1, B_b1, B_w2, B_b2)
    return g * a + (1 - g) * b
```

```asm
; @launch grid=(256,1,1) block=(512,1,1) lds=163840
.amdgcn_target "amdgcn-amd-amdhsa--gfx950"
.text
.globl gated_mix__grouped_kv_mqa__dense_activation_gelu__prompt_kernel
.p2align 8
.type gated_mix__grouped_kv_mqa__dense_activation_gelu__prompt_kernel,@function
gated_mix__grouped_kv_mqa__dense_activation_gelu__prompt_kernel:
    s_cmp_ge_u32 s2, 256
    s_cbranch_scc1 L_end
    s_load_dwordx16 s[4:19], s[0:1], 0
    s_load_dwordx8 s[20:27], s[0:1], 64
    s_load_dwordx4 s[28:31], s[0:1], 96
    s_getpc_b64 s[92:93]
L_pc:
    s_bfe_u32 s88, s2, 0x40003
    v_lshrrev_b32 v84, 4, v0
    v_and_b32 v85, 3, v0
    v_or_b32 v85, v84, v85
    v_lshl_add_u32 v85, v85, 4, s88
    v_lshlrev_b32 v80, 7, v85
    s_mov_b32 m0, 157184
    s_mov_b64 exec, 0xf
    global_load_lds_dword v80, s[92:93]
    s_mov_b64 exec, -1
    v_lshrrev_b32 v84, 6, v0
    v_and_b32 v22, 63, v0
    v_readfirstlane_b32 s72, v84
    v_lshrrev_b32 v77, 3, v22
    v_and_b32 v78, 7, v22
    v_lshrrev_b32 v79, 4, v22
    v_and_b32 v83, 1, v84
    v_lshlrev_b32 v83, 2, v83
    s_and_b32 s88, s2, 3
    s_lshl_b32 s76, s88, 2
    s_lshr_b32 s88, s2, 3
    s_and_b32 s89, s88, 3
    s_add_u32 s76, s76, s89
    s_lshr_b32 s75, s88, 2
    s_mov_b32 s94, 0x72725050
    s_mov_b32 s95, 0x83836161
    s_lshl_b32 s89, s76, 2
    s_lshr_b64 s[94:95], s[94:95], s89
    s_and_b32 s81, s94, 15
    s_and_b32 s89, s75, 6
    s_bitcmp1_b32 s2, 2
    s_addc_u32 s81, s81, s89
    s_sub_u32 s89, s81, 9
    s_min_u32 s81, s81, s89
    s_bfe_u32 s88, s2, 0x10002
    s_mul_i32 s88, s88, 8
    s_add_u32 s75, s75, s88
    s_lshl_b32 s87, s72, 10
    s_lshl4_add_u32 s88, s75, s72
    s_mul_i32 s77, s88, 9216
    s_and_b32 s89, s76, 1
    s_mov_b32 s94, 0x3a18b2d0
    s_mov_b32 s95, 0xf45c9e76
    s_lshl_b32 s88, s76, 2
    s_lshr_b64 s[94:95], s[94:95], s88
    s_and_b32 s95, s94, 15
    s_mul_i32 s88, s95, 576
    s_lshl_b32 s3, s89, 6
    s_add_u32 s86, s88, s3
    s_mul_i32 s79, s72, 73728
    s_add_u32 s79, s79, s86
    v_add_u32 v84, v83, v79
    v_xor_b32 v84, v84, v78
    v_mul_u32_u24 v85, 1152, v77
    v_lshl_add_u32 v76, v84, 4, v85
    v_and_b32 v84, 1, v79
    v_lshl_add_u32 v84, v84, 1, v83
    v_xor_b32 v86, v84, v78
    v_mul_u32_u24 v7, 9216, v77
    v_lshl_add_u32 v7, v86, 4, v7
    s_mov_b32 s34, 2359296
    s_mov_b32 s35, 0x20000
    s_mov_b32 s38, 5308416
    s_mov_b32 s39, 0x20000
    s_mov_b32 s84, s81
    s_waitcnt lgkmcnt(0)
    s_mov_b64 s[32:33], s[4:5]
    s_mov_b64 s[36:37], s[16:17]
    s_add_u32 m0, s87, 90112
    s_lshl_b32 s91, s81, 7
    s_add_u32 s91, s91, s77
    buffer_load_dwordx4 v76, s[32:35], s91 offen  lds
    s_add_u32 m0, s87, 98304
    s_add_u32 s91, s91, 73728
    buffer_load_dwordx4 v76, s[32:35], s91 offen  lds
    s_add_u32 m0, s87, 0
    s_mul_i32 s0, s81, 589824
    s_add_u32 s0, s0, s79
    buffer_load_dwordx4 v7, s[36:39], s0 offen  lds
    s_add_u32 s81, s81, 1
    s_cmp_eq_u32 s81, 9
    s_cselect_b32 s81, 0, s81
    v_lshl_add_u32 v87, v0, 1, s3
    s_mul_i32 s3, s89, 576
    v_subrev_u32 v84, s3, v87
    v_cmp_gt_u32 vcc, 0x100, v0
    s_mov_b64 s[60:61], s[18:19]
    s_mov_b32 s62, 9216
    s_mov_b32 s63, 0x20000
    v_cndmask_b32 v90, v84, v87, vcc
    s_lshl_b32 s3, s84, 7
    v_lshlrev_b32 v88, 2, v0
    v_add_u32 v87, s3, v88
    v_subrev_u32 v84, 1152, v87
    v_min_u32 v87, v84, v87
    s_mov_b64 s[68:69], s[24:25]
    s_mov_b32 s70, 1152
    s_mov_b32 s71, 0x20000
    s_cmp_lt_u32 s72, 5
    s_cbranch_scc0 L_skip_1
    buffer_load_ushort v91, v90, s[60:63], s88 offen
    buffer_load_dword v92, v87, s[68:71], 0 offen
L_skip_1:
    s_xor_b32 s85, s89, 1
    s_mul_i32 s85, s85, 8
    s_xor_b32 s85, s85, s76
    s_cmp_lt_u32 s85, 4
    s_cselect_b32 s88, 6, 4
    v_subrev_u32 v89, s88, v86
    v_min_u32 v86, s88, v86
    s_lshl3_add_u32 s88, s84, s72
    s_lshl_b32 s88, s88, 3
    v_add_u32 v80, s88, v77
    s_mov_b32 s64, 0x3a18b290
    s_mov_b32 s65, 0x7e5cf6d4
    s_lshl_b32 s88, s76, 2
    s_lshr_b64 s[64:65], s[64:65], s88
    s_and_b32 s94, s64, 15
    s_mul_i32 s88, s94, 72
    s_and_b32 s88, s88, 0xfffffff0
    v_mul_u32_u24 v84, 1152, v80
    v_lshl_add_u32 v84, v86, 4, v84
    v_add_u32 v84, s88, v84
    s_lshl_b32 s88, s89, 4
    v_mov_b32 v81, s88
    v_cmp_eq_u32 vcc, 5, v86
    s_nop 1
    v_cndmask_b32 v81, 20, v81, vcc
    v_mad_u32_u24 v81, v80, 36, v81
    s_bitcmp1_b32 s76, 1
    s_cselect_b32 s8, s10, s8
    s_cselect_b32 s9, s11, s9
    v_cmp_gt_u32 vcc, 5, v86
    s_nop 1
    v_cndmask_b32 v18, v81, v84, vcc
    v_mov_b32 v19, 0
    v_mov_b32 v84, s6
    v_mov_b32 v81, s8
    v_cndmask_b32 v16, v81, v84, vcc
    v_mov_b32 v84, s7
    v_mov_b32 v81, s9
    v_cndmask_b32 v17, v81, v84, vcc
    v_lshl_add_u64 v[16:17], v[18:19], 0, v[16:17]
    v_mov_b32 v84, 73728
    v_mov_b32 v81, 2304
    v_cndmask_b32 v18, v81, v84, vcc
    s_mov_b64 s[40:41], s[20:21]
    s_mov_b64 s[44:45], s[30:31]
    s_mov_b32 s46, 0x4000000
    s_mov_b32 s47, 0x20000
    s_mov_b64 s[48:49], s[28:29]
    s_mov_b64 s[52:53], s[26:27]
    s_mov_b64 s[56:57], s[12:13]
    s_mov_b64 s[64:65], s[22:23]
    s_xor_b32 s88, s85, 2
    s_or_b32 s88, s88, s75
    s_or_b32 s88, s88, s72
    v_mov_b32 v103, 0
    s_mov_b32 s3, 0x28000
    s_cmp_eq_u32 s88, 0
    s_cbranch_scc0 L_skip_2
    buffer_load_dword v103, v19, s[44:47], s3 offen sc1
L_skip_2:
    s_and_b32 s73, s72, 3
    s_lshr_b32 s74, s72, 2
    s_lshl_b32 s78, s73, 10
    v_and_b32 v80, 15, v22
    v_bfe_u32 v81, v22, 2, 2
    v_and_b32 v82, 3, v22
    v_lshlrev_b32 v0, 4, v22
    v_mov_b32 v1, 0xc0135761
    s_add_u32 s88, s78, 106496
    v_add_u32 v21, s88, v0
    v_lshlrev_b32 v6, 4, v79
    v_add_u32 v6, 155648, v6
    v_lshlrev_b32 v84, 1, v79
    v_xor_b32 v84, v84, v78
    v_lshl_add_u32 v20, v84, 4, v85
    v_lshlrev_b32 v101, 4, v84
    v_lshrrev_b32 v84, 5, v22
    v_lshlrev_b32 v84, 1, v84
    v_xor_b32 v84, v84, v82
    v_lshrrev_b32 v23, 2, v22
    v_mul_u32_u24 v23, 9216, v23
    v_lshl_add_u32 v23, v84, 4, v23
    v_lshrrev_b32 v84, 1, v80
    v_xor_b32 v84, v84, v79
    v_lshlrev_b32 v84, 4, v84
    v_lshl_add_u32 v84, v80, 7, v84
    s_lshl1_add_u32 s88, s73, s74
    s_lshl_b32 s88, s88, 11
    s_add_u32 s88, s88, 90112
    v_add_u32 v72, s88, v84
    v_xor_b32 v73, 64, v72
    v_xor_b32 v74, 0x800, v72
    v_xor_b32 v75, 0x840, v72
    v_lshrrev_b32 v84, 1, v81
    v_and_b32 v77, 1, v79
    v_lshl_add_u32 v77, v77, 1, v84
    v_lshlrev_b32 v77, 5, v77
    v_lshl_add_u32 v78, v79, 3, v81
    v_lshlrev_b32 v83, 3, v82
    s_lshl_b32 s88, s74, 6
    v_add_u32 v84, s88, v83
    v_xor_b32 v84, v84, v77
    v_lshl_add_u32 v2, v78, 7, v84
    v_xor_b32 v3, 32, v2
    v_add_u32 v4, 0x10000, v2
    v_add_u32 v5, 0x10000, v3
    v_and_b32 v84, 1, v79
    v_xor_b32 v84, s74, v84
    v_lshl_add_u32 v84, v84, 5, v83
    v_lshl_add_u32 v8, v78, 6, v84
    s_lshl2_add_u32 s3, s74, s89
    s_lshl_b32 s3, s3, 3
    v_add_u32 v84, s3, v83
    v_xor_b32 v9, v84, v77
    v_lshl_add_u32 v9, v78, 7, v9
    s_lshl_b32 s88, s89, 3
    v_add_u32 v84, 72, v83
    s_add_u32 s3, s88, 64
    v_mov_b32 v85, s3
    v_cmp_eq_u32 vcc, 0, v82
    s_nop 1
    v_cndmask_b32 v84, v84, v85, vcc
    s_sub_u32 s3, 104, s88
    v_mov_b32 v85, s3
    v_cmp_eq_u32 vcc, 3, v82
    s_nop 1
    v_cndmask_b32 v84, v84, v85, vcc
    s_add_u32 s3, s88, 64
    s_cmp_lt_u32 s85, 4
    s_cselect_b32 s3, 127, s3
    v_min_u32 v84, s3, v84
    v_xor_b32 v84, v84, v77
    v_lshl_add_u32 v10, v78, 7, v84
    s_and_b32 s3, s75, 15
    s_lshl4_add_u32 s88, s95, s3
    s_mul_i32 s88, s88, 20736
    s_mul_i32 s3, s72, 2688
    s_add_u32 s88, s88, s3
    v_min_u32 v100, 20, v22
    v_lshl_add_u32 v100, v100, 7, s88
    s_mul_i32 s88, s75, 9216
    s_lshl1_add_u32 s90, s73, s74
    s_mul_i32 s3, s90, 576
    s_add_u32 s3, s3, s88
    s_add_u32 s3, s3, 4096
    v_bfrev_b32 v77, 1
    v_mul_u32_u24 v84, 288, v79
    v_lshl_add_u32 v84, v80, 4, v84
    v_add_u32 v84, s3, v84
    s_lshl_b32 s3, s89, 7
    v_add_u32 v11, s3, v84
    v_add_u32 v84, 96, v84
    v_cmp_gt_u32 vcc, 8, v80
    v_lshrrev_b32 v85, 1, v80
    v_or_b32 v85, s3, v85
    v_cndmask_b32 v11, v77, v11, vcc
    v_cmp_eq_u32 vcc, 5, v85
    v_mov_b32 v19, v77
    s_nop 0
    v_cndmask_b32 v11, v11, v84, vcc
    s_and_b32 s3, s85, 12
    v_or_b32 v85, s3, v79
    v_cmp_gt_u32 vcc, 2, v85
    s_nop 1
    v_cndmask_b32 v11, v77, v11, vcc
    s_cmp_lt_u32 s85, 2
    s_cbranch_scc0 L_skip_3
    s_lshl1_add_u32 s3, s73, s85
    s_lshl1_add_u32 s3, s3, s74
    s_lshl_b32 s3, s3, 8
    s_add_u32 s3, s3, s88
    v_cmp_eq_u32 vcc, 0, v79
    v_lshl_add_u32 v84, v80, 4, s3
    s_lshl_b32 s90, s90, 6
    s_add_u32 s90, s90, s88
    v_cndmask_b32 v11, v77, v84, vcc
    s_add_u32 s90, s90, 8704
    v_lshl_add_u32 v84, v80, 2, s90
    s_lshl2_add_u32 s3, s85, 3
    v_cmp_eq_u32 vcc, s3, v79
    s_nop 1
    v_cndmask_b32 v19, v77, v84, vcc
L_skip_3:
    s_lshl_b32 s88, s72, 10
    s_add_u32 m0, s88, 106496
    s_lshl_b32 s91, s81, 7
    s_add_u32 s91, s91, s77
    buffer_load_dwordx4 v76, s[32:35], s91 offen  lds
    s_add_u32 m0, s88, 114688
    s_add_u32 s91, s91, 73728
    buffer_load_dwordx4 v76, s[32:35], s91 offen  lds
    s_add_u32 m0, s88, 8192
    s_mul_i32 s1, s81, 589824
    s_add_u32 s1, s1, s79
    buffer_load_dwordx4 v7, s[36:39], s1 offen  lds
    s_add_u32 s81, s81, 1
    s_cmp_eq_u32 s81, 9
    s_cselect_b32 s81, 0, s81
    s_add_u32 m0, s88, 122880
    s_lshl_b32 s91, s81, 7
    s_add_u32 s91, s91, s77
    buffer_load_dwordx4 v76, s[32:35], s91 offen  lds
    s_add_u32 m0, s88, 131072
    s_add_u32 s91, s91, 73728
    buffer_load_dwordx4 v76, s[32:35], s91 offen  lds
    s_add_u32 m0, s88, 16384
    s_mul_i32 s92, s81, 589824
    s_add_u32 s92, s92, s79
    buffer_load_dwordx4 v7, s[36:39], s92 offen  lds
    s_add_u32 s81, s81, 1
    s_cmp_eq_u32 s81, 9
    s_cselect_b32 s81, 0, s81
    s_mov_b64 exec, 0
    s_cmp_eq_u32 s72, 0
    s_cbranch_scc1 L_page0
    s_cmp_eq_u32 s72, 1
    s_cbranch_scc1 L_page1
    s_cmp_eq_u32 s72, 2
    s_cbranch_scc1 L_page2
    s_cmp_eq_u32 s72, 3
    s_cbranch_scc1 L_page3
L_probed:
    s_mov_b64 exec, -1
    s_waitcnt vmcnt(6)
    v_lshlrev_b32 v91, 16, v91
    v_add_u32 v88, 155648, v88
    ds_write_b32 v88, v91
    s_waitcnt vmcnt(6)
    ds_write_b32 v88, v92 offset:2048
    s_waitcnt vmcnt(6)
    v_readfirstlane_b32 s93, v103
    s_nop 0
    s_mul_i32 s93, s93, 0x9e3779b1
    s_add_u32 s93, s93, 0x7f4a7c15
    s_cmp_eq_u32 s74, 0
    s_cbranch_scc1 L_half0
    s_branch L_half1
.p2align 12
L_half1:
L_page0:
    s_cbranch_execz L_page4
    s_waitcnt lgkmcnt(0)
    s_barrier
    s_lshr_b32 s88, s76, 2
    s_cmp_eq_u32 s88, s73
    s_cbranch_scc0 L_skip_9
    ds_read_b128 v[84:87], v6 offset:2048
    ds_read_b128 v[88:91], v6 offset:2112
L_skip_9:
    ds_read_b128 v[112:115], v72
    ds_read_b128 v[184:187], v74
    ds_read_b128 v[116:119], v73
    ds_read_b128 v[188:191], v75
    ds_read_b128 v[40:43], v6 offset:128
    ds_read_b128 v[48:51], v6 offset:192
    ds_read_b64_tr_b16 v[104:105], v2
    ds_read_b64_tr_b16 v[106:107], v2 offset:512
    ds_read_b64_tr_b16 v[108:109], v2 offset:4096
    ds_read_b64_tr_b16 v[110:111], v2 offset:4608
    ds_read_b64_tr_b16 v[24:25], v3
    ds_read_b64_tr_b16 v[26:27], v3 offset:512
    ds_read_b64_tr_b16 v[28:29], v3 offset:4096
    ds_read_b64_tr_b16 v[30:31], v3 offset:4608
    s_add_u32 m0, s78, 143360
    s_lshl_b32 s91, s81, 7
    s_add_u32 s91, s91, s77
    buffer_load_dwordx4 v76, s[32:35], s91 offen  lds
    s_add_u32 m0, s78, 151552
    s_add_u32 s91, s91, 73728
    buffer_load_dwordx4 v76, s[32:35], s91 offen  lds
    s_add_u32 m0, s78, 28672
    s_mul_i32 s60, s81, 589824
    s_add_u32 s60, s60, s79
    buffer_load_dwordx4 v7, s[36:39], s60 offen  lds
    s_add_u32 s81, s81, 1
    s_cmp_eq_u32 s81, 9
    s_cselect_b32 s81, 0, s81
    s_and_b32 s89, s76, 1
    s_mov_b32 s42, 5308416
    s_mov_b32 s43, 0x20000
    s_mov_b32 s50, 256
    s_mov_b32 s51, 0x20000
    s_mov_b32 s54, 2359296
    s_mov_b32 s55, 0x20000
    s_mov_b32 s58, 663552
    s_mov_b32 s59, 0x20000
    s_mov_b32 s66, 1152
    s_mov_b32 s67, 0x20000
    s_mul_i32 s88, s95, 576
    s_xor_b32 s3, s89, 1
    s_lshl_b32 s3, s3, 9
    s_add_u32 s88, s88, s3
    s_mul_i32 s80, s73, 147456
    s_add_u32 s80, s80, s88
    s_sub_u32 s80, s80, s79
    s_lshl4_add_u32 s88, s73, s88
    s_mul_i32 s83, s88, 576
    s_lshl4_add_u32 s88, s73, s86
    s_mul_i32 s82, s88, 576
    s_lshl2_add_u32 s88, s75, s73
    s_mul_i32 s86, s88, 589824
    s_lshl_b32 s3, s74, 15
    s_add_u32 s86, s86, s3
    s_lshl_b32 s3, s76, 10
    s_add_u32 s86, s86, s3
    s_add_u32 s86, s86, 0x400000
    s_lshl1_add_u32 s84, s88, s74
    s_lshl4_add_u32 s84, s84, s76
    s_lshl_b32 s84, s84, 5
    s_add_u32 s84, s84, 0x340000
    s_mul_i32 s87, s88, 36
    s_lshl1_add_u32 s87, s94, s87
    s_add_u32 s87, s87, s74
    s_lshl_b32 s87, s87, 10
    s_add_u32 s87, s87, 0x100000
    s_mov_b64 exec, 0
    s_cmp_eq_u32 s73, 0
    s_cbranch_scc1 L_h1page0
    s_cmp_eq_u32 s73, 1
    s_cbranch_scc1 L_h1page1
    s_cmp_eq_u32 s73, 2
    s_cbranch_scc1 L_h1page2
    s_cmp_eq_u32 s73, 3
    s_cbranch_scc1 L_h1page3
L_probed1:
    s_mov_b64 exec, -1
    s_waitcnt vmcnt(6) lgkmcnt(10)
    s_barrier
    s_lshr_b32 s88, s76, 2
    s_cmp_eq_u32 s88, s73
    s_cbranch_scc0 L_skip_10
    v_mfma_f32_16x16x32_bf16 v[80:83], v[84:87], v[112:115], 0
    v_mfma_f32_16x16x32_bf16 v[80:83], v[88:91], v[116:119], v[80:83]
    ds_read_b128 v[84:87], v6 offset:2176
    ds_read_b128 v[88:91], v6 offset:2240
L_skip_10:
    ds_read_b128 v[120:123], v72 offset:16384
    ds_read_b128 v[192:195], v74 offset:16384
    ds_read_b128 v[124:127], v73 offset:16384
    ds_read_b128 v[196:199], v75 offset:16384
    ds_read_b64_tr_b16 v[32:33], v2 offset:8192
    s_waitcnt lgkmcnt(9)
    v_mfma_f32_16x16x32_bf16 v[44:47], v[104:107], v[184:187], v[40:43]
    ds_read_b64_tr_b16 v[34:35], v2 offset:8704
    s_add_u32 m0, s78, 94208
    s_lshl_b32 s91, s81, 7
    s_add_u32 s91, s91, s77
    buffer_load_dwordx4 v76, s[32:35], s91 offen  lds
    v_mfma_f32_16x16x32_bf16 v[44:47], v[108:111], v[188:191], v[44:47]
    ds_read_b64_tr_b16 v[36:37], v2 offset:12288
    s_add_u32 m0, s78, 102400
    s_add_u32 s91, s91, 73728
    buffer_load_dwordx4 v76, s[32:35], s91 offen  lds
    v_mfma_f32_16x16x32_bf16 v[40:43], v[104:107], v[112:115], v[40:43]
    ds_read_b64_tr_b16 v[38:39], v2 offset:12800
    s_add_u32 m0, s78, 36864
    s_mul_i32 s61, s81, 589824
    s_add_u32 s61, s61, s79
    buffer_load_dwordx4 v7, s[36:39], s61 offen  lds
    s_add_u32 s81, s81, 1
    s_cmp_eq_u32 s81, 9
    s_cselect_b32 s81, 0, s81
    v_mfma_f32_16x16x32_bf16 v[40:43], v[108:111], v[116:119], v[40:43]
    ds_read_b64_tr_b16 v[104:105], v3 offset:8192
    s_waitcnt lgkmcnt(9)
    v_mfma_f32_16x16x32_bf16 v[52:55], v[24:27], v[184:187], v[48:51]
    ds_read_b64_tr_b16 v[106:107], v3 offset:8704
    s_setprio 1
    v_mfma_f32_16x16x32_bf16 v[52:55], v[28:31], v[188:191], v[52:55]
    s_waitcnt vmcnt(6) lgkmcnt(6)
    s_barrier
    ds_read_b64_tr_b16 v[108:109], v3 offset:12288
    v_mfma_f32_16x16x32_bf16 v[48:51], v[24:27], v[112:115], v[48:51]
    ds_read_b64_tr_b16 v[110:111], v3 offset:12800
    v_mfma_f32_16x16x32_bf16 v[48:51], v[28:31], v[116:119], v[48:51]
    ds_read_b128 v[128:131], v72 offset:32768
    ds_read_b128 v[200:203], v74 offset:32768
    ds_read_b128 v[132:135], v73 offset:32768
    ds_read_b128 v[204:207], v75 offset:32768
    s_lshr_b32 s88, s76, 2
    s_cmp_eq_u32 s88, s73
    s_cbranch_scc0 L_skip_11
    v_mfma_f32_16x16x32_bf16 v[80:83], v[84:87], v[120:123], v[80:83]
    v_mfma_f32_16x16x32_bf16 v[80:83], v[88:91], v[124:127], v[80:83]
    ds_read_b128 v[84:87], v6 offset:2304
    ds_read_b128 v[88:91], v6 offset:2368
L_skip_11:
    s_add_u32 m0, s78, 110592
    s_lshl_b32 s91, s81, 7
    s_add_u32 s91, s91, s77
    buffer_load_dwordx4 v76, s[32:35], s91 offen  lds
    s_add_u32 m0, s78, 118784
    s_add_u32 s91, s91, 73728
    buffer_load_dwordx4 v76, s[32:35], s91 offen  lds
    s_add_u32 m0, s78, 45056
    s_mul_i32 s62, s81, 589824
    s_add_u32 s62, s62, s79
    buffer_load_dwordx4 v7, s[36:39], s62 offen  lds
    s_add_u32 s81, s81, 1
    s_cmp_eq_u32 s81, 9
    s_cselect_b32 s81, 0, s81
    s_setprio 0
    ds_read_b64_tr_b16 v[24:25], v2 offset:16384
    s_waitcnt lgkmcnt(9)
    v_mfma_f32_16x16x32_bf16 v[40:43], v[32:35], v[120:123], v[40:43]
    ds_read_b64_tr_b16 v[26:27], v2 offset:16896
    v_mfma_f32_16x16x32_bf16 v[40:43], v[36:39], v[124:127], v[40:43]
    ds_read_b64_tr_b16 v[28:29], v2 offset:20480
    v_mfma_f32_16x16x32_bf16 v[44:47], v[32:35], v[192:195], v[44:47]
    ds_read_b64_tr_b16 v[30:31], v2 offset:20992
    v_mfma_f32_16x16x32_bf16 v[44:47], v[36:39], v[196:199], v[44:47]
    ds_read_b64_tr_b16 v[32:33], v3 offset:16384
    s_waitcnt lgkmcnt(9)
    v_mfma_f32_16x16x32_bf16 v[48:51], v[104:107], v[120:123], v[48:51]
    ds_read_b64_tr_b16 v[34:35], v3 offset:16896
    s_setprio 1
    v_mfma_f32_16x16x32_bf16 v[48:51], v[108:111], v[124:127], v[48:51]
    s_waitcnt vmcnt(6) lgkmcnt(6)
    s_barrier
    ds_read_b64_tr_b16 v[36:37], v3 offset:20480
    v_mfma_f32_16x16x32_bf16 v[52:55], v[104:107], v[192:195], v[52:55]
    ds_read_b64_tr_b16 v[38:39], v3 offset:20992
    v_mfma_f32_16x16x32_bf16 v[52:55], v[108:111], v[196:199], v[52:55]
    ds_read_b128 v[136:139], v72 offset:49152
    ds_read_b128 v[208:211], v74 offset:49152
    ds_read_b128 v[140:143], v73 offset:49152
    ds_read_b128 v[212:215], v75 offset:49152
    s_lshr_b32 s88, s76, 2
    s_cmp_eq_u32 s88, s73
    s_cbranch_scc0 L_skip_12
    s_waitcnt lgkmcnt(12)
    v_mfma_f32_16x16x32_bf16 v[80:83], v[84:87], v[128:131], v[80:83]
    s_waitcnt lgkmcnt(12)
    v_mfma_f32_16x16x32_bf16 v[80:83], v[88:91], v[132:135], v[80:83]
    ds_read_b128 v[84:87], v6 offset:2432
    ds_read_b128 v[88:91], v6 offset:2496
L_skip_12:
    s_add_u32 m0, s78, 126976
    s_lshl_b32 s91, s81, 7
    s_add_u32 s91, s91, s77
    buffer_load_dwordx4 v76, s[32:35], s91 offen  lds
    s_add_u32 m0, s78, 135168
    s_add_u32 s91, s91, 73728
    buffer_load_dwordx4 v76, s[32:35], s91 offen  lds
    s_add_u32 m0, s78, 53248
    s_mul_i32 s63, s81, 589824
    s_add_u32 s63, s63, s79
    buffer_load_dwordx4 v7, s[36:39], s63 offen  lds
    s_add_u32 s81, s81, 1
    s_cmp_eq_u32 s81, 9
    s_cselect_b32 s81, 0, s81
    s_setprio 0
    ds_read_b64_tr_b16 v[104:105], v2 offset:24576
    s_waitcnt lgkmcnt(9)
    v_mfma_f32_16x16x32_bf16 v[40:43], v[24:27], v[128:131], v[40:43]
    ds_read_b64_tr_b16 v[106:107], v2 offset:25088
    v_mfma_f32_16x16x32_bf16 v[40:43], v[28:31], v[132:135], v[40:43]
    ds_read_b64_tr_b16 v[108:109], v2 offset:28672
    v_mfma_f32_16x16x32_bf16 v[44:47], v[24:27], v[200:203], v[44:47]
    ds_read_b64_tr_b16 v[110:111], v2 offset:29184
    v_mfma_f32_16x16x32_bf16 v[44:47], v[28:31], v[204:207], v[44:47]
    ds_read_b64_tr_b16 v[24:25], v3 offset:24576
    s_waitcnt lgkmcnt(9)
    v_mfma_f32_16x16x32_bf16 v[48:51], v[32:35], v[128:131], v[48:51]
    ds_read_b64_tr_b16 v[26:27], v3 offset:25088
    s_setprio 1
    v_mfma_f32_16x16x32_bf16 v[48:51], v[36:39], v[132:135], v[48:51]
    s_waitcnt vmcnt(6) lgkmcnt(6)
    s_barrier
    ds_read_b64_tr_b16 v[28:29], v3 offset:28672
    v_mfma_f32_16x16x32_bf16 v[52:55], v[32:35], v[200:203], v[52:55]
    ds_read_b64_tr_b16 v[30:31], v3 offset:29184
    v_mfma_f32_16x16x32_bf16 v[52:55], v[36:39], v[204:207], v[52:55]
    ds_read_b128 v[144:147], v72
    ds_read_b128 v[216:219], v74
    ds_read_b128 v[148:151], v73
    ds_read_b128 v[220:223], v75
    s_lshr_b32 s88, s76, 2
    s_cmp_eq_u32 s88, s73
    s_cbranch_scc0 L_skip_13
    s_waitcnt lgkmcnt(12)
    v_mfma_f32_16x16x32_bf16 v[80:83], v[84:87], v[136:139], v[80:83]
    s_waitcnt lgkmcnt(12)
    v_mfma_f32_16x16x32_bf16 v[80:83], v[88:91], v[140:143], v[80:83]
    ds_read_b128 v[84:87], v6 offset:2560
    ds_read_b128 v[88:91], v6 offset:2624
L_skip_13:
    s_add_u32 m0, s78, 143360
    s_lshl_b32 s91, s81, 7
    s_add_u32 s91, s91, s77
    buffer_load_dwordx4 v76, s[32:35], s91 offen  lds
    s_add_u32 m0, s78, 151552
    s_add_u32 s91, s91, 73728
    buffer_load_dwordx4 v76, s[32:35], s91 offen  lds
    s_add_u32 m0, s78, 61440
    s_mul_i32 s70, s81, 589824
    s_add_u32 s70, s70, s79
    buffer_load_dwordx4 v7, s[36:39], s70 offen  lds
    s_add_u32 s81, s81, 1
    s_cmp_eq_u32 s81, 9
    s_cselect_b32 s81, 0, s81
    s_setprio 0
    ds_read_b64_tr_b16 v[32:33], v2 offset:32768
    s_waitcnt lgkmcnt(9)
    v_mfma_f32_16x16x32_bf16 v[40:43], v[104:107], v[136:139], v[40:43]
    ds_read_b64_tr_b16 v[34:35], v2 offset:33280
    v_mfma_f32_16x16x32_bf16 v[40:43], v[108:111], v[140:143], v[40:43]
    ds_read_b64_tr_b16 v[36:37], v2 offset:36864
    v_mfma_f32_16x16x32_bf16 v[44:47], v[104:107], v[208:211], v[44:47]
    ds_read_b64_tr_b16 v[38:39], v2 offset:37376
    v_mfma_f32_16x16x32_bf16 v[44:47], v[108:111], v[212:215], v[44:47]
    ds_read_b64_tr_b16 v[104:105], v3 offset:32768
    s_waitcnt lgkmcnt(9)
    v_mfma_f32_16x16x32_bf16 v[48:51], v[24:27], v[136:139], v[48:51]
    ds_read_b64_tr_b16 v[106:107], v3 offset:33280
    s_setprio 1
    v_mfma_f32_16x16x32_bf16 v[48:51], v[28:31], v[140:143], v[48:51]
    s_waitcnt vmcnt(6) lgkmcnt(6)
    s_barrier
    ds_read_b64_tr_b16 v[108:109], v3 offset:36864
    v_mfma_f32_16x16x32_bf16 v[52:55], v[24:27], v[208:211], v[52:55]
    ds_read_b64_tr_b16 v[110:111], v3 offset:37376
    v_mfma_f32_16x16x32_bf16 v[52:55], v[28:31], v[212:215], v[52:55]
    ds_read_b128 v[152:155], v72 offset:16384
    ds_read_b128 v[224:227], v74 offset:16384
    ds_read_b128 v[156:159], v73 offset:16384
    ds_read_b128 v[228:231], v75 offset:16384
    s_lshr_b32 s88, s76, 2
    s_cmp_eq_u32 s88, s73
    s_cbranch_scc0 L_skip_14
    s_waitcnt lgkmcnt(12)
    v_mfma_f32_16x16x32_bf16 v[80:83], v[84:87], v[144:147], v[80:83]
    s_waitcnt lgkmcnt(12)
    v_mfma_f32_16x16x32_bf16 v[80:83], v[88:91], v[148:151], v[80:83]
    ds_read_b128 v[84:87], v6 offset:2688
    ds_read_b128 v[88:91], v6 offset:2752
L_skip_14:
    s_add_u32 m0, s78, 94208
    s_lshl_b32 s91, s81, 7
    s_add_u32 s91, s91, s77
    buffer_load_dwordx4 v76, s[32:35], s91 offen  lds
    s_add_u32 m0, s78, 102400
    s_add_u32 s91, s91, 73728
    buffer_load_dwordx4 v76, s[32:35], s91 offen  lds
    s_add_u32 m0, s78, 69632
    s_mul_i32 s71, s81, 589824
    s_add_u32 s71, s71, s79
    buffer_load_dwordx4 v7, s[36:39], s71 offen  lds
    s_add_u32 s81, s81, 1
    s_cmp_eq_u32 s81, 9
    s_cselect_b32 s81, 0, s81
    s_setprio 0
    ds_read_b64_tr_b16 v[24:25], v2 offset:40960
    s_waitcnt lgkmcnt(9)
    v_mfma_f32_16x16x32_bf16 v[40:43], v[32:35], v[144:147], v[40:43]
    ds_read_b64_tr_b16 v[26:27], v2 offset:41472
    v_mfma_f32_16x16x32_bf16 v[40:43], v[36:39], v[148:151], v[40:43]
    ds_read_b64_tr_b16 v[28:29], v2 offset:45056
    v_mfma_f32_16x16x32_bf16 v[44:47], v[32:35], v[216:219], v[44:47]
    ds_read_b64_tr_b16 v[30:31], v2 offset:45568
    v_mfma_f32_16x16x32_bf16 v[44:47], v[36:39], v[220:223], v[44:47]
    ds_read_b64_tr_b16 v[32:33], v3 offset:40960
    s_waitcnt lgkmcnt(9)
    v_mfma_f32_16x16x32_bf16 v[48:51], v[104:107], v[144:147], v[48:51]
    ds_read_b64_tr_b16 v[34:35], v3 offset:41472
    s_setprio 1
    v_mfma_f32_16x16x32_bf16 v[48:51], v[108:111], v[148:151], v[48:51]
    s_waitcnt vmcnt(6) lgkmcnt(6)
    s_barrier
    ds_read_b64_tr_b16 v[36:37], v3 offset:45056
    v_mfma_f32_16x16x32_bf16 v[52:55], v[104:107], v[216:219], v[52:55]
    ds_read_b64_tr_b16 v[38:39], v3 offset:45568
    v_mfma_f32_16x16x32_bf16 v[52:55], v[108:111], v[220:223], v[52:55]
    ds_read_b128 v[160:163], v72 offset:32768
    ds_read_b128 v[232:235], v74 offset:32768
    ds_read_b128 v[164:167], v73 offset:32768
    ds_read_b128 v[236:239], v75 offset:32768
    s_lshr_b32 s88, s76, 2
    s_cmp_eq_u32 s88, s73
    s_cbranch_scc0 L_skip_15
    s_waitcnt lgkmcnt(12)
    v_mfma_f32_16x16x32_bf16 v[80:83], v[84:87], v[152:155], v[80:83]
    s_waitcnt lgkmcnt(12)
    v_mfma_f32_16x16x32_bf16 v[80:83], v[88:91], v[156:159], v[80:83]
    ds_read_b128 v[84:87], v6 offset:2816
    ds_read_b128 v[88:91], v6 offset:2880
L_skip_15:
    s_add_u32 m0, s78, 77824
    s_add_u32 s90, s0, 128
    buffer_load_dwordx4 v7, s[36:39], s90 offen  lds
    s_add_u32 m0, s78, 86016
    s_add_u32 s90, s1, 128
    buffer_load_dwordx4 v7, s[36:39], s90 offen  lds
    s_setprio 0
    ds_read_b64_tr_b16 v[104:105], v2 offset:49152
    s_waitcnt lgkmcnt(9)
    v_mfma_f32_16x16x32_bf16 v[40:43], v[24:27], v[152:155], v[40:43]
    ds_read_b64_tr_b16 v[106:107], v2 offset:49664
    v_mfma_f32_16x16x32_bf16 v[40:43], v[28:31], v[156:159], v[40:43]
    ds_read_b64_tr_b16 v[108:109], v2 offset:53248
    v_mfma_f32_16x16x32_bf16 v[44:47], v[24:27], v[224:227], v[44:47]
    ds_read_b64_tr_b16 v[110:111], v2 offset:53760
    v_mfma_f32_16x16x32_bf16 v[44:47], v[28:31], v[228:231], v[44:47]
    ds_read_b64_tr_b16 v[24:25], v3 offset:49152
    s_waitcnt lgkmcnt(9)
    v_mfma_f32_16x16x32_bf16 v[48:51], v[32:35], v[152:155], v[48:51]
    ds_read_b64_tr_b16 v[26:27], v3 offset:49664
    s_setprio 1
    v_mfma_f32_16x16x32_bf16 v[48:51], v[36:39], v[156:159], v[48:51]
    s_waitcnt vmcnt(5) lgkmcnt(6)
    s_barrier
    ds_read_b64_tr_b16 v[28:29], v3 offset:53248
    v_mfma_f32_16x16x32_bf16 v[52:55], v[32:35], v[224:227], v[52:55]
    ds_read_b64_tr_b16 v[30:31], v3 offset:53760
    v_mfma_f32_16x16x32_bf16 v[52:55], v[36:39], v[228:231], v[52:55]
    ds_read_b128 v[168:171], v72 offset:49152
    ds_read_b128 v[240:243], v74 offset:49152
    ds_read_b128 v[172:175], v73 offset:49152
    ds_read_b128 v[244:247], v75 offset:49152
    s_lshr_b32 s88, s76, 2
    s_cmp_eq_u32 s88, s73
    s_cbranch_scc0 L_skip_16
    s_waitcnt lgkmcnt(12)
    v_mfma_f32_16x16x32_bf16 v[80:83], v[84:87], v[160:163], v[80:83]
    s_waitcnt lgkmcnt(12)
    v_mfma_f32_16x16x32_bf16 v[80:83], v[88:91], v[164:167], v[80:83]
    ds_read_b128 v[84:87], v6 offset:2944
    ds_read_b128 v[88:91], v6 offset:3008
L_skip_16:
    s_add_u32 m0, s78, 110592
    s_add_u32 s90, s92, 128
    buffer_load_dwordx4 v7, s[36:39], s90 offen  lds
    s_add_u32 m0, s78, 118784
    s_add_u32 s90, s60, 128
    buffer_load_dwordx4 v7, s[36:39], s90 offen  lds
    s_add_u32 m0, s78, 4096
    s_add_u32 s90, s61, 128
    buffer_load_dwordx4 v7, s[36:39], s90 offen  lds
    ds_read_b128 v[56:59], v6 offset:384
    s_setprio 0
    ds_read_b64_tr_b16 v[32:33], v2 offset:57344
    s_waitcnt lgkmcnt(10)
    v_mfma_f32_16x16x32_bf16 v[40:43], v[104:107], v[160:163], v[40:43]
    ds_read_b64_tr_b16 v[34:35], v2 offset:57856
    v_mfma_f32_16x16x32_bf16 v[40:43], v[108:111], v[164:167], v[40:43]
    ds_read_b64_tr_b16 v[36:37], v2 offset:61440
    v_mfma_f32_16x16x32_bf16 v[44:47], v[104:107], v[232:235], v[44:47]
    ds_read_b64_tr_b16 v[38:39], v2 offset:61952
    v_mfma_f32_16x16x32_bf16 v[44:47], v[108:111], v[236:239], v[44:47]
    ds_read_b64_tr_b16 v[104:105], v3 offset:57344
    s_waitcnt lgkmcnt(10)
    v_mfma_f32_16x16x32_bf16 v[48:51], v[24:27], v[160:163], v[48:51]
    ds_read_b64_tr_b16 v[106:107], v3 offset:57856
    s_setprio 1
    v_mfma_f32_16x16x32_bf16 v[48:51], v[28:31], v[164:167], v[48:51]
    s_waitcnt vmcnt(5) lgkmcnt(7)
    s_barrier
    ds_read_b64_tr_b16 v[108:109], v3 offset:61440
    v_mfma_f32_16x16x32_bf16 v[52:55], v[24:27], v[232:235], v[52:55]
    ds_read_b64_tr_b16 v[110:111], v3 offset:61952
    v_mfma_f32_16x16x32_bf16 v[52:55], v[28:31], v[236:239], v[52:55]
    ds_read_b128 v[176:179], v72
    ds_read_b128 v[248:251], v74
    ds_read_b128 v[180:183], v73
    ds_read_b128 v[252:255], v75
    s_lshr_b32 s88, s76, 2
    s_cmp_eq_u32 s88, s73
    s_cbranch_scc0 L_skip_17
    s_waitcnt lgkmcnt(13)
    v_mfma_f32_16x16x32_bf16 v[80:83], v[84:87], v[168:171], v[80:83]
    s_waitcnt lgkmcnt(13)
    v_mfma_f32_16x16x32_bf16 v[80:83], v[88:91], v[172:175], v[80:83]
    ds_read_b128 v[84:87], v6 offset:3072
    ds_read_b128 v[88:91], v6 offset:3136
L_skip_17:
    s_add_u32 m0, s78, 12288
    s_add_u32 s90, s62, 128
    buffer_load_dwordx4 v7, s[36:39], s90 offen  lds
    s_add_u32 m0, s78, 20480
    s_add_u32 s90, s63, 128
    buffer_load_dwordx4 v7, s[36:39], s90 offen  lds
    ds_read_b128 v[64:67], v6 offset:448
    s_setprio 0
    ds_read_b64_tr_b16 v[24:25], v4
    s_waitcnt lgkmcnt(10)
    v_mfma_f32_16x16x32_bf16 v[40:43], v[32:35], v[168:171], v[40:43]
    ds_read_b64_tr_b16 v[26:27], v4 offset:512
    v_mfma_f32_16x16x32_bf16 v[40:43], v[36:39], v[172:175], v[40:43]
    ds_read_b64_tr_b16 v[28:29], v4 offset:4096
    v_mfma_f32_16x16x32_bf16 v[44:47], v[32:35], v[240:243], v[44:47]
    ds_read_b64_tr_b16 v[30:31], v4 offset:4608
    v_mfma_f32_16x16x32_bf16 v[44:47], v[36:39], v[244:247], v[44:47]
    ds_read_b64_tr_b16 v[32:33], v5
    s_waitcnt lgkmcnt(10)
    v_mfma_f32_16x16x32_bf16 v[48:51], v[104:107], v[168:171], v[48:51]
    ds_read_b64_tr_b16 v[34:35], v5 offset:512
    s_setprio 1
    v_mfma_f32_16x16x32_bf16 v[48:51], v[108:111], v[172:175], v[48:51]
    s_waitcnt vmcnt(4) lgkmcnt(7)
    s_barrier
    ds_read_b64_tr_b16 v[36:37], v5 offset:4096
    v_mfma_f32_16x16x32_bf16 v[52:55], v[104:107], v[240:243], v[52:55]
    ds_read_b64_tr_b16 v[38:39], v5 offset:4608
    v_mfma_f32_16x16x32_bf16 v[52:55], v[108:111], v[244:247], v[52:55]
    s_lshr_b32 s88, s76, 2
    s_cmp_eq_u32 s88, s73
    s_cbranch_scc0 L_skip_18
    s_waitcnt lgkmcnt(9)
    v_mfma_f32_16x16x32_bf16 v[80:83], v[84:87], v[176:179], v[80:83]
    s_waitcnt lgkmcnt(9)
    v_mfma_f32_16x16x32_bf16 v[80:83], v[88:91], v[180:183], v[80:83]
L_skip_18:
    s_add_u32 m0, s78, 28672
    s_add_u32 s90, s70, 128
    buffer_load_dwordx4 v7, s[36:39], s90 offen  lds
    s_add_u32 m0, s78, 36864
    s_add_u32 s90, s71, 128
    buffer_load_dwordx4 v7, s[36:39], s90 offen  lds
    s_add_u32 m0, s78, 45056
    s_add_u32 s90, s0, 256
    buffer_load_dwordx4 v7, s[36:39], s90 offen  lds
    s_setprio 0
    ds_read_b64_tr_b16 v[104:105], v4 offset:8192
    s_waitcnt lgkmcnt(5)
    v_mfma_f32_16x16x32_bf16 v[40:43], v[24:27], v[176:179], v[40:43]
    ds_read_b64_tr_b16 v[106:107], v4 offset:8704
    s_add_u32 m0, s78, 53248
    v_mfma_f32_16x16x32_bf16 v[40:43], v[28:31], v[180:183], v[40:43]
    ds_read_b64_tr_b16 v[108:109], v4 offset:12288
    v_mfma_f32_16x16x32_bf16 v[44:47], v[24:27], v[248:251], v[44:47]
    ds_read_b64_tr_b16 v[110:111], v4 offset:12800
    v_mfma_f32_16x16x32_bf16 v[44:47], v[28:31], v[252:255], v[44:47]
    ds_read_b64_tr_b16 v[24:25], v4 offset:16384
    s_waitcnt lgkmcnt(5)
    v_mfma_f32_16x16x32_bf16 v[48:51], v[32:35], v[176:179], v[48:51]
    ds_read_b64_tr_b16 v[26:27], v4 offset:16896
    v_mfma_f32_16x16x32_bf16 v[48:51], v[36:39], v[180:183], v[48:51]
    ds_read_b64_tr_b16 v[28:29], v4 offset:20480
    v_mfma_f32_16x16x32_bf16 v[52:55], v[32:35], v[248:251], v[52:55]
    ds_read_b64_tr_b16 v[30:31], v4 offset:20992
    s_add_u32 s90, s1, 256
    v_mfma_f32_16x16x32_bf16 v[52:55], v[36:39], v[252:255], v[52:55]
    ds_read_b64_tr_b16 v[32:33], v4 offset:40960
    s_waitcnt lgkmcnt(5)
    v_mfma_f32_16x16x32_bf16 v[60:63], v[104:107], v[184:187], v[56:59]
    ds_read_b64_tr_b16 v[34:35], v4 offset:41472
    v_mfma_f32_16x16x32_bf16 v[60:63], v[108:111], v[188:191], v[60:63]
    ds_read_b64_tr_b16 v[36:37], v4 offset:45056
    v_mfma_f32_16x16x32_bf16 v[56:59], v[104:107], v[112:115], v[56:59]
    ds_read_b64_tr_b16 v[38:39], v4 offset:45568
    v_mfma_f32_16x16x32_bf16 v[56:59], v[108:111], v[116:119], v[56:59]
    ds_read_b64_tr_b16 v[104:105], v5 offset:8192
    s_waitcnt lgkmcnt(5)
    v_mfma_f32_16x16x32_bf16 v[56:59], v[24:27], v[120:123], v[56:59]
    ds_read_b64_tr_b16 v[106:107], v5 offset:8704
    v_mfma_f32_16x16x32_bf16 v[56:59], v[28:31], v[124:127], v[56:59]
    ds_read_b64_tr_b16 v[108:109], v5 offset:12288
    buffer_load_dwordx4 v7, s[36:39], s90 offen  lds
    v_mfma_f32_16x16x32_bf16 v[60:63], v[24:27], v[192:195], v[60:63]
    ds_read_b64_tr_b16 v[110:111], v5 offset:12800
    v_mfma_f32_16x16x32_bf16 v[60:63], v[28:31], v[196:199], v[60:63]
    ds_read_b64_tr_b16 v[24:25], v5 offset:16384
    s_waitcnt lgkmcnt(5)
    v_mfma_f32_16x16x32_bf16 v[60:63], v[32:35], v[200:203], v[60:63]
    ds_read_b64_tr_b16 v[26:27], v5 offset:16896
    v_mfma_f32_16x16x32_bf16 v[60:63], v[36:39], v[204:207], v[60:63]
    ds_read_b64_tr_b16 v[28:29], v5 offset:20480
    v_mfma_f32_16x16x32_bf16 v[56:59], v[32:35], v[128:131], v[56:59]
    ds_read_b64_tr_b16 v[30:31], v5 offset:20992
    v_mfma_f32_16x16x32_bf16 v[56:59], v[36:39], v[132:135], v[56:59]
    ds_read_b64_tr_b16 v[32:33], v5 offset:40960
    s_waitcnt lgkmcnt(5)
    v_mfma_f32_16x16x32_bf16 v[68:71], v[104:107], v[184:187], v[64:67]
    ds_read_b64_tr_b16 v[34:35], v5 offset:41472
    s_setprio 1
    v_mfma_f32_16x16x32_bf16 v[68:71], v[108:111], v[188:191], v[68:71]
    s_waitcnt vmcnt(5)
    s_barrier
    ds_read_b64_tr_b16 v[36:37], v5 offset:45056
    v_mfma_f32_16x16x32_bf16 v[64:67], v[104:107], v[112:115], v[64:67]
    ds_read_b64_tr_b16 v[38:39], v5 offset:45568
    v_mfma_f32_16x16x32_bf16 v[64:67], v[108:111], v[116:119], v[64:67]
    s_add_u32 m0, s78, 61440
    s_add_u32 s90, s92, 256
    buffer_load_dwordx4 v7, s[36:39], s90 offen  lds
    v_mul_f32 v12, v40, v40
    v_mul_f32 v13, v41, v41
    v_mul_f32 v14, v42, v42
    v_mul_f32 v15, v43, v43
    v_fmamk_f32 v12, v12, 0xbdd2d3e8, v1
    v_fmamk_f32 v13, v13, 0xbdd2d3e8, v1
    v_fmamk_f32 v14, v14, 0xbdd2d3e8, v1
    s_add_u32 m0, s78, 69632
    s_add_u32 s90, s60, 256
    buffer_load_dwordx4 v7, s[36:39], s90 offen  lds
    v_fmamk_f32 v15, v15, 0xbdd2d3e8, v1
    v_mul_f32 v12, v12, v40
    v_mul_f32 v13, v13, v41
    v_mul_f32 v14, v14, v42
    v_mul_f32 v15, v15, v43
    v_exp_f32 v12, v12
    v_exp_f32 v13, v13
    s_add_u32 m0, s78, 77824
    s_add_u32 s90, s61, 256
    buffer_load_dwordx4 v7, s[36:39], s90 offen  lds
    v_exp_f32 v14, v14
    v_exp_f32 v15, v15
    v_add_f32 v12, 1.0, v12
    v_add_f32 v13, 1.0, v13
    v_add_f32 v14, 1.0, v14
    v_add_f32 v15, 1.0, v15
    v_rcp_f32 v12, v12
    v_rcp_f32 v13, v13
    v_rcp_f32 v14, v14
    v_rcp_f32 v15, v15
    v_mul_f32 v12, v12, v40
    v_mul_f32 v13, v13, v41
    v_mul_f32 v14, v14, v42
    v_mul_f32 v15, v15, v43
    v_cvt_pk_bf16_f32 v72, v12, v13
    v_cvt_pk_bf16_f32 v73, v14, v15
    v_mul_f32 v12, v48, v48
    v_mul_f32 v13, v49, v49
    v_mul_f32 v14, v50, v50
    v_mul_f32 v15, v51, v51
    v_fmamk_f32 v12, v12, 0xbdd2d3e8, v1
    v_fmamk_f32 v13, v13, 0xbdd2d3e8, v1
    v_fmamk_f32 v14, v14, 0xbdd2d3e8, v1
    v_fmamk_f32 v15, v15, 0xbdd2d3e8, v1
    v_mul_f32 v12, v12, v48
    v_mul_f32 v13, v13, v49
    v_mul_f32 v14, v14, v50
    v_mul_f32 v15, v15, v51
    v_mul_f32 v80, 0xbfb8aa3b, v80
    v_and_b32 v81, 15, v22
    v_exp_f32 v80, v80
    s_lshl_b32 s88, s73, 7
    s_add_u32 s88, s88, 158912
    v_lshl_add_u32 v81, v81, 2, s88
    v_add_f32 v80, 1.0, v80
    v_rcp_f32 v80, v80
    s_nop 0
    ds_write_b32 v81, v80
    s_setprio 0
    ds_read_b64_tr_b16 v[104:105], v4 offset:49152
    s_waitcnt lgkmcnt(6)
    v_mfma_f32_16x16x32_bf16 v[64:67], v[24:27], v[120:123], v[64:67]
    ds_read_b64_tr_b16 v[106:107], v4 offset:49664
    ds_read_b128 v[40:43], v6 offset:640
    v_mfma_f32_16x16x32_bf16 v[64:67], v[28:31], v[124:127], v[64:67]
    ds_read_b64_tr_b16 v[108:109], v4 offset:53248
    s_add_u32 m0, s78, 94208
    v_mfma_f32_16x16x32_bf16 v[68:71], v[24:27], v[192:195], v[68:71]
    ds_read_b64_tr_b16 v[110:111], v4 offset:53760
    v_mfma_f32_16x16x32_bf16 v[68:71], v[28:31], v[196:199], v[68:71]
    ds_read_b64_tr_b16 v[24:25], v2
    s_waitcnt lgkmcnt(7)
    v_mfma_f32_16x16x32_bf16 v[68:71], v[32:35], v[200:203], v[68:71]
    ds_read_b64_tr_b16 v[26:27], v2 offset:512
    v_mfma_f32_16x16x32_bf16 v[68:71], v[36:39], v[204:207], v[68:71]
    ds_read_b64_tr_b16 v[28:29], v2 offset:4096
    v_mfma_f32_16x16x32_bf16 v[64:67], v[32:35], v[128:131], v[64:67]
    ds_read_b64_tr_b16 v[30:31], v2 offset:4608
    s_add_u32 s90, s62, 256
    v_mfma_f32_16x16x32_bf16 v[64:67], v[36:39], v[132:135], v[64:67]
    ds_read_b64_tr_b16 v[32:33], v2 offset:8192
    s_waitcnt lgkmcnt(5)
    v_mfma_f32_16x16x32_bf16 v[56:59], v[104:107], v[136:139], v[56:59]
    ds_read_b64_tr_b16 v[34:35], v2 offset:8704
    v_mfma_f32_16x16x32_bf16 v[56:59], v[108:111], v[140:143], v[56:59]
L_page2:
    s_cbranch_execz L_page6
    ds_read_b64_tr_b16 v[36:37], v2 offset:12288
    v_mfma_f32_16x16x32_bf16 v[60:63], v[104:107], v[208:211], v[60:63]
    ds_read_b64_tr_b16 v[38:39], v2 offset:12800
    v_mfma_f32_16x16x32_bf16 v[60:63], v[108:111], v[212:215], v[60:63]
    ds_read_b64_tr_b16 v[104:105], v5 offset:49152
    s_waitcnt lgkmcnt(5)
    v_mfma_f32_16x16x32_bf16 v[60:63], v[24:27], v[216:219], v[60:63]
    ds_read_b64_tr_b16 v[106:107], v5 offset:49664
    v_mfma_f32_16x16x32_bf16 v[60:63], v[28:31], v[220:223], v[60:63]
    ds_read_b64_tr_b16 v[108:109], v5 offset:53248
    buffer_load_dwordx4 v7, s[36:39], s90 offen  lds
    v_mfma_f32_16x16x32_bf16 v[56:59], v[24:27], v[144:147], v[56:59]
    ds_read_b64_tr_b16 v[110:111], v5 offset:53760
    v_mfma_f32_16x16x32_bf16 v[56:59], v[28:31], v[148:151], v[56:59]
    ds_read_b64_tr_b16 v[24:25], v3
    s_waitcnt lgkmcnt(5)
    v_mfma_f32_16x16x32_bf16 v[56:59], v[32:35], v[152:155], v[56:59]
    ds_read_b64_tr_b16 v[26:27], v3 offset:512
    v_mfma_f32_16x16x32_bf16 v[56:59], v[36:39], v[156:159], v[56:59]
    ds_read_b64_tr_b16 v[28:29], v3 offset:4096
    v_mfma_f32_16x16x32_bf16 v[60:63], v[32:35], v[224:227], v[60:63]
    ds_read_b64_tr_b16 v[30:31], v3 offset:4608
    v_mfma_f32_16x16x32_bf16 v[60:63], v[36:39], v[228:231], v[60:63]
    ds_read_b64_tr_b16 v[32:33], v3 offset:8192
    s_waitcnt lgkmcnt(5)
    v_mfma_f32_16x16x32_bf16 v[64:67], v[104:107], v[136:139], v[64:67]
    ds_read_b64_tr_b16 v[34:35], v3 offset:8704
    s_setprio 1
    v_mfma_f32_16x16x32_bf16 v[64:67], v[108:111], v[140:143], v[64:67]
    s_waitcnt vmcnt(6)
    s_barrier
    ds_read_b64_tr_b16 v[36:37], v3 offset:12288
    v_mfma_f32_16x16x32_bf16 v[68:71], v[104:107], v[208:211], v[68:71]
    ds_read_b64_tr_b16 v[38:39], v3 offset:12800
    v_mfma_f32_16x16x32_bf16 v[68:71], v[108:111], v[212:215], v[68:71]
    s_add_u32 m0, s78, 102400
    s_add_u32 s90, s63, 256
    buffer_load_dwordx4 v7, s[36:39], s90 offen  lds
    v_exp_f32 v12, v12
    v_exp_f32 v13, v13
    v_exp_f32 v14, v14
    v_exp_f32 v15, v15
    v_add_f32 v12, 1.0, v12
    v_add_f32 v13, 1.0, v13
    s_add_u32 m0, s78, 110592
    s_add_u32 s90, s70, 256
    buffer_load_dwordx4 v7, s[36:39], s90 offen  lds
    v_add_f32 v14, 1.0, v14
    v_add_f32 v15, 1.0, v15
    v_rcp_f32 v12, v12
    v_rcp_f32 v13, v13
    v_rcp_f32 v14, v14
    v_rcp_f32 v15, v15
    s_add_u32 m0, s78, 118784
    s_add_u32 s90, s71, 256
    buffer_load_dwordx4 v7, s[36:39], s90 offen  lds
    v_mul_f32 v12, v12, v48
    v_mul_f32 v13, v13, v49
    v_mul_f32 v14, v14, v50
    v_mul_f32 v15, v15, v51
    v_cvt_pk_bf16_f32 v74, v12, v13
    v_cvt_pk_bf16_f32 v75, v14, v15
    ds_write_b128 v21, v[72:75] offset:36864
    v_mul_f32 v12, v44, v44
    v_mul_f32 v13, v45, v45
    v_mul_f32 v14, v46, v46
    v_mul_f32 v15, v47, v47
    v_fmamk_f32 v12, v12, 0xbdd2d3e8, v1
    v_fmamk_f32 v13, v13, 0xbdd2d3e8, v1
    v_fmamk_f32 v14, v14, 0xbdd2d3e8, v1
    v_fmamk_f32 v15, v15, 0xbdd2d3e8, v1
    v_mul_f32 v12, v12, v44
    v_mul_f32 v13, v13, v45
    v_mul_f32 v14, v14, v46
    v_mul_f32 v15, v15, v47
    v_exp_f32 v12, v12
    v_exp_f32 v13, v13
    v_exp_f32 v14, v14
    v_exp_f32 v15, v15
    v_add_f32 v12, 1.0, v12
    v_add_f32 v13, 1.0, v13
    v_add_f32 v14, 1.0, v14
    v_add_f32 v15, 1.0, v15
    s_setprio 0
    ds_read_b64_tr_b16 v[104:105], v2 offset:16384
    s_waitcnt lgkmcnt(6)
    v_mfma_f32_16x16x32_bf16 v[68:71], v[24:27], v[216:219], v[68:71]
    ds_read_b64_tr_b16 v[106:107], v2 offset:16896
    ds_read_b128 v[48:51], v6 offset:704
    v_mfma_f32_16x16x32_bf16 v[68:71], v[28:31], v[220:223], v[68:71]
    ds_read_b64_tr_b16 v[108:109], v2 offset:20480
    s_add_u32 m0, s78, 86016
    v_mfma_f32_16x16x32_bf16 v[64:67], v[24:27], v[144:147], v[64:67]
    ds_read_b64_tr_b16 v[110:111], v2 offset:20992
    v_mfma_f32_16x16x32_bf16 v[64:67], v[28:31], v[148:151], v[64:67]
    ds_read_b64_tr_b16 v[24:25], v2 offset:24576
    s_waitcnt lgkmcnt(7)
    v_mfma_f32_16x16x32_bf16 v[64:67], v[32:35], v[152:155], v[64:67]
    ds_read_b64_tr_b16 v[26:27], v2 offset:25088
    v_mfma_f32_16x16x32_bf16 v[64:67], v[36:39], v[156:159], v[64:67]
    ds_read_b64_tr_b16 v[28:29], v2 offset:28672
    v_mfma_f32_16x16x32_bf16 v[68:71], v[32:35], v[224:227], v[68:71]
    ds_read_b64_tr_b16 v[30:31], v2 offset:29184
    s_add_u32 s90, s0, 384
    v_mfma_f32_16x16x32_bf16 v[68:71], v[36:39], v[228:231], v[68:71]
    ds_read_b64_tr_b16 v[32:33], v2 offset:32768
    s_waitcnt lgkmcnt(5)
    v_mfma_f32_16x16x32_bf16 v[56:59], v[104:107], v[160:163], v[56:59]
    ds_read_b64_tr_b16 v[34:35], v2 offset:33280
    v_mfma_f32_16x16x32_bf16 v[56:59], v[108:111], v[164:167], v[56:59]
    ds_read_b64_tr_b16 v[36:37], v2 offset:36864
    v_mfma_f32_16x16x32_bf16 v[60:63], v[104:107], v[232:235], v[60:63]
    ds_read_b64_tr_b16 v[38:39], v2 offset:37376
    v_mfma_f32_16x16x32_bf16 v[60:63], v[108:111], v[236:239], v[60:63]
    ds_read_b64_tr_b16 v[104:105], v3 offset:16384
    s_waitcnt lgkmcnt(5)
    v_mfma_f32_16x16x32_bf16 v[60:63], v[24:27], v[240:243], v[60:63]
    ds_read_b64_tr_b16 v[106:107], v3 offset:16896
    v_mfma_f32_16x16x32_bf16 v[60:63], v[28:31], v[244:247], v[60:63]
    ds_read_b64_tr_b16 v[108:109], v3 offset:20480
    buffer_load_dwordx4 v7, s[36:39], s90 offen  lds
    v_mfma_f32_16x16x32_bf16 v[56:59], v[24:27], v[168:171], v[56:59]
    ds_read_b64_tr_b16 v[110:111], v3 offset:20992
    v_mfma_f32_16x16x32_bf16 v[56:59], v[28:31], v[172:175], v[56:59]
    ds_read_b64_tr_b16 v[24:25], v3 offset:24576
    s_waitcnt lgkmcnt(5)
    v_mfma_f32_16x16x32_bf16 v[56:59], v[32:35], v[176:179], v[56:59]
    ds_read_b64_tr_b16 v[26:27], v3 offset:25088
    v_mfma_f32_16x16x32_bf16 v[56:59], v[36:39], v[180:183], v[56:59]
    ds_read_b64_tr_b16 v[28:29], v3 offset:28672
    v_mfma_f32_16x16x32_bf16 v[60:63], v[32:35], v[248:251], v[60:63]
    ds_read_b64_tr_b16 v[30:31], v3 offset:29184
    v_mfma_f32_16x16x32_bf16 v[60:63], v[36:39], v[252:255], v[60:63]
    ds_read_b64_tr_b16 v[32:33], v3 offset:32768
    s_waitcnt lgkmcnt(5)
    v_mfma_f32_16x16x32_bf16 v[64:67], v[104:107], v[160:163], v[64:67]
    ds_read_b64_tr_b16 v[34:35], v3 offset:33280
    s_setprio 1
    v_mfma_f32_16x16x32_bf16 v[64:67], v[108:111], v[164:167], v[64:67]
    s_waitcnt vmcnt(7)
    s_barrier
    ds_read_b64_tr_b16 v[36:37], v3 offset:36864
    v_mfma_f32_16x16x32_bf16 v[68:71], v[104:107], v[232:235], v[68:71]
    ds_read_b64_tr_b16 v[38:39], v3 offset:37376
    v_mfma_f32_16x16x32_bf16 v[68:71], v[108:111], v[236:239], v[68:71]
    s_add_u32 m0, s78, 4096
    s_add_u32 s90, s1, 384
    buffer_load_dwordx4 v7, s[36:39], s90 offen  lds
    v_rcp_f32 v12, v12
    v_rcp_f32 v13, v13
    v_rcp_f32 v14, v14
    v_rcp_f32 v15, v15
    v_mul_f32 v12, v12, v44
    v_mul_f32 v13, v13, v45
    v_mul_f32 v14, v14, v46
    v_mul_f32 v15, v15, v47
    v_cvt_pk_bf16_f32 v76, v12, v13
    v_cvt_pk_bf16_f32 v77, v14, v15
    s_add_u32 m0, s78, 12288
    s_add_u32 s90, s92, 384
    buffer_load_dwordx4 v7, s[36:39], s90 offen  lds
    v_mul_f32 v12, v52, v52
    v_mul_f32 v13, v53, v53
    v_mul_f32 v14, v54, v54
    v_mul_f32 v15, v55, v55
    v_fmamk_f32 v12, v12, 0xbdd2d3e8, v1
    v_fmamk_f32 v13, v13, 0xbdd2d3e8, v1
    v_fmamk_f32 v14, v14, 0xbdd2d3e8, v1
    v_fmamk_f32 v15, v15, 0xbdd2d3e8, v1
    v_mul_f32 v12, v12, v52
    v_mul_f32 v13, v13, v53
    v_mul_f32 v14, v14, v54
    v_mul_f32 v15, v15, v55
    v_exp_f32 v12, v12
    v_exp_f32 v13, v13
    v_exp_f32 v14, v14
    v_exp_f32 v15, v15
    v_add_f32 v12, 1.0, v12
    v_add_f32 v13, 1.0, v13
    v_add_f32 v14, 1.0, v14
    v_add_f32 v15, 1.0, v15
    v_rcp_f32 v12, v12
    v_rcp_f32 v13, v13
    v_rcp_f32 v14, v14
    v_rcp_f32 v15, v15
    v_mul_f32 v12, v12, v52
    v_mul_f32 v13, v13, v53
    v_mul_f32 v14, v14, v54
    v_mul_f32 v15, v15, v55
    v_cvt_pk_bf16_f32 v78, v12, v13
    v_cvt_pk_bf16_f32 v79, v14, v15
    ds_write_b128 v21, v[76:79] offset:45056
    s_setprio 0
    ds_read_b64_tr_b16 v[104:105], v2 offset:40960
    s_waitcnt lgkmcnt(6)
    v_mfma_f32_16x16x32_bf16 v[68:71], v[24:27], v[240:243], v[68:71]
    ds_read_b64_tr_b16 v[106:107], v2 offset:41472
    s_add_u32 m0, s78, 20480
    v_mfma_f32_16x16x32_bf16 v[68:71], v[28:31], v[244:247], v[68:71]
    ds_read_b64_tr_b16 v[108:109], v2 offset:45056
    v_mfma_f32_16x16x32_bf16 v[64:67], v[24:27], v[168:171], v[64:67]
    ds_read_b64_tr_b16 v[110:111], v2 offset:45568
    v_mfma_f32_16x16x32_bf16 v[64:67], v[28:31], v[172:175], v[64:67]
    ds_read_b64_tr_b16 v[24:25], v2 offset:49152
    s_waitcnt lgkmcnt(6)
    v_mfma_f32_16x16x32_bf16 v[64:67], v[32:35], v[176:179], v[64:67]
    ds_read_b64_tr_b16 v[26:27], v2 offset:49664
    v_mfma_f32_16x16x32_bf16 v[64:67], v[36:39], v[180:183], v[64:67]
    ds_read_b64_tr_b16 v[28:29], v2 offset:53248
    v_mfma_f32_16x16x32_bf16 v[68:71], v[32:35], v[248:251], v[68:71]
    ds_read_b64_tr_b16 v[30:31], v2 offset:53760
    s_add_u32 s90, s60, 384
    v_mfma_f32_16x16x32_bf16 v[68:71], v[36:39], v[252:255], v[68:71]
    ds_read_b64_tr_b16 v[32:33], v2 offset:57344
    s_waitcnt lgkmcnt(5)
    v_mfma_f32_16x16x32_bf16 v[44:47], v[104:107], v[184:187], v[40:43]
    ds_read_b64_tr_b16 v[34:35], v2 offset:57856
    v_mfma_f32_16x16x32_bf16 v[44:47], v[108:111], v[188:191], v[44:47]
    ds_read_b64_tr_b16 v[36:37], v2 offset:61440
    v_mfma_f32_16x16x32_bf16 v[40:43], v[104:107], v[112:115], v[40:43]
    ds_read_b64_tr_b16 v[38:39], v2 offset:61952
    v_mfma_f32_16x16x32_bf16 v[40:43], v[108:111], v[116:119], v[40:43]
    ds_read_b64_tr_b16 v[104:105], v3 offset:40960
    s_waitcnt lgkmcnt(5)
    v_mfma_f32_16x16x32_bf16 v[40:43], v[24:27], v[120:123], v[40:43]
    ds_read_b64_tr_b16 v[106:107], v3 offset:41472
    v_mfma_f32_16x16x32_bf16 v[40:43], v[28:31], v[124:127], v[40:43]
    ds_read_b64_tr_b16 v[108:109], v3 offset:45056
    buffer_load_dwordx4 v7, s[36:39], s90 offen  lds
    v_mfma_f32_16x16x32_bf16 v[44:47], v[24:27], v[192:195], v[44:47]
    ds_read_b64_tr_b16 v[110:111], v3 offset:45568
    v_mfma_f32_16x16x32_bf16 v[44:47], v[28:31], v[196:199], v[44:47]
    ds_read_b64_tr_b16 v[24:25], v3 offset:49152
    s_waitcnt lgkmcnt(5)
    v_mfma_f32_16x16x32_bf16 v[44:47], v[32:35], v[200:203], v[44:47]
    ds_read_b64_tr_b16 v[26:27], v3 offset:49664
    v_mfma_f32_16x16x32_bf16 v[44:47], v[36:39], v[204:207], v[44:47]
    ds_read_b64_tr_b16 v[28:29], v3 offset:53248
    v_mfma_f32_16x16x32_bf16 v[40:43], v[32:35], v[128:131], v[40:43]
    ds_read_b64_tr_b16 v[30:31], v3 offset:53760
    v_mfma_f32_16x16x32_bf16 v[40:43], v[36:39], v[132:135], v[40:43]
    ds_read_b64_tr_b16 v[32:33], v3 offset:57344
    s_waitcnt lgkmcnt(5)
    v_mfma_f32_16x16x32_bf16 v[52:55], v[104:107], v[184:187], v[48:51]
    ds_read_b64_tr_b16 v[34:35], v3 offset:57856
    s_setprio 1
    v_mfma_f32_16x16x32_bf16 v[52:55], v[108:111], v[188:191], v[52:55]
    s_waitcnt vmcnt(7)
    s_barrier
    ds_read_b64_tr_b16 v[36:37], v3 offset:61440
    v_mfma_f32_16x16x32_bf16 v[48:51], v[104:107], v[112:115], v[48:51]
    ds_read_b64_tr_b16 v[38:39], v3 offset:61952
    v_mfma_f32_16x16x32_bf16 v[48:51], v[108:111], v[116:119], v[48:51]
    s_bfm_b64 exec, 11, 0
    s_mov_b32 m0, 157184
    s_nop 0
    buffer_load_dword v100, s[40:43], 0 offen lds
    s_mov_b64 exec, -1
    s_add_u32 m0, s78, 28672
    s_add_u32 s90, s61, 384
    buffer_load_dwordx4 v7, s[36:39], s90 offen  lds
    v_mul_f32 v12, v56, v56
    v_mul_f32 v13, v57, v57
    v_mul_f32 v14, v58, v58
    v_mul_f32 v15, v59, v59
    v_fmamk_f32 v12, v12, 0xbdd2d3e8, v1
    v_fmamk_f32 v13, v13, 0xbdd2d3e8, v1
    v_fmamk_f32 v14, v14, 0xbdd2d3e8, v1
    v_fmamk_f32 v15, v15, 0xbdd2d3e8, v1
    v_mul_f32 v12, v12, v56
    v_mul_f32 v13, v13, v57
    s_add_u32 m0, s78, 36864
    s_add_u32 s90, s62, 384
    buffer_load_dwordx4 v7, s[36:39], s90 offen  lds
    v_mul_f32 v14, v14, v58
    v_mul_f32 v15, v15, v59
    v_exp_f32 v12, v12
    v_exp_f32 v13, v13
    v_exp_f32 v14, v14
    v_exp_f32 v15, v15
    v_add_f32 v12, 1.0, v12
    v_add_f32 v13, 1.0, v13
    v_add_f32 v14, 1.0, v14
    v_add_f32 v15, 1.0, v15
    v_rcp_f32 v12, v12
    v_rcp_f32 v13, v13
    v_rcp_f32 v14, v14
    v_rcp_f32 v15, v15
    v_mul_f32 v12, v12, v56
    v_mul_f32 v13, v13, v57
    v_mul_f32 v14, v14, v58
    v_mul_f32 v15, v15, v59
    v_cvt_pk_bf16_f32 v80, v12, v13
    v_cvt_pk_bf16_f32 v81, v14, v15
    v_mul_f32 v12, v64, v64
    v_mul_f32 v13, v65, v65
    v_mul_f32 v14, v66, v66
    v_mul_f32 v15, v67, v67
    v_fmamk_f32 v12, v12, 0xbdd2d3e8, v1
    v_fmamk_f32 v13, v13, 0xbdd2d3e8, v1
    v_fmamk_f32 v14, v14, 0xbdd2d3e8, v1
    v_fmamk_f32 v15, v15, 0xbdd2d3e8, v1
    v_mul_f32 v12, v12, v64
    v_mul_f32 v13, v13, v65
    v_mul_f32 v14, v14, v66
    v_mul_f32 v15, v15, v67
    s_setprio 0
    ds_read_b64_tr_b16 v[104:105], v4
    s_waitcnt lgkmcnt(5)
    v_mfma_f32_16x16x32_bf16 v[48:51], v[24:27], v[120:123], v[48:51]
    ds_read_b64_tr_b16 v[106:107], v4 offset:512
    ds_read_b128 v[56:59], v6 offset:896
    v_mfma_f32_16x16x32_bf16 v[48:51], v[28:31], v[124:127], v[48:51]
    ds_read_b64_tr_b16 v[108:109], v4 offset:4096
    s_add_u32 m0, s78, 45056
    v_mfma_f32_16x16x32_bf16 v[52:55], v[24:27], v[192:195], v[52:55]
    ds_read_b64_tr_b16 v[110:111], v4 offset:4608
    v_mfma_f32_16x16x32_bf16 v[52:55], v[28:31], v[196:199], v[52:55]
    ds_read_b64_tr_b16 v[24:25], v4 offset:8192
    s_waitcnt lgkmcnt(6)
    v_mfma_f32_16x16x32_bf16 v[52:55], v[32:35], v[200:203], v[52:55]
    ds_read_b64_tr_b16 v[26:27], v4 offset:8704
    v_mfma_f32_16x16x32_bf16 v[52:55], v[36:39], v[204:207], v[52:55]
    ds_read_b64_tr_b16 v[28:29], v4 offset:12288
    v_mfma_f32_16x16x32_bf16 v[48:51], v[32:35], v[128:131], v[48:51]
    ds_read_b64_tr_b16 v[30:31], v4 offset:12800
    s_add_u32 s90, s63, 384
    v_mfma_f32_16x16x32_bf16 v[48:51], v[36:39], v[132:135], v[48:51]
    ds_read_b64_tr_b16 v[32:33], v4 offset:24576
    s_waitcnt lgkmcnt(5)
    v_mfma_f32_16x16x32_bf16 v[40:43], v[104:107], v[136:139], v[40:43]
    ds_read_b64_tr_b16 v[34:35], v4 offset:25088
    v_mfma_f32_16x16x32_bf16 v[40:43], v[108:111], v[140:143], v[40:43]
    ds_read_b64_tr_b16 v[36:37], v4 offset:28672
    v_mfma_f32_16x16x32_bf16 v[44:47], v[104:107], v[208:211], v[44:47]
    ds_read_b64_tr_b16 v[38:39], v4 offset:29184
    v_mfma_f32_16x16x32_bf16 v[44:47], v[108:111], v[212:215], v[44:47]
    ds_read_b64_tr_b16 v[104:105], v5
    s_waitcnt lgkmcnt(5)
    v_mfma_f32_16x16x32_bf16 v[44:47], v[24:27], v[216:219], v[44:47]
    ds_read_b64_tr_b16 v[106:107], v5 offset:512
    v_mfma_f32_16x16x32_bf16 v[44:47], v[28:31], v[220:223], v[44:47]
    ds_read_b64_tr_b16 v[108:109], v5 offset:4096
    buffer_load_dwordx4 v7, s[36:39], s90 offen  lds
    v_mfma_f32_16x16x32_bf16 v[40:43], v[24:27], v[144:147], v[40:43]
    ds_read_b64_tr_b16 v[110:111], v5 offset:4608
    v_mfma_f32_16x16x32_bf16 v[40:43], v[28:31], v[148:151], v[40:43]
    ds_read_b64_tr_b16 v[24:25], v5 offset:8192
    s_waitcnt lgkmcnt(5)
    v_mfma_f32_16x16x32_bf16 v[40:43], v[32:35], v[152:155], v[40:43]
    ds_read_b64_tr_b16 v[26:27], v5 offset:8704
    v_mfma_f32_16x16x32_bf16 v[40:43], v[36:39], v[156:159], v[40:43]
    ds_read_b64_tr_b16 v[28:29], v5 offset:12288
    v_mfma_f32_16x16x32_bf16 v[44:47], v[32:35], v[224:227], v[44:47]
    ds_read_b64_tr_b16 v[30:31], v5 offset:12800
    v_mfma_f32_16x16x32_bf16 v[44:47], v[36:39], v[228:231], v[44:47]
    ds_read_b64_tr_b16 v[32:33], v5 offset:24576
    s_waitcnt lgkmcnt(5)
    v_mfma_f32_16x16x32_bf16 v[48:51], v[104:107], v[136:139], v[48:51]
    ds_read_b64_tr_b16 v[34:35], v5 offset:25088
    s_setprio 1
    v_mfma_f32_16x16x32_bf16 v[48:51], v[108:111], v[140:143], v[48:51]
    s_waitcnt vmcnt(8)
    s_barrier
    ds_read_b64_tr_b16 v[36:37], v5 offset:28672
    v_mfma_f32_16x16x32_bf16 v[52:55], v[104:107], v[208:211], v[52:55]
    ds_read_b64_tr_b16 v[38:39], v5 offset:29184
    v_mfma_f32_16x16x32_bf16 v[52:55], v[108:111], v[212:215], v[52:55]
    s_add_u32 m0, s78, 53248
    s_add_u32 s90, s70, 384
    buffer_load_dwordx4 v7, s[36:39], s90 offen  lds
    v_exp_f32 v12, v12
    v_exp_f32 v13, v13
    v_exp_f32 v14, v14
    v_exp_f32 v15, v15
    v_add_f32 v12, 1.0, v12
    v_add_f32 v13, 1.0, v13
    v_add_f32 v14, 1.0, v14
    v_add_f32 v15, 1.0, v15
    v_rcp_f32 v12, v12
    s_add_u32 m0, s78, 61440
    s_add_u32 s90, s71, 384
    buffer_load_dwordx4 v7, s[36:39], s90 offen  lds
    v_rcp_f32 v13, v13
    v_rcp_f32 v14, v14
    v_rcp_f32 v15, v15
    v_mul_f32 v12, v12, v64
    v_mul_f32 v13, v13, v65
    v_mul_f32 v14, v14, v66
    v_mul_f32 v15, v15, v67
    v_cvt_pk_bf16_f32 v82, v12, v13
    v_cvt_pk_bf16_f32 v83, v14, v15
    ds_write_b128 v21, v[80:83] offset:20480
    v_mul_f32 v12, v60, v60
    v_mul_f32 v13, v61, v61
    v_mul_f32 v14, v62, v62
    v_mul_f32 v15, v63, v63
    v_fmamk_f32 v12, v12, 0xbdd2d3e8, v1
    v_fmamk_f32 v13, v13, 0xbdd2d3e8, v1
    v_fmamk_f32 v14, v14, 0xbdd2d3e8, v1
    v_fmamk_f32 v15, v15, 0xbdd2d3e8, v1
    v_mul_f32 v12, v12, v60
    v_mul_f32 v13, v13, v61
    v_mul_f32 v14, v14, v62
    v_mul_f32 v15, v15, v63
    v_exp_f32 v12, v12
    v_exp_f32 v13, v13
    v_exp_f32 v14, v14
    v_exp_f32 v15, v15
    v_add_f32 v12, 1.0, v12
    v_add_f32 v13, 1.0, v13
    v_add_f32 v14, 1.0, v14
    v_add_f32 v15, 1.0, v15
    s_setprio 0
    ds_read_b64_tr_b16 v[104:105], v4 offset:32768
    s_waitcnt lgkmcnt(6)
    v_mfma_f32_16x16x32_bf16 v[52:55], v[24:27], v[216:219], v[52:55]
    ds_read_b64_tr_b16 v[106:107], v4 offset:33280
    ds_read_b128 v[64:67], v6 offset:960
    v_mfma_f32_16x16x32_bf16 v[52:55], v[28:31], v[220:223], v[52:55]
    ds_read_b64_tr_b16 v[108:109], v4 offset:36864
    s_add_u32 m0, s78, 65536
    v_mfma_f32_16x16x32_bf16 v[48:51], v[24:27], v[144:147], v[48:51]
    ds_read_b64_tr_b16 v[110:111], v4 offset:37376
    v_mfma_f32_16x16x32_bf16 v[48:51], v[28:31], v[148:151], v[48:51]
    ds_read_b64_tr_b16 v[24:25], v4 offset:40960
    s_waitcnt lgkmcnt(7)
    v_mfma_f32_16x16x32_bf16 v[48:51], v[32:35], v[152:155], v[48:51]
    ds_read_b64_tr_b16 v[26:27], v4 offset:41472
    v_mfma_f32_16x16x32_bf16 v[48:51], v[36:39], v[156:159], v[48:51]
    ds_read_b64_tr_b16 v[28:29], v4 offset:45056
    v_mfma_f32_16x16x32_bf16 v[52:55], v[32:35], v[224:227], v[52:55]
    ds_read_b64_tr_b16 v[30:31], v4 offset:45568
    s_add_u32 s90, s0, s80
    v_mfma_f32_16x16x32_bf16 v[52:55], v[36:39], v[228:231], v[52:55]
    ds_read_b64_tr_b16 v[32:33], v4 offset:49152
    s_waitcnt lgkmcnt(5)
    v_mfma_f32_16x16x32_bf16 v[40:43], v[104:107], v[160:163], v[40:43]
    ds_read_b64_tr_b16 v[34:35], v4 offset:49664
    v_mfma_f32_16x16x32_bf16 v[40:43], v[108:111], v[164:167], v[40:43]
    ds_read_b64_tr_b16 v[36:37], v4 offset:53248
    v_mfma_f32_16x16x32_bf16 v[44:47], v[104:107], v[232:235], v[44:47]
    ds_read_b64_tr_b16 v[38:39], v4 offset:53760
    v_mfma_f32_16x16x32_bf16 v[44:47], v[108:111], v[236:239], v[44:47]
    ds_read_b64_tr_b16 v[104:105], v5 offset:32768
    s_waitcnt lgkmcnt(5)
    v_mfma_f32_16x16x32_bf16 v[44:47], v[24:27], v[240:243], v[44:47]
    ds_read_b64_tr_b16 v[106:107], v5 offset:33280
    v_mfma_f32_16x16x32_bf16 v[44:47], v[28:31], v[244:247], v[44:47]
    ds_read_b64_tr_b16 v[108:109], v5 offset:36864
    buffer_load_dwordx4 v23, s[36:39], s90 offen  lds
    v_mfma_f32_16x16x32_bf16 v[40:43], v[24:27], v[168:171], v[40:43]
    ds_read_b64_tr_b16 v[110:111], v5 offset:37376
    v_mfma_f32_16x16x32_bf16 v[40:43], v[28:31], v[172:175], v[40:43]
    ds_read_b64_tr_b16 v[24:25], v5 offset:40960
    s_waitcnt lgkmcnt(5)
    v_mfma_f32_16x16x32_bf16 v[40:43], v[32:35], v[176:179], v[40:43]
    ds_read_b64_tr_b16 v[26:27], v5 offset:41472
    v_mfma_f32_16x16x32_bf16 v[40:43], v[36:39], v[180:183], v[40:43]
    ds_read_b64_tr_b16 v[28:29], v5 offset:45056
    v_mfma_f32_16x16x32_bf16 v[44:47], v[32:35], v[248:251], v[44:47]
    ds_read_b64_tr_b16 v[30:31], v5 offset:45568
    v_mfma_f32_16x16x32_bf16 v[44:47], v[36:39], v[252:255], v[44:47]
    ds_read_b64_tr_b16 v[32:33], v5 offset:49152
    s_waitcnt lgkmcnt(5)
    v_mfma_f32_16x16x32_bf16 v[48:51], v[104:107], v[160:163], v[48:51]
    ds_read_b64_tr_b16 v[34:35], v5 offset:49664
    s_setprio 1
    v_mfma_f32_16x16x32_bf16 v[48:51], v[108:111], v[164:167], v[48:51]
    s_waitcnt vmcnt(8)
    s_barrier
    ds_read_b64_tr_b16 v[36:37], v5 offset:53248
    v_mfma_f32_16x16x32_bf16 v[52:55], v[104:107], v[232:235], v[52:55]
    ds_read_b64_tr_b16 v[38:39], v5 offset:53760
    v_mfma_f32_16x16x32_bf16 v[52:55], v[108:111], v[236:239], v[52:55]
    s_add_u32 m0, s78, 73728
    s_add_u32 s90, s92, s80
    buffer_load_dwordx4 v23, s[36:39], s90 offen  lds
    v_rcp_f32 v12, v12
    v_rcp_f32 v13, v13
    v_rcp_f32 v14, v14
    v_rcp_f32 v15, v15
    v_mul_f32 v12, v12, v60
    v_mul_f32 v13, v13, v61
    v_mul_f32 v14, v14, v62
    v_mul_f32 v15, v15, v63
    v_cvt_pk_bf16_f32 v84, v12, v13
    v_cvt_pk_bf16_f32 v85, v14, v15
    s_add_u32 m0, s78, 77824
    s_add_u32 s90, s60, s80
    buffer_load_dwordx4 v23, s[36:39], s90 offen  lds
    v_mul_f32 v12, v68, v68
    v_mul_f32 v13, v69, v69
    v_mul_f32 v14, v70, v70
    v_mul_f32 v15, v71, v71
    v_fmamk_f32 v12, v12, 0xbdd2d3e8, v1
    v_fmamk_f32 v13, v13, 0xbdd2d3e8, v1
    v_fmamk_f32 v14, v14, 0xbdd2d3e8, v1
    v_fmamk_f32 v15, v15, 0xbdd2d3e8, v1
    v_mul_f32 v12, v12, v68
    v_mul_f32 v13, v13, v69
    v_mul_f32 v14, v14, v70
    v_mul_f32 v15, v15, v71
    v_exp_f32 v12, v12
    v_exp_f32 v13, v13
    v_exp_f32 v14, v14
    v_exp_f32 v15, v15
    v_add_f32 v12, 1.0, v12
    v_add_f32 v13, 1.0, v13
    v_add_f32 v14, 1.0, v14
    v_add_f32 v15, 1.0, v15
    v_rcp_f32 v12, v12
    v_rcp_f32 v13, v13
    v_rcp_f32 v14, v14
    v_rcp_f32 v15, v15
    v_mul_f32 v12, v12, v68
    v_mul_f32 v13, v13, v69
    v_mul_f32 v14, v14, v70
    v_mul_f32 v15, v15, v71
    v_cvt_pk_bf16_f32 v86, v12, v13
    v_cvt_pk_bf16_f32 v87, v14, v15
    ds_write_b128 v21, v[84:87] offset:28672
    s_setprio 0
    ds_read_b64_tr_b16 v[104:105], v4 offset:16384
    s_waitcnt lgkmcnt(6)
    v_mfma_f32_16x16x32_bf16 v[52:55], v[24:27], v[240:243], v[52:55]
    ds_read_b64_tr_b16 v[106:107], v4 offset:16896
    s_add_u32 m0, s78, 90112
    v_mfma_f32_16x16x32_bf16 v[52:55], v[28:31], v[244:247], v[52:55]
    ds_read_b64_tr_b16 v[108:109], v4 offset:20480
    v_mfma_f32_16x16x32_bf16 v[48:51], v[24:27], v[168:171], v[48:51]
    ds_read_b64_tr_b16 v[110:111], v4 offset:20992
    v_mfma_f32_16x16x32_bf16 v[48:51], v[28:31], v[172:175], v[48:51]
    ds_read_b64_tr_b16 v[24:25], v2
    s_waitcnt lgkmcnt(6)
    v_mfma_f32_16x16x32_bf16 v[48:51], v[32:35], v[176:179], v[48:51]
    ds_read_b64_tr_b16 v[26:27], v2 offset:512
    v_mfma_f32_16x16x32_bf16 v[48:51], v[36:39], v[180:183], v[48:51]
    ds_read_b64_tr_b16 v[28:29], v2 offset:4096
    v_mfma_f32_16x16x32_bf16 v[52:55], v[32:35], v[248:251], v[52:55]
    ds_read_b64_tr_b16 v[30:31], v2 offset:4608
    s_add_u32 s90, s61, s80
    v_mfma_f32_16x16x32_bf16 v[52:55], v[36:39], v[252:255], v[52:55]
    ds_read_b64_tr_b16 v[32:33], v2 offset:8192
    s_waitcnt lgkmcnt(5)
    v_mfma_f32_16x16x32_bf16 v[60:63], v[104:107], v[184:187], v[56:59]
    ds_read_b64_tr_b16 v[34:35], v2 offset:8704
    v_mfma_f32_16x16x32_bf16 v[60:63], v[108:111], v[188:191], v[60:63]
    ds_read_b64_tr_b16 v[36:37], v2 offset:12288
    v_mfma_f32_16x16x32_bf16 v[56:59], v[104:107], v[112:115], v[56:59]
    ds_read_b64_tr_b16 v[38:39], v2 offset:12800
    v_mfma_f32_16x16x32_bf16 v[56:59], v[108:111], v[116:119], v[56:59]
    ds_read_b64_tr_b16 v[104:105], v5 offset:16384
    s_waitcnt lgkmcnt(5)
    v_mfma_f32_16x16x32_bf16 v[56:59], v[24:27], v[120:123], v[56:59]
    ds_read_b64_tr_b16 v[106:107], v5 offset:16896
    v_mfma_f32_16x16x32_bf16 v[56:59], v[28:31], v[124:127], v[56:59]
    ds_read_b64_tr_b16 v[108:109], v5 offset:20480
    buffer_load_dwordx4 v23, s[36:39], s90 offen  lds
    v_mfma_f32_16x16x32_bf16 v[60:63], v[24:27], v[192:195], v[60:63]
    ds_read_b64_tr_b16 v[110:111], v5 offset:20992
    v_mfma_f32_16x16x32_bf16 v[60:63], v[28:31], v[196:199], v[60:63]
    ds_read_b64_tr_b16 v[24:25], v3
    s_waitcnt lgkmcnt(5)
    v_mfma_f32_16x16x32_bf16 v[60:63], v[32:35], v[200:203], v[60:63]
    ds_read_b64_tr_b16 v[26:27], v3 offset:512
    v_mfma_f32_16x16x32_bf16 v[60:63], v[36:39], v[204:207], v[60:63]
    ds_read_b64_tr_b16 v[28:29], v3 offset:4096
    v_mfma_f32_16x16x32_bf16 v[56:59], v[32:35], v[128:131], v[56:59]
    ds_read_b64_tr_b16 v[30:31], v3 offset:4608
    v_mfma_f32_16x16x32_bf16 v[56:59], v[36:39], v[132:135], v[56:59]
    ds_read_b64_tr_b16 v[32:33], v3 offset:8192
    s_waitcnt lgkmcnt(5)
    v_mfma_f32_16x16x32_bf16 v[68:71], v[104:107], v[184:187], v[64:67]
    ds_read_b64_tr_b16 v[34:35], v3 offset:8704
    s_setprio 1
    v_mfma_f32_16x16x32_bf16 v[68:71], v[108:111], v[188:191], v[68:71]
    s_waitcnt vmcnt(7)
    s_barrier
    ds_read_b64_tr_b16 v[36:37], v3 offset:12288
    v_mfma_f32_16x16x32_bf16 v[64:67], v[104:107], v[112:115], v[64:67]
    ds_read_b64_tr_b16 v[38:39], v3 offset:12800
    v_mfma_f32_16x16x32_bf16 v[64:67], v[108:111], v[116:119], v[64:67]
    s_bfm_b64 exec, 10, 11
    s_mov_b32 m0, 157184
    s_nop 0
    buffer_load_dword v100, s[40:43], 0 offen lds
    s_mov_b64 exec, -1
    v_mul_f32 v12, v40, v40
    v_mul_f32 v13, v41, v41
    v_mul_f32 v14, v42, v42
    v_mul_f32 v15, v43, v43
    v_fmamk_f32 v12, v12, 0xbdd2d3e8, v1
    v_fmamk_f32 v13, v13, 0xbdd2d3e8, v1
    v_fmamk_f32 v14, v14, 0xbdd2d3e8, v1
    v_fmamk_f32 v15, v15, 0xbdd2d3e8, v1
    v_mul_f32 v12, v12, v40
    v_mul_f32 v13, v13, v41
    v_mul_f32 v14, v14, v42
    v_mul_f32 v15, v15, v43
    v_exp_f32 v12, v12
    v_exp_f32 v13, v13
    v_exp_f32 v14, v14
    v_exp_f32 v15, v15
    v_add_f32 v12, 1.0, v12
    v_add_f32 v13, 1.0, v13
    v_add_f32 v14, 1.0, v14
    v_add_f32 v15, 1.0, v15
    v_rcp_f32 v12, v12
    v_rcp_f32 v13, v13
    v_rcp_f32 v14, v14
    v_rcp_f32 v15, v15
    v_mul_f32 v12, v12, v40
    v_mul_f32 v13, v13, v41
    v_mul_f32 v14, v14, v42
    v_mul_f32 v15, v15, v43
    v_cvt_pk_bf16_f32 v88, v12, v13
    v_cvt_pk_bf16_f32 v89, v14, v15
    v_mul_f32 v12, v48, v48
    v_mul_f32 v13, v49, v49
    v_mul_f32 v14, v50, v50
    v_mul_f32 v15, v51, v51
    v_fmamk_f32 v12, v12, 0xbdd2d3e8, v1
    v_fmamk_f32 v13, v13, 0xbdd2d3e8, v1
    v_fmamk_f32 v14, v14, 0xbdd2d3e8, v1
    v_fmamk_f32 v15, v15, 0xbdd2d3e8, v1
    v_mul_f32 v12, v12, v48
    v_mul_f32 v13, v13, v49
    v_mul_f32 v14, v14, v50
    v_mul_f32 v15, v15, v51
    s_setprio 0
    ds_read_b64_tr_b16 v[104:105], v2 offset:16384
    s_waitcnt lgkmcnt(5)
    v_mfma_f32_16x16x32_bf16 v[64:67], v[24:27], v[120:123], v[64:67]
    ds_read_b64_tr_b16 v[106:107], v2 offset:16896
    ds_read_b128 v[40:43], v6 offset:1088
    v_mfma_f32_16x16x32_bf16 v[64:67], v[28:31], v[124:127], v[64:67]
    ds_read_b64_tr_b16 v[108:109], v2 offset:20480
    s_add_u32 m0, s78, 81920
    v_mfma_f32_16x16x32_bf16 v[68:71], v[24:27], v[192:195], v[68:71]
    ds_read_b64_tr_b16 v[110:111], v2 offset:20992
    v_mfma_f32_16x16x32_bf16 v[68:71], v[28:31], v[196:199], v[68:71]
L_page3:
    s_cbranch_execz L_page7
    ds_read_b64_tr_b16 v[24:25], v2 offset:24576
    s_waitcnt lgkmcnt(6)
    v_mfma_f32_16x16x32_bf16 v[68:71], v[32:35], v[200:203], v[68:71]
    ds_read_b64_tr_b16 v[26:27], v2 offset:25088
    v_mfma_f32_16x16x32_bf16 v[68:71], v[36:39], v[204:207], v[68:71]
    ds_read_b64_tr_b16 v[28:29], v2 offset:28672
    v_mfma_f32_16x16x32_bf16 v[64:67], v[32:35], v[128:131], v[64:67]
    ds_read_b64_tr_b16 v[30:31], v2 offset:29184
    s_add_u32 s90, s71, s80
    v_mfma_f32_16x16x32_bf16 v[64:67], v[36:39], v[132:135], v[64:67]
    ds_read_b64_tr_b16 v[32:33], v2 offset:32768
    s_waitcnt lgkmcnt(5)
    v_mfma_f32_16x16x32_bf16 v[56:59], v[104:107], v[136:139], v[56:59]
    ds_read_b64_tr_b16 v[34:35], v2 offset:33280
    v_mfma_f32_16x16x32_bf16 v[56:59], v[108:111], v[140:143], v[56:59]
    ds_read_b64_tr_b16 v[36:37], v2 offset:36864
    v_mfma_f32_16x16x32_bf16 v[60:63], v[104:107], v[208:211], v[60:63]
    ds_read_b64_tr_b16 v[38:39], v2 offset:37376
    v_mfma_f32_16x16x32_bf16 v[60:63], v[108:111], v[212:215], v[60:63]
    ds_read_b64_tr_b16 v[104:105], v3 offset:16384
    s_waitcnt lgkmcnt(5)
    v_mfma_f32_16x16x32_bf16 v[60:63], v[24:27], v[216:219], v[60:63]
    ds_read_b64_tr_b16 v[106:107], v3 offset:16896
    v_mfma_f32_16x16x32_bf16 v[60:63], v[28:31], v[220:223], v[60:63]
    ds_read_b64_tr_b16 v[108:109], v3 offset:20480
    buffer_load_dwordx4 v23, s[36:39], s90 offen  lds
    v_mfma_f32_16x16x32_bf16 v[56:59], v[24:27], v[144:147], v[56:59]
    ds_read_b64_tr_b16 v[110:111], v3 offset:20992
    v_mfma_f32_16x16x32_bf16 v[56:59], v[28:31], v[148:151], v[56:59]
    ds_read_b64_tr_b16 v[24:25], v3 offset:24576
    s_waitcnt lgkmcnt(5)
    v_mfma_f32_16x16x32_bf16 v[56:59], v[32:35], v[152:155], v[56:59]
    ds_read_b64_tr_b16 v[26:27], v3 offset:25088
    v_mfma_f32_16x16x32_bf16 v[56:59], v[36:39], v[156:159], v[56:59]
    ds_read_b64_tr_b16 v[28:29], v3 offset:28672
    v_mfma_f32_16x16x32_bf16 v[60:63], v[32:35], v[224:227], v[60:63]
    ds_read_b64_tr_b16 v[30:31], v3 offset:29184
    v_mfma_f32_16x16x32_bf16 v[60:63], v[36:39], v[228:231], v[60:63]
    ds_read_b64_tr_b16 v[32:33], v3 offset:32768
    s_waitcnt lgkmcnt(5)
    v_mfma_f32_16x16x32_bf16 v[64:67], v[104:107], v[136:139], v[64:67]
    ds_read_b64_tr_b16 v[34:35], v3 offset:33280
    s_setprio 1
    v_mfma_f32_16x16x32_bf16 v[64:67], v[108:111], v[140:143], v[64:67]
    s_waitcnt vmcnt(6)
    s_barrier
    ds_read_b64_tr_b16 v[36:37], v3 offset:36864
    v_mfma_f32_16x16x32_bf16 v[68:71], v[104:107], v[208:211], v[68:71]
    ds_read_b64_tr_b16 v[38:39], v3 offset:37376
    v_mfma_f32_16x16x32_bf16 v[68:71], v[108:111], v[212:215], v[68:71]
    s_add_u32 m0, s78, 0
    s_add_u32 s81, s81, 1
    s_cmp_eq_u32 s81, 9
    global_load_lds_dwordx4 v[16:17], off
    s_cselect_b32 s90, -8, 1
    s_cselect_b32 s81, 0, s81
    v_mad_i64_i32 v[16:17], vcc, v18, s90, v[16:17]
    v_exp_f32 v12, v12
    v_exp_f32 v13, v13
    v_exp_f32 v14, v14
    v_exp_f32 v15, v15
    v_add_f32 v12, 1.0, v12
    v_add_f32 v13, 1.0, v13
    v_add_f32 v14, 1.0, v14
    v_add_f32 v15, 1.0, v15
    v_rcp_f32 v12, v12
    s_add_u32 m0, s78, 8192
    s_add_u32 s81, s81, 1
    s_cmp_eq_u32 s81, 9
    global_load_lds_dwordx4 v[16:17], off
    s_cselect_b32 s90, -8, 1
    s_cselect_b32 s81, 0, s81
    v_mad_i64_i32 v[16:17], vcc, v18, s90, v[16:17]
    v_rcp_f32 v13, v13
    v_rcp_f32 v14, v14
    v_rcp_f32 v15, v15
    v_mul_f32 v12, v12, v48
    v_mul_f32 v13, v13, v49
    v_mul_f32 v14, v14, v50
    v_mul_f32 v15, v15, v51
    v_cvt_pk_bf16_f32 v90, v12, v13
    v_cvt_pk_bf16_f32 v91, v14, v15
    ds_write_b128 v21, v[88:91] offset:4096
    v_mul_f32 v12, v44, v44
    v_mul_f32 v13, v45, v45
    v_mul_f32 v14, v46, v46
    v_mul_f32 v15, v47, v47
    v_fmamk_f32 v12, v12, 0xbdd2d3e8, v1
    v_fmamk_f32 v13, v13, 0xbdd2d3e8, v1
    v_fmamk_f32 v14, v14, 0xbdd2d3e8, v1
    v_fmamk_f32 v15, v15, 0xbdd2d3e8, v1
    v_mul_f32 v12, v12, v44
    v_mul_f32 v13, v13, v45
    v_mul_f32 v14, v14, v46
    v_mul_f32 v15, v15, v47
    v_exp_f32 v12, v12
    v_exp_f32 v13, v13
    v_exp_f32 v14, v14
    v_exp_f32 v15, v15
    v_add_f32 v12, 1.0, v12
    v_add_f32 v13, 1.0, v13
    v_add_f32 v14, 1.0, v14
    v_add_f32 v15, 1.0, v15
    s_setprio 0
    ds_read_b64_tr_b16 v[104:105], v2 offset:40960
    s_waitcnt lgkmcnt(6)
    v_mfma_f32_16x16x32_bf16 v[68:71], v[24:27], v[216:219], v[68:71]
    ds_read_b64_tr_b16 v[106:107], v2 offset:41472
    s_add_u32 m0, s78, 16384
    v_mfma_f32_16x16x32_bf16 v[68:71], v[28:31], v[220:223], v[68:71]
    ds_read_b64_tr_b16 v[108:109], v2 offset:45056
    v_mfma_f32_16x16x32_bf16 v[64:67], v[24:27], v[144:147], v[64:67]
    ds_read_b64_tr_b16 v[110:111], v2 offset:45568
    s_add_u32 s81, s81, 1
    v_mfma_f32_16x16x32_bf16 v[64:67], v[28:31], v[148:151], v[64:67]
    ds_read_b64_tr_b16 v[24:25], v2 offset:49152
    s_waitcnt lgkmcnt(6)
    v_mfma_f32_16x16x32_bf16 v[64:67], v[32:35], v[152:155], v[64:67]
    ds_read_b64_tr_b16 v[26:27], v2 offset:49664
    v_mfma_f32_16x16x32_bf16 v[64:67], v[36:39], v[156:159], v[64:67]
    ds_read_b64_tr_b16 v[28:29], v2 offset:53248
    s_cmp_eq_u32 s81, 9
    v_mfma_f32_16x16x32_bf16 v[68:71], v[32:35], v[224:227], v[68:71]
    ds_read_b64_tr_b16 v[30:31], v2 offset:53760
    v_mfma_f32_16x16x32_bf16 v[68:71], v[36:39], v[228:231], v[68:71]
    ds_read_b64_tr_b16 v[32:33], v2 offset:57344
    s_waitcnt lgkmcnt(5)
    v_mfma_f32_16x16x32_bf16 v[56:59], v[104:107], v[160:163], v[56:59]
    ds_read_b64_tr_b16 v[34:35], v2 offset:57856
    global_load_lds_dwordx4 v[16:17], off
    v_mfma_f32_16x16x32_bf16 v[56:59], v[108:111], v[164:167], v[56:59]
    ds_read_b64_tr_b16 v[36:37], v2 offset:61440
    v_mfma_f32_16x16x32_bf16 v[60:63], v[104:107], v[232:235], v[60:63]
    ds_read_b64_tr_b16 v[38:39], v2 offset:61952
    s_cselect_b32 s90, -8, 1
    v_mfma_f32_16x16x32_bf16 v[60:63], v[108:111], v[236:239], v[60:63]
    ds_read_b64_tr_b16 v[104:105], v3 offset:40960
    s_waitcnt lgkmcnt(5)
    v_mfma_f32_16x16x32_bf16 v[60:63], v[24:27], v[240:243], v[60:63]
    ds_read_b64_tr_b16 v[106:107], v3 offset:41472
    v_mfma_f32_16x16x32_bf16 v[60:63], v[28:31], v[244:247], v[60:63]
    ds_read_b64_tr_b16 v[108:109], v3 offset:45056
    s_cselect_b32 s81, 0, s81
    v_mfma_f32_16x16x32_bf16 v[56:59], v[24:27], v[168:171], v[56:59]
    ds_read_b64_tr_b16 v[110:111], v3 offset:45568
    v_mfma_f32_16x16x32_bf16 v[56:59], v[28:31], v[172:175], v[56:59]
    ds_read_b64_tr_b16 v[24:25], v3 offset:49152
    s_waitcnt lgkmcnt(5)
    v_mfma_f32_16x16x32_bf16 v[56:59], v[32:35], v[176:179], v[56:59]
    ds_read_b64_tr_b16 v[26:27], v3 offset:49664
    v_mad_i64_i32 v[16:17], vcc, v18, s90, v[16:17]
    v_mfma_f32_16x16x32_bf16 v[56:59], v[36:39], v[180:183], v[56:59]
    ds_read_b64_tr_b16 v[28:29], v3 offset:53248
    v_mfma_f32_16x16x32_bf16 v[60:63], v[32:35], v[248:251], v[60:63]
    ds_read_b64_tr_b16 v[30:31], v3 offset:53760
    v_mfma_f32_16x16x32_bf16 v[60:63], v[36:39], v[252:255], v[60:63]
    ds_read_b64_tr_b16 v[32:33], v3 offset:57344
    s_waitcnt lgkmcnt(5)
    v_mfma_f32_16x16x32_bf16 v[64:67], v[104:107], v[160:163], v[64:67]
    ds_read_b64_tr_b16 v[34:35], v3 offset:57856
    s_setprio 1
    v_mfma_f32_16x16x32_bf16 v[64:67], v[108:111], v[164:167], v[64:67]
    s_waitcnt vmcnt(6)
    s_barrier
    ds_read_b64_tr_b16 v[36:37], v3 offset:61440
    v_mfma_f32_16x16x32_bf16 v[68:71], v[104:107], v[232:235], v[68:71]
    ds_read_b64_tr_b16 v[38:39], v3 offset:61952
    v_mfma_f32_16x16x32_bf16 v[68:71], v[108:111], v[236:239], v[68:71]
    s_add_u32 m0, s78, 24576
    s_add_u32 s81, s81, 1
    s_cmp_eq_u32 s81, 9
    global_load_lds_dwordx4 v[16:17], off
    s_cselect_b32 s90, -8, 1
    s_cselect_b32 s81, 0, s81
    v_mad_i64_i32 v[16:17], vcc, v18, s90, v[16:17]
    v_rcp_f32 v12, v12
    v_rcp_f32 v13, v13
    v_rcp_f32 v14, v14
    v_rcp_f32 v15, v15
    v_mul_f32 v12, v12, v44
    v_mul_f32 v13, v13, v45
    v_mul_f32 v14, v14, v46
    v_mul_f32 v15, v15, v47
    v_cvt_pk_bf16_f32 v92, v12, v13
    v_cvt_pk_bf16_f32 v93, v14, v15
    s_add_u32 m0, s78, 32768
    s_add_u32 s81, s81, 1
    s_cmp_eq_u32 s81, 9
    global_load_lds_dwordx4 v[16:17], off
    s_cselect_b32 s90, -8, 1
    s_cselect_b32 s81, 0, s81
    v_mad_i64_i32 v[16:17], vcc, v18, s90, v[16:17]
    v_mul_f32 v12, v52, v52
    v_mul_f32 v13, v53, v53
    v_mul_f32 v14, v54, v54
    v_mul_f32 v15, v55, v55
    v_fmamk_f32 v12, v12, 0xbdd2d3e8, v1
    v_fmamk_f32 v13, v13, 0xbdd2d3e8, v1
    v_fmamk_f32 v14, v14, 0xbdd2d3e8, v1
    v_fmamk_f32 v15, v15, 0xbdd2d3e8, v1
    v_mul_f32 v12, v12, v52
    v_mul_f32 v13, v13, v53
    v_mul_f32 v14, v14, v54
    v_mul_f32 v15, v15, v55
    v_exp_f32 v12, v12
    v_exp_f32 v13, v13
    v_exp_f32 v14, v14
    v_exp_f32 v15, v15
    v_add_f32 v12, 1.0, v12
    v_add_f32 v13, 1.0, v13
    v_add_f32 v14, 1.0, v14
    v_add_f32 v15, 1.0, v15
    v_rcp_f32 v12, v12
    v_rcp_f32 v13, v13
    v_rcp_f32 v14, v14
    v_rcp_f32 v15, v15
    v_mul_f32 v12, v12, v52
    v_mul_f32 v13, v13, v53
    v_mul_f32 v14, v14, v54
    v_mul_f32 v15, v15, v55
    v_cvt_pk_bf16_f32 v94, v12, v13
    v_cvt_pk_bf16_f32 v95, v14, v15
    ds_write_b128 v21, v[92:95] offset:12288
    v_add_u32 v8, 0x10000, v8
    s_setprio 0
    ds_read_b64_tr_b16 v[104:105], v8
    s_waitcnt lgkmcnt(6)
    v_mfma_f32_16x16x32_bf16 v[68:71], v[24:27], v[240:243], v[68:71]
    ds_read_b64_tr_b16 v[106:107], v8 offset:256
    s_add_u32 m0, s78, 40960
    v_mfma_f32_16x16x32_bf16 v[68:71], v[28:31], v[244:247], v[68:71]
    ds_read_b64_tr_b16 v[108:109], v8 offset:2048
    s_add_u32 s81, s81, 1
    v_mfma_f32_16x16x32_bf16 v[64:67], v[24:27], v[168:171], v[64:67]
    ds_read_b64_tr_b16 v[110:111], v8 offset:2304
    s_cmp_eq_u32 s81, 9
    v_mfma_f32_16x16x32_bf16 v[64:67], v[28:31], v[172:175], v[64:67]
    ds_read_b64_tr_b16 v[24:25], v8 offset:4096
    s_waitcnt lgkmcnt(6)
    v_mfma_f32_16x16x32_bf16 v[64:67], v[32:35], v[176:179], v[64:67]
    ds_read_b64_tr_b16 v[26:27], v8 offset:4352
    global_load_lds_dwordx4 v[16:17], off
    v_mfma_f32_16x16x32_bf16 v[64:67], v[36:39], v[180:183], v[64:67]
    ds_read_b64_tr_b16 v[28:29], v8 offset:6144
    v_mfma_f32_16x16x32_bf16 v[68:71], v[32:35], v[248:251], v[68:71]
    ds_read_b64_tr_b16 v[30:31], v8 offset:6400
    s_cselect_b32 s90, -8, 1
    v_mfma_f32_16x16x32_bf16 v[68:71], v[36:39], v[252:255], v[68:71]
    ds_read_b64_tr_b16 v[32:33], v8 offset:8192
    s_waitcnt lgkmcnt(5)
    v_mfma_f32_16x16x32_bf16 v[44:47], v[104:107], v[184:187], v[40:43]
    ds_read_b64_tr_b16 v[34:35], v8 offset:8448
    s_cselect_b32 s81, 0, s81
    v_mfma_f32_16x16x32_bf16 v[44:47], v[108:111], v[188:191], v[44:47]
    ds_read_b64_tr_b16 v[36:37], v8 offset:10240
    v_mad_i64_i32 v[16:17], vcc, v18, s90, v[16:17]
    v_mfma_f32_16x16x32_bf16 v[40:43], v[104:107], v[112:115], v[40:43]
    ds_read_b64_tr_b16 v[38:39], v8 offset:10496
    v_mfma_f32_16x16x32_bf16 v[40:43], v[108:111], v[116:119], v[40:43]
    ds_read_b64_tr_b16 v[104:105], v8 offset:12288
    s_waitcnt lgkmcnt(5)
    v_mfma_f32_16x16x32_bf16 v[40:43], v[24:27], v[120:123], v[40:43]
    ds_read_b64_tr_b16 v[106:107], v8 offset:12544
    s_setprio 1
    v_mfma_f32_16x16x32_bf16 v[40:43], v[28:31], v[124:127], v[40:43]
    s_waitcnt vmcnt(6)
    s_barrier
    ds_read_b64_tr_b16 v[108:109], v8 offset:14336
    v_mfma_f32_16x16x32_bf16 v[44:47], v[24:27], v[192:195], v[44:47]
    ds_read_b64_tr_b16 v[110:111], v8 offset:14592
    v_mfma_f32_16x16x32_bf16 v[44:47], v[28:31], v[196:199], v[44:47]
    s_add_u32 m0, s78, 49152
    s_add_u32 s81, s81, 1
    s_cmp_eq_u32 s81, 9
    global_load_lds_dwordx4 v[16:17], off
    s_cselect_b32 s90, -8, 1
    s_cselect_b32 s81, 0, s81
    v_mad_i64_i32 v[16:17], vcc, v18, s90, v[16:17]
    v_mul_f32 v12, v56, v56
    v_mul_f32 v13, v57, v57
    v_mul_f32 v14, v58, v58
    v_mul_f32 v15, v59, v59
    v_fmamk_f32 v12, v12, 0xbdd2d3e8, v1
    v_fmamk_f32 v13, v13, 0xbdd2d3e8, v1
    v_fmamk_f32 v14, v14, 0xbdd2d3e8, v1
    s_add_u32 m0, s78, 57344
    s_add_u32 s81, s81, 1
    s_cmp_eq_u32 s81, 9
    global_load_lds_dwordx4 v[16:17], off
    s_cselect_b32 s90, -8, 1
    s_cselect_b32 s81, 0, s81
    v_mad_i64_i32 v[16:17], vcc, v18, s90, v[16:17]
    v_fmamk_f32 v15, v15, 0xbdd2d3e8, v1
    v_mul_f32 v12, v12, v56
    v_mul_f32 v13, v13, v57
    v_mul_f32 v14, v14, v58
    v_mul_f32 v15, v15, v59
    v_exp_f32 v12, v12
    v_exp_f32 v13, v13
    v_exp_f32 v14, v14
    v_exp_f32 v15, v15
    v_add_f32 v12, 1.0, v12
    v_add_f32 v13, 1.0, v13
    v_add_f32 v14, 1.0, v14
    v_add_f32 v15, 1.0, v15
    v_rcp_f32 v12, v12
    v_rcp_f32 v13, v13
    v_rcp_f32 v14, v14
    v_rcp_f32 v15, v15
    v_mul_f32 v12, v12, v56
    v_mul_f32 v13, v13, v57
    v_mul_f32 v14, v14, v58
    v_mul_f32 v15, v15, v59
    v_cvt_pk_bf16_f32 v96, v12, v13
    v_cvt_pk_bf16_f32 v97, v14, v15
    s_setprio 0
    ds_read_b64_tr_b16 v[24:25], v8 offset:24576
    s_waitcnt lgkmcnt(5)
    v_mfma_f32_16x16x32_bf16 v[44:47], v[32:35], v[200:203], v[44:47]
    ds_read_b64_tr_b16 v[26:27], v8 offset:24832
    s_add_u32 m0, s78, 65536
    v_mfma_f32_16x16x32_bf16 v[44:47], v[36:39], v[204:207], v[44:47]
    ds_read_b64_tr_b16 v[28:29], v8 offset:26624
    v_mfma_f32_16x16x32_bf16 v[40:43], v[32:35], v[128:131], v[40:43]
    ds_read_b64_tr_b16 v[30:31], v8 offset:26880
    v_mfma_f32_16x16x32_bf16 v[40:43], v[36:39], v[132:135], v[40:43]
    ds_read_b64_tr_b16 v[32:33], v8 offset:28672
    s_waitcnt lgkmcnt(5)
    v_mfma_f32_16x16x32_bf16 v[40:43], v[104:107], v[136:139], v[40:43]
    ds_read_b64_tr_b16 v[34:35], v8 offset:28928
    v_mfma_f32_16x16x32_bf16 v[40:43], v[108:111], v[140:143], v[40:43]
    ds_read_b64_tr_b16 v[36:37], v8 offset:30720
    v_mfma_f32_16x16x32_bf16 v[44:47], v[104:107], v[208:211], v[44:47]
    ds_read_b64_tr_b16 v[38:39], v8 offset:30976
    v_mfma_f32_16x16x32_bf16 v[44:47], v[108:111], v[212:215], v[44:47]
    ds_read_b64_tr_b16 v[104:105], v8 offset:32768
    s_waitcnt lgkmcnt(5)
    v_mfma_f32_16x16x32_bf16 v[44:47], v[24:27], v[216:219], v[44:47]
    ds_read_b64_tr_b16 v[106:107], v8 offset:33024
    global_load_lds_dwordx4 v[16:17], off
    v_mfma_f32_16x16x32_bf16 v[44:47], v[28:31], v[220:223], v[44:47]
    ds_read_b64_tr_b16 v[108:109], v8 offset:34816
    v_mfma_f32_16x16x32_bf16 v[40:43], v[24:27], v[144:147], v[40:43]
    ds_read_b64_tr_b16 v[110:111], v8 offset:35072
    v_mfma_f32_16x16x32_bf16 v[40:43], v[28:31], v[148:151], v[40:43]
    ds_read_b64_tr_b16 v[24:25], v8 offset:36864
    s_waitcnt lgkmcnt(5)
    v_mfma_f32_16x16x32_bf16 v[40:43], v[32:35], v[152:155], v[40:43]
    ds_read_b64_tr_b16 v[26:27], v8 offset:37120
    v_mfma_f32_16x16x32_bf16 v[40:43], v[36:39], v[156:159], v[40:43]
    ds_read_b64_tr_b16 v[28:29], v8 offset:38912
    v_mfma_f32_16x16x32_bf16 v[44:47], v[32:35], v[224:227], v[44:47]
    ds_read_b64_tr_b16 v[30:31], v8 offset:39168
    v_mfma_f32_16x16x32_bf16 v[44:47], v[36:39], v[228:231], v[44:47]
    ds_read_b64_tr_b16 v[32:33], v8 offset:16384
    s_waitcnt lgkmcnt(5)
    v_mfma_f32_16x16x32_bf16 v[44:47], v[104:107], v[232:235], v[44:47]
    ds_read_b64_tr_b16 v[34:35], v8 offset:16640
    s_setprio 1
    v_mfma_f32_16x16x32_bf16 v[44:47], v[108:111], v[236:239], v[44:47]
    s_waitcnt vmcnt(6)
    s_barrier
    ds_read_b64_tr_b16 v[36:37], v8 offset:18432
    v_mfma_f32_16x16x32_bf16 v[40:43], v[104:107], v[160:163], v[40:43]
    ds_read_b64_tr_b16 v[38:39], v8 offset:18688
    v_mfma_f32_16x16x32_bf16 v[40:43], v[108:111], v[164:167], v[40:43]
    s_add_u32 m0, s78, 73728
    s_add_u32 s90, s82, 37888
    buffer_load_dwordx4 v20, s[40:43], s90 offen  lds
    v_mul_f32 v12, v64, v64
    v_mul_f32 v13, v65, v65
    v_mul_f32 v14, v66, v66
    v_mul_f32 v15, v67, v67
    v_fmamk_f32 v12, v12, 0xbdd2d3e8, v1
    s_add_u32 m0, s78, 77824
    s_add_u32 s90, s82, 74752
    buffer_load_dwordx4 v20, s[40:43], s90 offen  lds
    v_fmamk_f32 v13, v13, 0xbdd2d3e8, v1
    v_fmamk_f32 v14, v14, 0xbdd2d3e8, v1
    v_fmamk_f32 v15, v15, 0xbdd2d3e8, v1
    v_mul_f32 v12, v12, v64
    v_mul_f32 v13, v13, v65
    s_add_u32 m0, s78, 90112
    s_add_u32 s90, s82, 111616
    buffer_load_dwordx4 v20, s[40:43], s90 offen  lds
    v_mul_f32 v14, v14, v66
    v_mul_f32 v15, v15, v67
    v_exp_f32 v12, v12
    v_exp_f32 v13, v13
    v_exp_f32 v14, v14
    v_exp_f32 v15, v15
    v_add_f32 v12, 1.0, v12
    v_add_f32 v13, 1.0, v13
    v_add_f32 v14, 1.0, v14
    v_add_f32 v15, 1.0, v15
    v_rcp_f32 v12, v12
    v_rcp_f32 v13, v13
    v_rcp_f32 v14, v14
    v_rcp_f32 v15, v15
    v_mul_f32 v12, v12, v64
    v_mul_f32 v13, v13, v65
    v_mul_f32 v14, v14, v66
    v_mul_f32 v15, v15, v67
    v_cvt_pk_bf16_f32 v98, v12, v13
    v_cvt_pk_bf16_f32 v99, v14, v15
    v_add_u32 v10, 0x15000, v10
    v_add_u32 v9, 0x15000, v9
    s_setprio 0
    ds_read_b64_tr_b16 v[104:105], v9
    s_waitcnt lgkmcnt(5)
    v_mfma_f32_16x16x32_bf16 v[40:43], v[24:27], v[168:171], v[40:43]
    ds_read_b64_tr_b16 v[106:107], v9 offset:512
    v_mfma_f32_16x16x32_bf16 v[40:43], v[28:31], v[172:175], v[40:43]
    v_add_u32 v9, 0xfffeb000, v9
    ds_read_b64_tr_b16 v[108:109], v9
    v_mfma_f32_16x16x32_bf16 v[44:47], v[24:27], v[240:243], v[44:47]
    ds_read_b64_tr_b16 v[110:111], v9 offset:512
    v_mfma_f32_16x16x32_bf16 v[44:47], v[28:31], v[244:247], v[44:47]
    ds_read_b64_tr_b16 v[24:25], v10
    s_waitcnt lgkmcnt(5)
    v_mfma_f32_16x16x32_bf16 v[44:47], v[32:35], v[248:251], v[44:47]
    ds_read_b64_tr_b16 v[26:27], v10 offset:512
    v_mfma_f32_16x16x32_bf16 v[44:47], v[36:39], v[252:255], v[44:47]
    v_add_u32 v10, 0xfffeb000, v10
    ds_read_b64_tr_b16 v[28:29], v10
    v_mfma_f32_16x16x32_bf16 v[40:43], v[32:35], v[176:179], v[40:43]
    ds_read_b64_tr_b16 v[30:31], v10 offset:512
    v_mfma_f32_16x16x32_bf16 v[40:43], v[36:39], v[180:183], v[40:43]
    ds_read_b64_tr_b16 v[32:33], v9 offset:4096
    s_waitcnt lgkmcnt(5)
    v_mfma_f32_16x16x32_bf16 v[48:51], v[104:107], v[112:115], 0
    ds_read_b64_tr_b16 v[34:35], v9 offset:4608
    v_mfma_f32_16x16x32_bf16 v[48:51], v[108:111], v[116:119], v[48:51]
    ds_read_b64_tr_b16 v[36:37], v9 offset:8192
    v_mfma_f32_16x16x32_bf16 v[52:55], v[104:107], v[184:187], 0
    ds_read_b64_tr_b16 v[38:39], v9 offset:8704
    v_mfma_f32_16x16x32_bf16 v[52:55], v[108:111], v[188:191], v[52:55]
    ds_read_b64_tr_b16 v[104:105], v10 offset:4096
    s_waitcnt lgkmcnt(5)
    v_mfma_f32_16x16x32_bf16 v[56:59], v[24:27], v[112:115], 0
    ds_read_b64_tr_b16 v[106:107], v10 offset:4608
    ds_read_b64_tr_b16 v[108:109], v10 offset:8192
    v_mfma_f32_16x16x32_bf16 v[56:59], v[28:31], v[116:119], v[56:59]
    ds_read_b64_tr_b16 v[110:111], v10 offset:8704
    ds_read_b64_tr_b16 v[24:25], v9 offset:12288
    s_waitcnt lgkmcnt(5)
    v_mfma_f32_16x16x32_bf16 v[48:51], v[32:35], v[120:123], v[48:51]
    ds_read_b64_tr_b16 v[26:27], v9 offset:12800
    v_mfma_f32_16x16x32_bf16 v[48:51], v[36:39], v[124:127], v[48:51]
    ds_read_b64_tr_b16 v[28:29], v9 offset:16384
    v_mfma_f32_16x16x32_bf16 v[52:55], v[32:35], v[192:195], v[52:55]
    ds_read_b64_tr_b16 v[30:31], v9 offset:16896
    s_setprio 1
    v_mfma_f32_16x16x32_bf16 v[52:55], v[36:39], v[196:199], v[52:55]
    s_waitcnt vmcnt(6)
    s_barrier
    ds_read_b64_tr_b16 v[32:33], v10 offset:12288
    ds_read_b64_tr_b16 v[34:35], v10 offset:12800
    s_waitcnt lgkmcnt(6)
    v_mfma_f32_16x16x32_bf16 v[56:59], v[104:107], v[120:123], v[56:59]
    ds_read_b64_tr_b16 v[36:37], v10 offset:16384
    ds_read_b64_tr_b16 v[38:39], v10 offset:16896
    v_mfma_f32_16x16x32_bf16 v[56:59], v[108:111], v[124:127], v[56:59]
    s_add_u32 m0, s78, 102400
    s_add_u32 s90, s82, 0
    buffer_load_dwordx4 v20, s[40:43], s90 offen  lds
    v_mul_f32 v12, v60, v60
    v_mul_f32 v13, v61, v61
    v_mul_f32 v14, v62, v62
    v_mul_f32 v15, v63, v63
    v_fmamk_f32 v12, v12, 0xbdd2d3e8, v1
    v_fmamk_f32 v13, v13, 0xbdd2d3e8, v1
    v_fmamk_f32 v14, v14, 0xbdd2d3e8, v1
    s_add_u32 m0, s78, 0
    s_add_u32 s90, s82, 36864
    buffer_load_dwordx4 v20, s[40:43], s90 offen  lds
    v_fmamk_f32 v15, v15, 0xbdd2d3e8, v1
    v_mul_f32 v12, v12, v60
    v_mul_f32 v13, v13, v61
    v_mul_f32 v14, v14, v62
    v_mul_f32 v15, v15, v63
    v_exp_f32 v12, v12
    v_exp_f32 v13, v13
    v_exp_f32 v14, v14
    v_exp_f32 v15, v15
    v_add_f32 v12, 1.0, v12
    v_add_f32 v13, 1.0, v13
    v_add_f32 v14, 1.0, v14
    v_add_f32 v15, 1.0, v15
    v_rcp_f32 v12, v12
    v_rcp_f32 v13, v13
    v_rcp_f32 v14, v14
    v_rcp_f32 v15, v15
    v_mul_f32 v12, v12, v60
    v_mul_f32 v13, v13, v61
    v_mul_f32 v14, v14, v62
    v_mul_f32 v15, v15, v63
    v_cvt_pk_bf16_f32 v100, v12, v13
    v_cvt_pk_bf16_f32 v101, v14, v15
    s_setprio 0
    ds_read_b64_tr_b16 v[124:125], v9 offset:20480
    ds_read_b64_tr_b16 v[126:127], v9 offset:20992
    s_waitcnt lgkmcnt(6)
    v_mfma_f32_16x16x32_bf16 v[48:51], v[24:27], v[128:131], v[48:51]
    ds_read_b64_tr_b16 v[196:197], v9 offset:24576
    ds_read_b128 v[112:115], v21 offset:40960
    v_mfma_f32_16x16x32_bf16 v[48:51], v[28:31], v[132:135], v[48:51]
    ds_read_b64_tr_b16 v[198:199], v9 offset:25088
    ds_read_b128 v[184:187], v21 offset:32768
    v_mfma_f32_16x16x32_bf16 v[52:55], v[24:27], v[200:203], v[52:55]
    ds_read_b128 v[116:119], v21 offset:24576
    v_mfma_f32_16x16x32_bf16 v[52:55], v[28:31], v[204:207], v[52:55]
    ds_read_b64_tr_b16 v[24:25], v10 offset:20480
    s_waitcnt lgkmcnt(8)
    v_mfma_f32_16x16x32_bf16 v[56:59], v[32:35], v[128:131], v[56:59]
    ds_read_b64_tr_b16 v[26:27], v10 offset:20992
    ds_read_b64_tr_b16 v[28:29], v10 offset:24576
    v_mfma_f32_16x16x32_bf16 v[56:59], v[36:39], v[132:135], v[56:59]
    ds_read_b64_tr_b16 v[30:31], v10 offset:25088
    ds_read_b64_tr_b16 v[32:33], v9 offset:28672
    s_waitcnt lgkmcnt(7)
    v_mfma_f32_16x16x32_bf16 v[48:51], v[124:127], v[136:139], v[48:51]
    ds_read_b64_tr_b16 v[34:35], v9 offset:29184
    v_mfma_f32_16x16x32_bf16 v[48:51], v[196:199], v[140:143], v[48:51]
    ds_read_b64_tr_b16 v[36:37], v9 offset:32768
    ds_read_b128 v[188:191], v21 offset:16384
    v_mfma_f32_16x16x32_bf16 v[52:55], v[124:127], v[208:211], v[52:55]
    ds_read_b64_tr_b16 v[38:39], v9 offset:33280
    ds_read_b128 v[120:123], v21 offset:8192
    v_mfma_f32_16x16x32_bf16 v[52:55], v[196:199], v[212:215], v[52:55]
    ds_read_b64_tr_b16 v[124:125], v10 offset:28672
    s_waitcnt lgkmcnt(7)
    v_mfma_f32_16x16x32_bf16 v[56:59], v[24:27], v[136:139], v[56:59]
    ds_read_b64_tr_b16 v[126:127], v10 offset:29184
    ds_read_b64_tr_b16 v[196:197], v10 offset:32768
    v_mfma_f32_16x16x32_bf16 v[56:59], v[28:31], v[140:143], v[56:59]
    ds_read_b64_tr_b16 v[198:199], v10 offset:33280
    ds_read_b64_tr_b16 v[24:25], v9 offset:36864
    s_waitcnt lgkmcnt(6)
    v_mfma_f32_16x16x32_bf16 v[48:51], v[32:35], v[144:147], v[48:51]
    ds_read_b64_tr_b16 v[26:27], v9 offset:37376
    ds_read_b128 v[192:195], v21
    v_mfma_f32_16x16x32_bf16 v[48:51], v[36:39], v[148:151], v[48:51]
    ds_read_b64_tr_b16 v[28:29], v9 offset:40960
    v_mfma_f32_16x16x32_bf16 v[52:55], v[32:35], v[216:219], v[52:55]
    ds_read_b64_tr_b16 v[30:31], v9 offset:41472
    s_setprio 1
    v_mfma_f32_16x16x32_bf16 v[52:55], v[36:39], v[220:223], v[52:55]
    s_waitcnt vmcnt(5) lgkmcnt(2)
    s_barrier
    ds_read_b64_tr_b16 v[32:33], v10 offset:36864
    ds_read_b64_tr_b16 v[34:35], v10 offset:37376
    v_mfma_f32_16x16x32_bf16 v[56:59], v[124:127], v[144:147], v[56:59]
    ds_read_b64_tr_b16 v[36:37], v10 offset:40960
    ds_read_b64_tr_b16 v[38:39], v10 offset:41472
    v_mfma_f32_16x16x32_bf16 v[56:59], v[196:199], v[148:151], v[56:59]
    s_add_u32 m0, s78, 106496
    s_add_u32 s90, s82, 147456
    buffer_load_dwordx4 v20, s[40:43], s90 offen  lds
    v_mul_f32 v12, v68, v68
    v_mul_f32 v13, v69, v69
    v_mul_f32 v14, v70, v70
    v_mul_f32 v15, v71, v71
    v_fmamk_f32 v12, v12, 0xbdd2d3e8, v1
    s_add_u32 m0, s78, 110592
    s_add_u32 s90, s82, 184320
    buffer_load_dwordx4 v20, s[40:43], s90 offen  lds
    v_fmamk_f32 v13, v13, 0xbdd2d3e8, v1
    v_fmamk_f32 v14, v14, 0xbdd2d3e8, v1
    v_fmamk_f32 v15, v15, 0xbdd2d3e8, v1
    v_mul_f32 v12, v12, v68
    v_mul_f32 v13, v13, v69
    s_add_u32 m0, s78, 114688
    s_add_u32 s90, s82, 222208
    buffer_load_dwordx4 v20, s[40:43], s90 offen  lds
    v_mul_f32 v14, v14, v70
    v_mul_f32 v15, v15, v71
    v_exp_f32 v12, v12
    v_exp_f32 v13, v13
    v_exp_f32 v14, v14
    v_exp_f32 v15, v15
    v_add_f32 v12, 1.0, v12
    v_add_f32 v13, 1.0, v13
    v_add_f32 v14, 1.0, v14
    v_add_f32 v15, 1.0, v15
    v_rcp_f32 v12, v12
    v_rcp_f32 v13, v13
    v_rcp_f32 v14, v14
    v_rcp_f32 v15, v15
    v_mul_f32 v12, v12, v68
    v_mul_f32 v13, v13, v69
    v_mul_f32 v14, v14, v70
    v_mul_f32 v15, v15, v71
    v_cvt_pk_bf16_f32 v102, v12, v13
    v_cvt_pk_bf16_f32 v103, v14, v15
    v_add_u32 v10, 0xb000, v10
    v_add_u32 v9, 0xb000, v9
    s_setprio 0
    ds_read_b64_tr_b16 v[136:137], v9
    ds_read_b64_tr_b16 v[138:139], v9 offset:512
    s_waitcnt lgkmcnt(6)
    v_mfma_f32_16x16x32_bf16 v[48:51], v[24:27], v[152:155], v[48:51]
    ds_read_b64_tr_b16 v[140:141], v9 offset:4096
    v_mfma_f32_16x16x32_bf16 v[48:51], v[28:31], v[156:159], v[48:51]
    ds_read_b64_tr_b16 v[142:143], v9 offset:4608
    v_mfma_f32_16x16x32_bf16 v[52:55], v[24:27], v[224:227], v[52:55]
    v_mfma_f32_16x16x32_bf16 v[52:55], v[28:31], v[228:231], v[52:55]
    ds_read_b64_tr_b16 v[24:25], v10
    s_waitcnt lgkmcnt(5)
    v_mfma_f32_16x16x32_bf16 v[56:59], v[32:35], v[152:155], v[56:59]
    ds_read_b64_tr_b16 v[26:27], v10 offset:512
    ds_read_b64_tr_b16 v[28:29], v10 offset:4096
    v_mfma_f32_16x16x32_bf16 v[56:59], v[36:39], v[156:159], v[56:59]
    ds_read_b64_tr_b16 v[30:31], v10 offset:4608
    ds_read_b64_tr_b16 v[32:33], v9 offset:8192
    s_waitcnt lgkmcnt(5)
    v_mfma_f32_16x16x32_bf16 v[48:51], v[136:139], v[160:163], v[48:51]
    ds_read_b64_tr_b16 v[34:35], v9 offset:8704
    v_mfma_f32_16x16x32_bf16 v[48:51], v[140:143], v[164:167], v[48:51]
    ds_read_b64_tr_b16 v[36:37], v9 offset:12288
    v_mfma_f32_16x16x32_bf16 v[52:55], v[136:139], v[232:235], v[52:55]
    ds_read_b64_tr_b16 v[38:39], v9 offset:12800
    v_mfma_f32_16x16x32_bf16 v[52:55], v[140:143], v[236:239], v[52:55]
    ds_read_b64_tr_b16 v[136:137], v10 offset:8192
    s_waitcnt lgkmcnt(5)
    v_mfma_f32_16x16x32_bf16 v[56:59], v[24:27], v[160:163], v[56:59]
    ds_read_b64_tr_b16 v[138:139], v10 offset:8704
    ds_read_b64_tr_b16 v[140:141], v10 offset:12288
    v_mfma_f32_16x16x32_bf16 v[56:59], v[28:31], v[164:167], v[56:59]
    ds_read_b64_tr_b16 v[142:143], v10 offset:12800
    ds_read_b64_tr_b16 v[24:25], v9 offset:16384
    s_waitcnt lgkmcnt(5)
    v_mfma_f32_16x16x32_bf16 v[48:51], v[32:35], v[168:171], v[48:51]
    ds_read_b64_tr_b16 v[26:27], v9 offset:16896
    v_mfma_f32_16x16x32_bf16 v[48:51], v[36:39], v[172:175], v[48:51]
    ds_read_b64_tr_b16 v[28:29], v9 offset:20480
    v_mfma_f32_16x16x32_bf16 v[52:55], v[32:35], v[240:243], v[52:55]
    ds_read_b64_tr_b16 v[30:31], v9 offset:20992
    s_setprio 1
    v_mfma_f32_16x16x32_bf16 v[52:55], v[36:39], v[244:247], v[52:55]
L_page4:
    s_cbranch_execz L_probed
    s_waitcnt vmcnt(3)
    s_barrier
    ds_read_b64_tr_b16 v[32:33], v10 offset:16384
    s_waitcnt lgkmcnt(5)
    v_mfma_f32_16x16x32_bf16 v[56:59], v[136:139], v[168:171], v[56:59]
    ds_read_b64_tr_b16 v[34:35], v10 offset:16896
    ds_read_b64_tr_b16 v[36:37], v10 offset:20480
    v_mfma_f32_16x16x32_bf16 v[56:59], v[140:143], v[172:175], v[56:59]
    ds_read_b64_tr_b16 v[38:39], v10 offset:20992
    ds_write_b128 v21, v[96:99] offset:16384
    ds_write_b128 v21, v[100:103] offset:24576
    s_add_u32 m0, s78, 16384
    s_add_u32 s90, s83, 1024
    buffer_load_dwordx4 v20, s[40:43], s90 offen  lds
    v_mul_f32 v12, v40, v40
    v_mul_f32 v13, v41, v41
    v_mul_f32 v14, v42, v42
    v_mul_f32 v15, v43, v43
    v_fmamk_f32 v12, v12, 0xbdd2d3e8, v1
    s_add_u32 m0, s78, 20480
    s_add_u32 s90, s83, 0
    buffer_load_dwordx4 v20, s[40:43], s90 offen  lds
    v_fmamk_f32 v13, v13, 0xbdd2d3e8, v1
    v_fmamk_f32 v14, v14, 0xbdd2d3e8, v1
    v_fmamk_f32 v15, v15, 0xbdd2d3e8, v1
    v_mul_f32 v12, v12, v40
    v_mul_f32 v13, v13, v41
    s_add_u32 m0, s78, 24576
    s_add_u32 s90, s82, 128
    buffer_load_dwordx4 v20, s[40:43], s90 offen  lds
    v_mul_f32 v14, v14, v42
    v_mul_f32 v15, v15, v43
    v_exp_f32 v12, v12
    v_exp_f32 v13, v13
    v_exp_f32 v14, v14
    v_exp_f32 v15, v15
    s_add_u32 m0, s78, 28672
    s_add_u32 s90, s82, 36992
    buffer_load_dwordx4 v20, s[40:43], s90 offen  lds
    v_add_f32 v12, 1.0, v12
    v_add_f32 v13, 1.0, v13
    v_add_f32 v14, 1.0, v14
    v_add_f32 v15, 1.0, v15
    v_rcp_f32 v12, v12
    s_add_u32 m0, s78, 32768
    s_add_u32 s90, s82, 73856
    buffer_load_dwordx4 v20, s[40:43], s90 offen  lds
    v_rcp_f32 v13, v13
    v_rcp_f32 v14, v14
    v_rcp_f32 v15, v15
    v_mul_f32 v12, v12, v40
    v_mul_f32 v13, v13, v41
    v_mul_f32 v14, v14, v42
    v_mul_f32 v15, v15, v43
    v_cvt_pk_bf16_f32 v104, v12, v13
    v_cvt_pk_bf16_f32 v105, v14, v15
    v_mul_f32 v12, v44, v44
    v_mul_f32 v13, v45, v45
    v_mul_f32 v14, v46, v46
    v_mul_f32 v15, v47, v47
    v_fmamk_f32 v12, v12, 0xbdd2d3e8, v1
    v_fmamk_f32 v13, v13, 0xbdd2d3e8, v1
    v_fmamk_f32 v14, v14, 0xbdd2d3e8, v1
    v_fmamk_f32 v15, v15, 0xbdd2d3e8, v1
    v_mul_f32 v12, v12, v44
    v_mul_f32 v13, v13, v45
    v_mul_f32 v14, v14, v46
    v_mul_f32 v15, v15, v47
    v_exp_f32 v12, v12
    v_exp_f32 v13, v13
    v_exp_f32 v14, v14
    v_exp_f32 v15, v15
    v_and_b32 v134, 0x300, v0
    v_mad_i32_i24 v128, v134, -2, v2
    v_mad_i32_i24 v129, v134, -2, v3
    v_mad_i32_i24 v130, v134, -2, v4
    v_mad_i32_i24 v131, v134, -2, v5
    v_add_u32 v132, 0x20000, v128
    v_add_u32 v133, 0x20000, v129
    s_setprio 0
    ds_read_b64_tr_b16 v[136:137], v130 offset:4096
    s_waitcnt lgkmcnt(7)
    v_mfma_f32_16x16x32_bf16 v[48:51], v[24:27], v[176:179], v[48:51]
    ds_read_b64_tr_b16 v[138:139], v130 offset:6144
    v_mfma_f32_16x16x32_bf16 v[48:51], v[28:31], v[180:183], v[48:51]
    ds_read_b64_tr_b16 v[140:141], v130 offset:8192
    v_mfma_f32_16x16x32_bf16 v[52:55], v[24:27], v[248:251], v[52:55]
    ds_read_b64_tr_b16 v[142:143], v130 offset:10240
    v_mfma_f32_16x16x32_bf16 v[52:55], v[28:31], v[252:255], v[52:55]
    ds_read_b64_tr_b16 v[24:25], v130 offset:12288
    s_waitcnt lgkmcnt(7)
    v_mfma_f32_16x16x32_bf16 v[56:59], v[32:35], v[176:179], v[56:59]
    ds_read_b64_tr_b16 v[26:27], v130 offset:14336
    ds_read_b64_tr_b16 v[28:29], v130 offset:24576
    v_mfma_f32_16x16x32_bf16 v[56:59], v[36:39], v[180:183], v[56:59]
    ds_read_b64_tr_b16 v[30:31], v130 offset:26624
    ds_read_b64_tr_b16 v[32:33], v130 offset:28672
    s_waitcnt lgkmcnt(5)
    v_mfma_f32_16x16x32_bf16 v[144:147], v[136:139], v[112:115], 0
    ds_read_b64_tr_b16 v[34:35], v130 offset:30720
    v_mfma_f32_16x16x32_bf16 v[144:147], v[140:143], v[72:75], v[144:147]
    ds_read_b64_tr_b16 v[36:37], v130 offset:32768
    v_mfma_f32_16x16x32_bf16 v[148:151], v[136:139], v[184:187], 0
    ds_read_b64_tr_b16 v[38:39], v130 offset:34816
    v_mfma_f32_16x16x32_bf16 v[148:151], v[140:143], v[76:79], v[148:151]
    ds_read_b64_tr_b16 v[136:137], v131 offset:4096
    s_waitcnt lgkmcnt(5)
    v_mfma_f32_16x16x32_bf16 v[148:151], v[24:27], v[188:191], v[148:151]
    ds_read_b64_tr_b16 v[138:139], v131 offset:6144
    v_mfma_f32_16x16x32_bf16 v[148:151], v[28:31], v[84:87], v[148:151]
    ds_read_b64_tr_b16 v[140:141], v131 offset:8192
    v_mfma_f32_16x16x32_bf16 v[144:147], v[24:27], v[116:119], v[144:147]
    ds_read_b64_tr_b16 v[142:143], v131 offset:10240
    v_mfma_f32_16x16x32_bf16 v[144:147], v[28:31], v[80:83], v[144:147]
    ds_read_b64_tr_b16 v[24:25], v131 offset:12288
    s_waitcnt lgkmcnt(5)
    v_mfma_f32_16x16x32_bf16 v[144:147], v[32:35], v[120:123], v[144:147]
    ds_read_b64_tr_b16 v[26:27], v131 offset:14336
    v_mfma_f32_16x16x32_bf16 v[144:147], v[36:39], v[88:91], v[144:147]
    ds_read_b64_tr_b16 v[28:29], v131 offset:24576
    v_mfma_f32_16x16x32_bf16 v[148:151], v[32:35], v[192:195], v[148:151]
    ds_read_b64_tr_b16 v[30:31], v131 offset:26624
    v_mfma_f32_16x16x32_bf16 v[148:151], v[36:39], v[92:95], v[148:151]
    ds_read_b64_tr_b16 v[32:33], v131 offset:28672
    s_waitcnt lgkmcnt(5)
    v_mfma_f32_16x16x32_bf16 v[152:155], v[136:139], v[112:115], 0
    ds_read_b64_tr_b16 v[34:35], v131 offset:30720
    v_mfma_f32_16x16x32_bf16 v[152:155], v[140:143], v[72:75], v[152:155]
    ds_read_b64_tr_b16 v[36:37], v131 offset:32768
    v_mfma_f32_16x16x32_bf16 v[156:159], v[136:139], v[184:187], 0
    ds_read_b64_tr_b16 v[38:39], v131 offset:34816
    v_mfma_f32_16x16x32_bf16 v[156:159], v[140:143], v[76:79], v[156:159]
    ds_read_b64_tr_b16 v[136:137], v130 offset:36864
    s_waitcnt lgkmcnt(5)
    v_mfma_f32_16x16x32_bf16 v[156:159], v[24:27], v[188:191], v[156:159]
    ds_read_b64_tr_b16 v[138:139], v130 offset:38912
    v_mfma_f32_16x16x32_bf16 v[156:159], v[28:31], v[84:87], v[156:159]
    ds_read_b64_tr_b16 v[140:141], v128
    v_mfma_f32_16x16x32_bf16 v[152:155], v[24:27], v[116:119], v[152:155]
    ds_read_b64_tr_b16 v[142:143], v128 offset:2048
    v_mfma_f32_16x16x32_bf16 v[152:155], v[28:31], v[80:83], v[152:155]
    ds_read_b64_tr_b16 v[24:25], v131 offset:36864
    s_waitcnt lgkmcnt(5)
    v_mfma_f32_16x16x32_bf16 v[152:155], v[32:35], v[120:123], v[152:155]
    ds_read_b64_tr_b16 v[26:27], v131 offset:38912
    s_setprio 1
    v_mfma_f32_16x16x32_bf16 v[152:155], v[36:39], v[88:91], v[152:155]
    s_waitcnt vmcnt(5)
    s_barrier
    ds_read_b64_tr_b16 v[28:29], v129
    v_mfma_f32_16x16x32_bf16 v[156:159], v[32:35], v[192:195], v[156:159]
    ds_read_b64_tr_b16 v[30:31], v129 offset:2048
    v_mfma_f32_16x16x32_bf16 v[156:159], v[36:39], v[92:95], v[156:159]
    v_and_b32 v64, 15, v22
    v_lshrrev_b32 v65, 4, v22
    s_mul_i32 s88, s73, 3328
    s_add_u32 s88, s88, 143360
    v_mov_b32 v67, 0x3eae1a93
    v_cmp_eq_u32 vcc, 0, v65
    v_mul_u32_u24 v66, 104, v64
    v_add_u32 v66, s88, v66
    v_cndmask_b32 v69, 1.0, v67, vcc
    v_lshl_add_u32 v68, v65, 3, v66
    v_mul_f32 v56, v56, v69
    v_mul_f32 v57, v57, v69
    v_mul_f32 v58, v58, v69
    v_mul_f32 v59, v59, v69
    v_cvt_pk_bf16_f32 v204, v56, v57
    v_cvt_pk_bf16_f32 v205, v58, v59
    ds_write_b64 v68, v[204:205] offset:1728
    s_cmp_lt_u32 s85, 4
    s_cbranch_scc0 L_skip_8
    s_cmp_ge_u32 s85, 2
    s_cbranch_scc0 L_skip_6
    v_and_b32 v69, 3, v22
    v_min_u32 v69, 2, v69
    v_lshl_add_u32 v69, v69, 3, s88
    v_bfe_u32 v70, v22, 2, 3
    v_and_b32 v200, 4, v70
    v_add_u32 v70, v70, v200
    v_mul_u32_u24 v70, 104, v70
    v_add_u32 v69, v69, v70
    ds_read_b64_tr_b16 v[200:201], v69 offset:1736
    ds_read_b64_tr_b16 v[202:203], v69 offset:2152
L_skip_6:
    s_cmp_lt_u32 s85, 2
    s_cbranch_scc0 L_skip_7
    ds_read2_b64 v[200:203], v66 offset0:217 offset1:218
    v_mov_b32 v70, 0
    s_mov_b32 exec_lo, 0xffff0000
    s_mov_b32 exec_hi, 0x0000ffff
    v_fmac_f32 v70, v56, v56
    v_fmac_f32 v70, v57, v57
    s_cmp_eq_u32 s85, 0
    s_cselect_b32 exec_hi, -1, exec_hi
    v_fmac_f32 v70, v58, v58
    v_fmac_f32 v70, v59, v59
    s_mov_b64 exec, -1
    v_mov_b32 v69, v70
    s_nop 1
    v_permlane32_swap_b32 v69, v70
    v_add_f32 v70, v69, v70
    v_mov_b32 v69, v70
    s_nop 1
    v_permlane16_swap_b32 v69, v70
    v_add_f32 v70, v69, v70
    s_nop 1
    v_max_f32_dpp v70, v70, v70 row_ror:8 row_mask:0xf bank_mask:0xf
    s_nop 1
    v_max_f32_dpp v70, v70, v70 row_ror:4 row_mask:0xf bank_mask:0xf
    s_nop 1
    v_max_f32_dpp v70, v70, v70 row_ror:2 row_mask:0xf bank_mask:0xf
    s_nop 1
    v_max_f32_dpp v70, v70, v70 row_ror:1 row_mask:0xf bank_mask:0xf
    s_lshl2_add_u32 s89, s72, 157440
    v_mov_b32 v69, s89
    ds_write_b32 v69, v70
L_skip_7:
L_skip_8:
    v_add_f32 v12, 1.0, v12
    v_add_f32 v13, 1.0, v13
    v_add_f32 v14, 1.0, v14
    v_add_f32 v15, 1.0, v15
    v_rcp_f32 v12, v12
    v_rcp_f32 v13, v13
    v_rcp_f32 v14, v14
    v_rcp_f32 v15, v15
    v_mul_f32 v12, v12, v44
    v_mul_f32 v13, v13, v45
    v_mul_f32 v14, v14, v46
    v_mul_f32 v15, v15, v47
    v_cvt_pk_bf16_f32 v108, v12, v13
    v_cvt_pk_bf16_f32 v109, v14, v15
    ds_write_b64 v21, v[104:105] offset:32768
    ds_write_b64 v21, v[108:109] offset:32776
    s_add_u32 m0, s78, 53248
    s_add_u32 s90, s82, 258176
    buffer_load_dwordx4 v20, s[40:43], s90 offen  lds
    s_add_u32 m0, s78, 57344
    s_add_u32 s90, s83, 128
    buffer_load_dwordx4 v20, s[40:43], s90 offen  lds
    s_add_u32 m0, s78, 61440
    s_add_u32 s90, s82, 256
    buffer_load_dwordx4 v20, s[40:43], s90 offen  lds
    s_add_u32 m0, s78, 65536
    s_add_u32 s90, s82, 37120
    buffer_load_dwordx4 v20, s[40:43], s90 offen  lds
    buffer_store_dword v205, v19, s[44:47], 0 offen sc1
    s_add_u32 m0, s78, 69632
    s_add_u32 s90, s82, 73984
    buffer_load_dwordx4 v20, s[40:43], s90 offen  lds
    s_waitcnt lgkmcnt(2)
    buffer_store_dwordx4 v[200:203], v11, s[44:47], 0 offen sc1
    s_and_b32 s85, s85, 3
    s_setprio 0
    ds_read_b64_tr_b16 v[32:33], v130 offset:16384
    v_mfma_f32_16x16x32_bf16 v[160:163], v[136:139], v[112:115], 0
    ds_read_b64_tr_b16 v[34:35], v130 offset:18432
    ds_read_b128 v[124:127], v21 offset:20480
    v_mfma_f32_16x16x32_bf16 v[160:163], v[140:143], v[72:75], v[160:163]
    ds_read_b64_tr_b16 v[36:37], v130 offset:20480
    ds_read_b128 v[196:199], v21 offset:12288
    v_mfma_f32_16x16x32_bf16 v[164:167], v[136:139], v[184:187], 0
    ds_read_b64_tr_b16 v[38:39], v130 offset:22528
    v_mfma_f32_16x16x32_bf16 v[164:167], v[140:143], v[76:79], v[164:167]
    ds_read_b64_tr_b16 v[136:137], v130 offset:40960
    v_mfma_f32_16x16x32_bf16 v[168:171], v[24:27], v[112:115], 0
    ds_read_b64_tr_b16 v[138:139], v130 offset:43008
    v_mfma_f32_16x16x32_bf16 v[168:171], v[28:31], v[72:75], v[168:171]
    ds_read_b64_tr_b16 v[140:141], v130 offset:45056
    v_mfma_f32_16x16x32_bf16 v[172:175], v[24:27], v[184:187], 0
    ds_read_b64_tr_b16 v[142:143], v130 offset:47104
    v_mfma_f32_16x16x32_bf16 v[172:175], v[28:31], v[76:79], v[172:175]
    ds_read_b64_tr_b16 v[24:25], v131 offset:16384
    s_waitcnt lgkmcnt(5)
    v_mfma_f32_16x16x32_bf16 v[160:163], v[32:35], v[116:119], v[160:163]
    ds_read_b64_tr_b16 v[26:27], v131 offset:18432
    v_mfma_f32_16x16x32_bf16 v[160:163], v[36:39], v[80:83], v[160:163]
    ds_read_b64_tr_b16 v[28:29], v131 offset:20480
    v_mfma_f32_16x16x32_bf16 v[164:167], v[32:35], v[188:191], v[164:167]
    ds_read_b64_tr_b16 v[30:31], v131 offset:22528
    v_mfma_f32_16x16x32_bf16 v[164:167], v[36:39], v[84:87], v[164:167]
    ds_read_b64_tr_b16 v[32:33], v131 offset:40960
    s_waitcnt lgkmcnt(5)
    v_mfma_f32_16x16x32_bf16 v[164:167], v[136:139], v[192:195], v[164:167]
    ds_read_b64_tr_b16 v[34:35], v131 offset:43008
    v_mfma_f32_16x16x32_bf16 v[164:167], v[140:143], v[92:95], v[164:167]
    ds_read_b64_tr_b16 v[36:37], v131 offset:45056
    v_mfma_f32_16x16x32_bf16 v[160:163], v[136:139], v[120:123], v[160:163]
    ds_read_b64_tr_b16 v[38:39], v131 offset:47104
    v_mfma_f32_16x16x32_bf16 v[160:163], v[140:143], v[88:91], v[160:163]
    ds_read_b64_tr_b16 v[136:137], v130 offset:49152
    s_waitcnt lgkmcnt(5)
    v_mfma_f32_16x16x32_bf16 v[168:171], v[24:27], v[116:119], v[168:171]
    ds_read_b64_tr_b16 v[138:139], v130 offset:51200
    v_mfma_f32_16x16x32_bf16 v[168:171], v[28:31], v[80:83], v[168:171]
    ds_read_b64_tr_b16 v[140:141], v128 offset:4096
    v_mfma_f32_16x16x32_bf16 v[172:175], v[24:27], v[188:191], v[172:175]
    ds_read_b64_tr_b16 v[142:143], v128 offset:6144
    v_mfma_f32_16x16x32_bf16 v[172:175], v[28:31], v[84:87], v[172:175]
    ds_read_b64_tr_b16 v[24:25], v131 offset:49152
    s_waitcnt lgkmcnt(5)
    v_mfma_f32_16x16x32_bf16 v[172:175], v[32:35], v[192:195], v[172:175]
    ds_read_b64_tr_b16 v[26:27], v131 offset:51200
    v_mfma_f32_16x16x32_bf16 v[172:175], v[36:39], v[92:95], v[172:175]
    ds_read_b64_tr_b16 v[28:29], v129 offset:4096
    v_mfma_f32_16x16x32_bf16 v[168:171], v[32:35], v[120:123], v[168:171]
    ds_read_b64_tr_b16 v[30:31], v129 offset:6144
    v_mfma_f32_16x16x32_bf16 v[168:171], v[36:39], v[88:91], v[168:171]
    ds_read_b64_tr_b16 v[32:33], v128 offset:8192
    s_waitcnt lgkmcnt(5)
    v_mfma_f32_16x16x32_bf16 v[144:147], v[136:139], v[124:127], v[144:147]
    ds_read_b64_tr_b16 v[34:35], v128 offset:10240
    v_mfma_f32_16x16x32_bf16 v[144:147], v[140:143], v[96:99], v[144:147]
    ds_read_b64_tr_b16 v[36:37], v128 offset:12288
    v_mfma_f32_16x16x32_bf16 v[148:151], v[136:139], v[196:199], v[148:151]
    ds_read_b64_tr_b16 v[38:39], v128 offset:14336
    v_mfma_f32_16x16x32_bf16 v[148:151], v[140:143], v[100:103], v[148:151]
    ds_read_b64_tr_b16 v[136:137], v129 offset:8192
    s_waitcnt lgkmcnt(5)
    v_mfma_f32_16x16x32_bf16 v[152:155], v[24:27], v[124:127], v[152:155]
    ds_read_b64_tr_b16 v[138:139], v129 offset:10240
    s_setprio 1
    v_mfma_f32_16x16x32_bf16 v[152:155], v[28:31], v[96:99], v[152:155]
    s_waitcnt vmcnt(0)
    s_barrier
    ds_read_b64_tr_b16 v[140:141], v129 offset:12288
    v_mfma_f32_16x16x32_bf16 v[156:159], v[24:27], v[196:199], v[156:159]
    ds_read_b64_tr_b16 v[142:143], v129 offset:14336
    v_mfma_f32_16x16x32_bf16 v[156:159], v[28:31], v[100:103], v[156:159]
    v_mul_f32 v48, v48, v67
    v_mul_f32 v49, v49, v67
    v_mul_f32 v50, v50, v67
    v_mul_f32 v51, v51, v67
    v_mul_f32 v52, v52, v67
    v_mul_f32 v53, v53, v67
    v_mul_f32 v54, v54, v67
    v_mul_f32 v55, v55, v67
    v_cvt_pk_bf16_f32 v200, v48, v49
    v_cvt_pk_bf16_f32 v201, v50, v51
    v_cvt_pk_bf16_f32 v202, v52, v53
    v_cvt_pk_bf16_f32 v203, v54, v55
    ds_write_b64 v68, v[200:201] offset:1696
    ds_write_b64 v68, v[202:203] offset:32
    s_add_u32 m0, s78, 102400
    s_add_u32 s90, s83, 256
    buffer_load_dwordx4 v20, s[40:43], s90 offen  lds
    s_add_u32 m0, s78, 106496
    s_add_u32 s90, s82, 384
    buffer_load_dwordx4 v20, s[40:43], s90 offen  lds
    s_add_u32 m0, s78, 110592
    s_add_u32 s90, s82, 37248
    buffer_load_dwordx4 v20, s[40:43], s90 offen  lds
    s_add_u32 m0, s78, 114688
    s_add_u32 s90, s82, 74112
    buffer_load_dwordx4 v20, s[40:43], s90 offen  lds
    s_add_u32 m0, s78, 118784
    s_add_u32 s90, s82, 110976
    buffer_load_dwordx4 v20, s[40:43], s90 offen  lds
    v_mov_b32 v200, -1
    v_mov_b32 v201, -1
    v_mov_b32 v202, -1
    v_mov_b32 v203, -1
    buffer_store_dwordx4 v[200:203], v0, s[44:47], s87 offen sc1
    s_lshl2_add_u32 s88, s75, s73
    s_mul_i32 s88, s88, 36864
    s_add_u32 s88, s88, 0x100000
    s_sub_u32 s34, s87, s88
    s_lshr_b32 s34, s34, 3
    s_add_u32 s34, s34, s88
    s_add_u32 s34, s34, 32768
    s_mov_b64 exec, 0xff
    buffer_store_dwordx4 v[200:203], v0, s[44:47], s34 offen sc1
    s_mov_b64 exec, -1
    s_setprio 0
    ds_read_b64_tr_b16 v[24:25], v128 offset:18432
    s_waitcnt lgkmcnt(7)
    v_mfma_f32_16x16x32_bf16 v[160:163], v[32:35], v[124:127], v[160:163]
    ds_read_b64_tr_b16 v[26:27], v128 offset:16384
    ds_read_b64 v[106:107], v21 offset:28680
    v_mfma_f32_16x16x32_bf16 v[160:163], v[36:39], v[96:99], v[160:163]
    ds_read_b64_tr_b16 v[28:29], v129 offset:18432
    ds_read_b64 v[110:111], v21 offset:28672
    v_mfma_f32_16x16x32_bf16 v[164:167], v[32:35], v[196:199], v[164:167]
    ds_read_b64_tr_b16 v[30:31], v129 offset:16384
    v_mfma_f32_16x16x32_bf16 v[164:167], v[36:39], v[100:103], v[164:167]
    ds_read_b64_tr_b16 v[32:33], v128 offset:22528
    s_waitcnt lgkmcnt(9)
    v_mfma_f32_16x16x32_bf16 v[168:171], v[136:139], v[124:127], v[168:171]
    ds_read_b64_tr_b16 v[34:35], v128 offset:20480
    v_mfma_f32_16x16x32_bf16 v[168:171], v[140:143], v[96:99], v[168:171]
    ds_read_b64_tr_b16 v[36:37], v129 offset:22528
    v_mfma_f32_16x16x32_bf16 v[172:175], v[136:139], v[196:199], v[172:175]
    ds_read_b64_tr_b16 v[38:39], v129 offset:20480
    v_mfma_f32_16x16x32_bf16 v[172:175], v[140:143], v[100:103], v[172:175]
    ds_read_b64_tr_b16 v[136:137], v128 offset:24576
    s_waitcnt lgkmcnt(8)
    v_mfma_f32_16x16x32_bf16 v[144:147], v[24:27], v[104:107], v[144:147]
    ds_read_b64_tr_b16 v[138:139], v128 offset:26624
    s_waitcnt lgkmcnt(7)
    v_mfma_f32_16x16x32_bf16 v[148:151], v[24:27], v[108:111], v[148:151]
    ds_read_b64_tr_b16 v[140:141], v128 offset:28672
    s_waitcnt lgkmcnt(7)
    v_mfma_f32_16x16x32_bf16 v[152:155], v[28:31], v[104:107], v[152:155]
    ds_read_b64_tr_b16 v[142:143], v128 offset:30720
    v_mfma_f32_16x16x32_bf16 v[156:159], v[28:31], v[108:111], v[156:159]
    ds_read_b64_tr_b16 v[24:25], v128 offset:32768
    s_waitcnt lgkmcnt(7)
    v_mfma_f32_16x16x32_bf16 v[160:163], v[32:35], v[104:107], v[160:163]
    ds_read_b64_tr_b16 v[26:27], v128 offset:34816
    v_mfma_f32_16x16x32_bf16 v[164:167], v[32:35], v[108:111], v[164:167]
    ds_read_b64_tr_b16 v[28:29], v128 offset:36864
    s_waitcnt lgkmcnt(7)
    v_mfma_f32_16x16x32_bf16 v[168:171], v[36:39], v[104:107], v[168:171]
    ds_read_b64_tr_b16 v[30:31], v128 offset:38912
    v_mfma_f32_16x16x32_bf16 v[172:175], v[36:39], v[108:111], v[172:175]
    ds_read_b64_tr_b16 v[32:33], v128 offset:40960
    s_waitcnt lgkmcnt(5)
    v_mfma_f32_16x16x32_bf16 v[240:243], v[136:139], v[112:115], 0
    ds_read_b64_tr_b16 v[34:35], v128 offset:43008
    v_mfma_f32_16x16x32_bf16 v[240:243], v[140:143], v[72:75], v[240:243]
    ds_read_b64_tr_b16 v[36:37], v128 offset:45056
    v_mfma_f32_16x16x32_bf16 v[244:247], v[136:139], v[184:187], 0
    ds_read_b64_tr_b16 v[38:39], v128 offset:47104
    v_mfma_f32_16x16x32_bf16 v[244:247], v[140:143], v[76:79], v[244:247]
    ds_read_b64_tr_b16 v[136:137], v128 offset:49152
    s_waitcnt lgkmcnt(5)
    v_mfma_f32_16x16x32_bf16 v[244:247], v[24:27], v[188:191], v[244:247]
    ds_read_b64_tr_b16 v[138:139], v128 offset:51200
    v_mfma_f32_16x16x32_bf16 v[244:247], v[28:31], v[84:87], v[244:247]
    ds_read_b64_tr_b16 v[140:141], v128 offset:53248
    v_mfma_f32_16x16x32_bf16 v[240:243], v[24:27], v[116:119], v[240:243]
    ds_read_b64_tr_b16 v[142:143], v128 offset:55296
    v_mfma_f32_16x16x32_bf16 v[240:243], v[28:31], v[80:83], v[240:243]
    ds_read_b64_tr_b16 v[24:25], v129 offset:24576
    s_waitcnt lgkmcnt(5)
    v_mfma_f32_16x16x32_bf16 v[240:243], v[32:35], v[120:123], v[240:243]
    ds_read_b64_tr_b16 v[26:27], v129 offset:26624
    v_mfma_f32_16x16x32_bf16 v[240:243], v[36:39], v[88:91], v[240:243]
    ds_read_b64_tr_b16 v[28:29], v129 offset:28672
    v_mfma_f32_16x16x32_bf16 v[244:247], v[32:35], v[192:195], v[244:247]
    ds_read_b64_tr_b16 v[30:31], v129 offset:30720
    v_mfma_f32_16x16x32_bf16 v[244:247], v[36:39], v[92:95], v[244:247]
    ds_read_b64_tr_b16 v[32:33], v129 offset:32768
    s_waitcnt lgkmcnt(5)
    v_mfma_f32_16x16x32_bf16 v[244:247], v[136:139], v[196:199], v[244:247]
    ds_read_b64_tr_b16 v[34:35], v129 offset:34816
    v_mfma_f32_16x16x32_bf16 v[244:247], v[140:143], v[100:103], v[244:247]
    ds_read_b64_tr_b16 v[36:37], v129 offset:36864
    v_mfma_f32_16x16x32_bf16 v[240:243], v[136:139], v[124:127], v[240:243]
    ds_read_b64_tr_b16 v[38:39], v129 offset:38912
    v_mfma_f32_16x16x32_bf16 v[240:243], v[140:143], v[96:99], v[240:243]
    ds_read_b64_tr_b16 v[136:137], v129 offset:40960
    s_waitcnt lgkmcnt(5)
    v_mfma_f32_16x16x32_bf16 v[248:251], v[24:27], v[112:115], 0
    ds_read_b64_tr_b16 v[138:139], v129 offset:43008
    v_mfma_f32_16x16x32_bf16 v[248:251], v[28:31], v[72:75], v[248:251]
    ds_read_b64_tr_b16 v[140:141], v129 offset:45056
    v_mfma_f32_16x16x32_bf16 v[252:255], v[24:27], v[184:187], 0
    ds_read_b64_tr_b16 v[142:143], v129 offset:47104
    v_mfma_f32_16x16x32_bf16 v[252:255], v[28:31], v[76:79], v[252:255]
    ds_read_b64_tr_b16 v[24:25], v129 offset:49152
    s_waitcnt lgkmcnt(5)
    v_mfma_f32_16x16x32_bf16 v[252:255], v[32:35], v[188:191], v[252:255]
    ds_read_b64_tr_b16 v[26:27], v129 offset:51200
    v_mfma_f32_16x16x32_bf16 v[252:255], v[36:39], v[84:87], v[252:255]
    ds_read_b64_tr_b16 v[28:29], v129 offset:53248
    v_mfma_f32_16x16x32_bf16 v[248:251], v[32:35], v[116:119], v[248:251]
    ds_read_b64_tr_b16 v[30:31], v129 offset:55296
    v_mfma_f32_16x16x32_bf16 v[248:251], v[36:39], v[80:83], v[248:251]
    ds_read_b64_tr_b16 v[32:33], v128 offset:59392
    s_waitcnt lgkmcnt(5)
    v_mfma_f32_16x16x32_bf16 v[248:251], v[136:139], v[120:123], v[248:251]
    ds_read_b64_tr_b16 v[34:35], v128 offset:57344
    s_setprio 1
    v_mfma_f32_16x16x32_bf16 v[248:251], v[140:143], v[88:91], v[248:251]
    s_waitcnt vmcnt(6)
    s_barrier
    ds_read_b64_tr_b16 v[36:37], v129 offset:59392
    v_mfma_f32_16x16x32_bf16 v[252:255], v[136:139], v[192:195], v[252:255]
    ds_read_b64_tr_b16 v[38:39], v129 offset:57344
    v_mfma_f32_16x16x32_bf16 v[252:255], v[140:143], v[92:95], v[252:255]
    s_add_u32 m0, s78, 8192
    s_add_u32 s90, s82, 512
    buffer_load_dwordx4 v20, s[40:43], s90 offen  lds
    s_lshl3_add_u32 s88, s85, s72
    s_lshr_b32 s89, s76, 2
    s_lshl2_add_u32 s89, s75, s89
    s_lshl_b32 s89, s89, 5
    s_add_u32 m0, s78, 12288
    s_add_u32 s90, s82, 37376
    buffer_load_dwordx4 v20, s[40:43], s90 offen  lds
    v_add_u32 v5, s89, v22
    s_lshl_b32 s89, s88, 5
    s_sub_u32 s89, s89, 32
    v_add_u32 v200, s89, v22
    v_cmp_gt_u32 vcc, 32, v22
    s_add_u32 m0, s78, 16384
    s_add_u32 s90, s82, 74240
    buffer_load_dwordx4 v20, s[40:43], s90 offen  lds
    v_and_b32 v202, 1, v22
    s_lshl4_add_u32 s89, s85, s72
    s_lshl1_add_u32 s89, s89, 1024
    v_cndmask_b32 v5, v200, v5, vcc
    v_add_u32 v200, s89, v202
    s_add_u32 m0, s78, 20480
    s_add_u32 s90, s82, 111104
    buffer_load_dwordx4 v20, s[40:43], s90 offen  lds
    v_cmp_gt_u32 vcc, 48, v22
    s_and_b32 s89, s88, 3
    s_lshl_b32 s89, s89, 5
    s_lshr_b32 s88, s88, 2
    s_add_u32 s89, s89, s88
    s_add_u32 m0, s78, 24576
    s_add_u32 s90, s82, 147968
    buffer_load_dwordx4 v20, s[40:43], s90 offen  lds
    s_add_u32 s89, s89, 1152
    v_cndmask_b32 v5, v200, v5, vcc
    v_lshl_add_u32 v200, v202, 7, s89
    v_cmp_gt_u32 vcc, 52, v22
    s_lshl_b32 s89, s85, 5
    s_add_u32 s89, s89, 1160
    v_cndmask_b32 v5, v200, v5, vcc
    v_lshl_add_u32 v200, v202, 7, s89
    v_cmp_gt_u32 vcc, 56, v22
    s_mov_b32 s89, 0x340000
    s_nop 0
    v_cndmask_b32 v5, v200, v5, vcc
    v_lshl_add_u32 v5, v5, 5, s89
    v_cvt_pk_bf16_f32 v210, v144, v145
    v_cvt_pk_bf16_f32 v211, v146, v147
    v_cvt_pk_bf16_f32 v208, v148, v149
    v_cvt_pk_bf16_f32 v209, v150, v151
    v_cvt_pk_bf16_f32 v214, v152, v153
    v_cvt_pk_bf16_f32 v215, v154, v155
    v_cvt_pk_bf16_f32 v212, v156, v157
    v_cvt_pk_bf16_f32 v213, v158, v159
    v_cvt_pk_bf16_f32 v218, v160, v161
    v_cvt_pk_bf16_f32 v219, v162, v163
    v_cvt_pk_bf16_f32 v216, v164, v165
    v_cvt_pk_bf16_f32 v217, v166, v167
    v_cvt_pk_bf16_f32 v222, v168, v169
    v_cvt_pk_bf16_f32 v223, v170, v171
    v_cvt_pk_bf16_f32 v220, v172, v173
    v_cvt_pk_bf16_f32 v221, v174, v175
    s_add_u32 s91, s86, 524288
    buffer_store_dwordx4 v[208:211], v0, s[44:47], s91 offen sc1
    s_setprio 0
    ds_read_b64_tr_b16 v[136:137], v128 offset:61440
    s_waitcnt lgkmcnt(5)
    v_mfma_f32_16x16x32_bf16 v[252:255], v[24:27], v[196:199], v[252:255]
    ds_read_b64_tr_b16 v[138:139], v128 offset:63488
    v_mfma_f32_16x16x32_bf16 v[252:255], v[28:31], v[100:103], v[252:255]
    ds_read_b64_tr_b16 v[140:141], v130
    v_mfma_f32_16x16x32_bf16 v[248:251], v[24:27], v[124:127], v[248:251]
    ds_read_b64_tr_b16 v[142:143], v130 offset:2048
    v_mfma_f32_16x16x32_bf16 v[248:251], v[28:31], v[96:99], v[248:251]
    ds_read_b64_tr_b16 v[24:25], v130 offset:4096
    s_waitcnt lgkmcnt(7)
    v_mfma_f32_16x16x32_bf16 v[240:243], v[32:35], v[104:107], v[240:243]
    ds_read_b64_tr_b16 v[26:27], v130 offset:6144
    v_mfma_f32_16x16x32_bf16 v[244:247], v[32:35], v[108:111], v[244:247]
    ds_read_b64_tr_b16 v[28:29], v130 offset:8192
    s_waitcnt lgkmcnt(7)
    v_mfma_f32_16x16x32_bf16 v[248:251], v[36:39], v[104:107], v[248:251]
    ds_read_b64_tr_b16 v[30:31], v130 offset:10240
    v_mfma_f32_16x16x32_bf16 v[252:255], v[36:39], v[108:111], v[252:255]
    ds_read_b64_tr_b16 v[32:33], v130 offset:12288
    s_waitcnt lgkmcnt(5)
    v_mfma_f32_16x16x32_bf16 v[144:147], v[136:139], v[112:115], 0
    ds_read_b64_tr_b16 v[34:35], v130 offset:14336
    v_mfma_f32_16x16x32_bf16 v[144:147], v[140:143], v[72:75], v[144:147]
    ds_read_b64_tr_b16 v[36:37], v130 offset:24576
    v_mfma_f32_16x16x32_bf16 v[148:151], v[136:139], v[184:187], 0
    ds_read_b64_tr_b16 v[38:39], v130 offset:26624
    v_mfma_f32_16x16x32_bf16 v[148:151], v[140:143], v[76:79], v[148:151]
    ds_read_b64_tr_b16 v[136:137], v130 offset:28672
    s_waitcnt lgkmcnt(5)
    v_mfma_f32_16x16x32_bf16 v[148:151], v[24:27], v[188:191], v[148:151]
    ds_read_b64_tr_b16 v[138:139], v130 offset:30720
    v_mfma_f32_16x16x32_bf16 v[148:151], v[28:31], v[84:87], v[148:151]
    ds_read_b64_tr_b16 v[140:141], v130 offset:32768
    v_mfma_f32_16x16x32_bf16 v[144:147], v[24:27], v[116:119], v[144:147]
    ds_read_b64_tr_b16 v[142:143], v130 offset:34816
    v_mfma_f32_16x16x32_bf16 v[144:147], v[28:31], v[80:83], v[144:147]
    ds_read_b64_tr_b16 v[24:25], v129 offset:61440
    s_waitcnt lgkmcnt(5)
    v_mfma_f32_16x16x32_bf16 v[144:147], v[32:35], v[120:123], v[144:147]
    ds_read_b64_tr_b16 v[26:27], v129 offset:63488
    v_mfma_f32_16x16x32_bf16 v[144:147], v[36:39], v[88:91], v[144:147]
    ds_read_b64_tr_b16 v[28:29], v131
    v_mfma_f32_16x16x32_bf16 v[148:151], v[32:35], v[192:195], v[148:151]
    ds_read_b64_tr_b16 v[30:31], v131 offset:2048
    v_mfma_f32_16x16x32_bf16 v[148:151], v[36:39], v[92:95], v[148:151]
    ds_read_b64_tr_b16 v[32:33], v131 offset:4096
    s_waitcnt lgkmcnt(5)
    v_mfma_f32_16x16x32_bf16 v[148:151], v[136:139], v[196:199], v[148:151]
    ds_read_b64_tr_b16 v[34:35], v131 offset:6144
    v_mfma_f32_16x16x32_bf16 v[148:151], v[140:143], v[100:103], v[148:151]
    ds_read_b64_tr_b16 v[36:37], v131 offset:8192
    v_mfma_f32_16x16x32_bf16 v[144:147], v[136:139], v[124:127], v[144:147]
    ds_read_b64_tr_b16 v[38:39], v131 offset:10240
    v_mfma_f32_16x16x32_bf16 v[144:147], v[140:143], v[96:99], v[144:147]
    ds_read_b64_tr_b16 v[136:137], v131 offset:12288
    s_waitcnt lgkmcnt(5)
    v_mfma_f32_16x16x32_bf16 v[152:155], v[24:27], v[112:115], 0
    ds_read_b64_tr_b16 v[138:139], v131 offset:14336
L_page5:
    s_cbranch_execz L_probed
    v_mfma_f32_16x16x32_bf16 v[152:155], v[28:31], v[72:75], v[152:155]
    ds_read_b64_tr_b16 v[140:141], v131 offset:24576
    v_mfma_f32_16x16x32_bf16 v[156:159], v[24:27], v[184:187], 0
    ds_read_b64_tr_b16 v[142:143], v131 offset:26624
    v_mfma_f32_16x16x32_bf16 v[156:159], v[28:31], v[76:79], v[156:159]
    ds_read_b64_tr_b16 v[24:25], v131 offset:28672
    s_waitcnt lgkmcnt(5)
    v_mfma_f32_16x16x32_bf16 v[156:159], v[32:35], v[188:191], v[156:159]
    ds_read_b64_tr_b16 v[26:27], v131 offset:30720
    v_mfma_f32_16x16x32_bf16 v[156:159], v[36:39], v[84:87], v[156:159]
    ds_read_b64_tr_b16 v[28:29], v131 offset:32768
    v_mfma_f32_16x16x32_bf16 v[152:155], v[32:35], v[116:119], v[152:155]
    ds_read_b64_tr_b16 v[30:31], v131 offset:34816
    v_mfma_f32_16x16x32_bf16 v[152:155], v[36:39], v[80:83], v[152:155]
    ds_read_b64_tr_b16 v[32:33], v130 offset:38912
    s_waitcnt lgkmcnt(5)
    v_mfma_f32_16x16x32_bf16 v[152:155], v[136:139], v[120:123], v[152:155]
    ds_read_b64_tr_b16 v[34:35], v130 offset:36864
    s_setprio 1
    v_mfma_f32_16x16x32_bf16 v[152:155], v[140:143], v[88:91], v[152:155]
    s_waitcnt vmcnt(8)
    s_barrier
    ds_read_b64_tr_b16 v[36:37], v131 offset:38912
    v_mfma_f32_16x16x32_bf16 v[156:159], v[136:139], v[192:195], v[156:159]
    ds_read_b64_tr_b16 v[38:39], v131 offset:36864
    v_mfma_f32_16x16x32_bf16 v[156:159], v[140:143], v[92:95], v[156:159]
    s_add_u32 m0, s78, 49152
    s_add_u32 s90, s82, 37504
    buffer_load_dwordx4 v20, s[40:43], s90 offen  lds
    v_and_b32 v69, 1, v65
    v_mad_u32_u24 v69, v69, 36, v66
    v_add_u32 v69, 1664, v69
    v_lshrrev_b32 v70, 1, v65
    s_add_u32 m0, s78, 53248
    s_add_u32 s90, s82, 74368
    buffer_load_dwordx4 v20, s[40:43], s90 offen  lds
    v_lshl_add_u32 v70, v70, 4, v69
    ds_read2_b32 v[40:41], v70 offset0:0 offset1:1
    ds_read2_b32 v[42:43], v70 offset0:2 offset1:3
    ds_read_b32 v44, v69 offset:32
    s_add_u32 m0, s78, 57344
    s_add_u32 s90, s82, 111232
    buffer_load_dwordx4 v20, s[40:43], s90 offen  lds
    v_mov_b32 v53, 0x3f80
    v_mov_b32 v54, 0xdddddddd
    v_and_b32 v200, 27, v22
    v_cmp_eq_u32 vcc, 18, v200
    s_add_u32 m0, s78, 61440
    s_add_u32 s90, s82, 148096
    buffer_load_dwordx4 v20, s[40:43], s90 offen  lds
    v_mov_b32 v200, 0x3f803f80
    v_cndmask_b32 v56, 0, v200, vcc
    v_cndmask_b32 v57, 0, v200, vcc
    v_cndmask_b32 v58, 0, v200, vcc
    s_add_u32 m0, s78, 65536
    s_add_u32 s90, s82, 184960
    buffer_load_dwordx4 v20, s[40:43], s90 offen  lds
    v_cndmask_b32 v59, 0, v200, vcc
    v_cndmask_b32 v60, 0, v200, vcc
    v_cndmask_b32 v61, 0, v200, vcc
    v_cndmask_b32 v62, 0, v200, vcc
    v_cndmask_b32 v63, 0, v200, vcc
    v_mov_b32 v2, v0
    v_lshlrev_b32 v4, 2, v22
    v_lshlrev_b32 v1, 2, v22
    v_and_b32 v200, 31, v22
    v_lshrrev_b32 v3, 5, v22
    v_mul_u32_u24 v3, 288, v3
    v_lshl_add_u32 v3, v200, 4, v3
    s_mov_b32 s92, 0x3ffff
    s_mov_b32 s93, 0x3ffff
    v_cvt_pk_bf16_f32 v226, v240, v241
    v_cvt_pk_bf16_f32 v227, v242, v243
    v_cvt_pk_bf16_f32 v224, v244, v245
    v_cvt_pk_bf16_f32 v225, v246, v247
    v_cvt_pk_bf16_f32 v230, v248, v249
    v_cvt_pk_bf16_f32 v231, v250, v251
    v_cvt_pk_bf16_f32 v228, v252, v253
    v_cvt_pk_bf16_f32 v229, v254, v255
    s_add_u32 s91, s86, 540672
    buffer_store_dwordx4 v[212:215], v0, s[44:47], s91 offen sc1
    s_setprio 0
    ds_read_b64_tr_b16 v[136:137], v130 offset:40960
    s_waitcnt lgkmcnt(8)
    v_mfma_f32_16x16x32_bf16 v[156:159], v[24:27], v[196:199], v[156:159]
    ds_read_b64_tr_b16 v[138:139], v130 offset:43008
    v_mfma_f32_16x16x32_bf16 v[156:159], v[28:31], v[100:103], v[156:159]
    ds_read_b64_tr_b16 v[140:141], v130 offset:45056
    v_mfma_f32_16x16x32_bf16 v[152:155], v[24:27], v[124:127], v[152:155]
    ds_read_b64_tr_b16 v[142:143], v130 offset:47104
    v_mfma_f32_16x16x32_bf16 v[152:155], v[28:31], v[96:99], v[152:155]
    ds_read_b64_tr_b16 v[24:25], v130 offset:49152
    s_waitcnt lgkmcnt(10)
    v_mfma_f32_16x16x32_bf16 v[144:147], v[32:35], v[104:107], v[144:147]
    ds_read_b64_tr_b16 v[26:27], v130 offset:51200
    v_mfma_f32_16x16x32_bf16 v[148:151], v[32:35], v[108:111], v[148:151]
    ds_read_b64_tr_b16 v[28:29], v130 offset:53248
    s_waitcnt lgkmcnt(10)
    v_mfma_f32_16x16x32_bf16 v[152:155], v[36:39], v[104:107], v[152:155]
    ds_read_b64_tr_b16 v[30:31], v130 offset:55296
    v_mfma_f32_16x16x32_bf16 v[156:159], v[36:39], v[108:111], v[156:159]
    ds_read_b64_tr_b16 v[32:33], v130 offset:57344
    s_waitcnt lgkmcnt(5)
    v_mfma_f32_16x16x32_bf16 v[160:163], v[136:139], v[112:115], 0
    ds_read_b64_tr_b16 v[34:35], v130 offset:59392
    v_mfma_f32_16x16x32_bf16 v[160:163], v[140:143], v[72:75], v[160:163]
    ds_read_b64_tr_b16 v[36:37], v130 offset:61440
    v_mfma_f32_16x16x32_bf16 v[164:167], v[136:139], v[184:187], 0
    ds_read_b64_tr_b16 v[38:39], v130 offset:63488
    v_mfma_f32_16x16x32_bf16 v[164:167], v[140:143], v[76:79], v[164:167]
    ds_read_b64_tr_b16 v[136:137], v132
    s_waitcnt lgkmcnt(5)
    v_mfma_f32_16x16x32_bf16 v[164:167], v[24:27], v[188:191], v[164:167]
    ds_read_b64_tr_b16 v[138:139], v132 offset:2048
    v_mfma_f32_16x16x32_bf16 v[164:167], v[28:31], v[84:87], v[164:167]
    ds_read_b64_tr_b16 v[140:141], v128
    v_mfma_f32_16x16x32_bf16 v[160:163], v[24:27], v[116:119], v[160:163]
    ds_read_b64_tr_b16 v[142:143], v128 offset:2048
    v_mfma_f32_16x16x32_bf16 v[160:163], v[28:31], v[80:83], v[160:163]
    ds_read_b64_tr_b16 v[24:25], v131 offset:40960
    s_waitcnt lgkmcnt(5)
    v_mfma_f32_16x16x32_bf16 v[160:163], v[32:35], v[120:123], v[160:163]
    ds_read_b64_tr_b16 v[26:27], v131 offset:43008
    v_mfma_f32_16x16x32_bf16 v[160:163], v[36:39], v[88:91], v[160:163]
    ds_read_b64_tr_b16 v[28:29], v131 offset:45056
    v_mfma_f32_16x16x32_bf16 v[164:167], v[32:35], v[192:195], v[164:167]
    ds_read_b64_tr_b16 v[30:31], v131 offset:47104
    v_mfma_f32_16x16x32_bf16 v[164:167], v[36:39], v[92:95], v[164:167]
    ds_read_b64_tr_b16 v[32:33], v131 offset:49152
    s_waitcnt lgkmcnt(5)
    v_mfma_f32_16x16x32_bf16 v[164:167], v[136:139], v[196:199], v[164:167]
    ds_read_b64_tr_b16 v[34:35], v131 offset:51200
    v_mfma_f32_16x16x32_bf16 v[164:167], v[140:143], v[100:103], v[164:167]
    ds_read_b64_tr_b16 v[36:37], v131 offset:53248
    v_mfma_f32_16x16x32_bf16 v[160:163], v[136:139], v[124:127], v[160:163]
    ds_read_b64_tr_b16 v[38:39], v131 offset:55296
    v_mfma_f32_16x16x32_bf16 v[160:163], v[140:143], v[96:99], v[160:163]
    ds_read_b64_tr_b16 v[136:137], v131 offset:57344
    s_waitcnt lgkmcnt(5)
    v_mfma_f32_16x16x32_bf16 v[168:171], v[24:27], v[112:115], 0
    ds_read_b64_tr_b16 v[138:139], v131 offset:59392
    v_mfma_f32_16x16x32_bf16 v[168:171], v[28:31], v[72:75], v[168:171]
    ds_read_b64_tr_b16 v[140:141], v131 offset:61440
    v_mfma_f32_16x16x32_bf16 v[172:175], v[24:27], v[184:187], 0
    ds_read_b64_tr_b16 v[142:143], v131 offset:63488
    v_mfma_f32_16x16x32_bf16 v[172:175], v[28:31], v[76:79], v[172:175]
    ds_read_b64_tr_b16 v[24:25], v133
    s_waitcnt lgkmcnt(5)
    v_mfma_f32_16x16x32_bf16 v[172:175], v[32:35], v[188:191], v[172:175]
    ds_read_b64_tr_b16 v[26:27], v133 offset:2048
    v_mfma_f32_16x16x32_bf16 v[172:175], v[36:39], v[84:87], v[172:175]
    ds_read_b64_tr_b16 v[28:29], v129
    v_mfma_f32_16x16x32_bf16 v[168:171], v[32:35], v[116:119], v[168:171]
    ds_read_b64_tr_b16 v[30:31], v129 offset:2048
    v_mfma_f32_16x16x32_bf16 v[168:171], v[36:39], v[80:83], v[168:171]
    ds_read_b64_tr_b16 v[32:33], v128 offset:6144
    s_waitcnt lgkmcnt(5)
    v_mfma_f32_16x16x32_bf16 v[168:171], v[136:139], v[120:123], v[168:171]
    ds_read_b64_tr_b16 v[34:35], v128 offset:4096
    s_setprio 1
    v_mfma_f32_16x16x32_bf16 v[168:171], v[140:143], v[88:91], v[168:171]
    s_waitcnt vmcnt(7)
    s_barrier
    ds_read_b64_tr_b16 v[36:37], v129 offset:6144
    v_mfma_f32_16x16x32_bf16 v[172:175], v[136:139], v[192:195], v[172:175]
    ds_read_b64_tr_b16 v[38:39], v129 offset:4096
    v_mfma_f32_16x16x32_bf16 v[172:175], v[140:143], v[92:95], v[172:175]
    s_add_u32 m0, s78, 90112
    s_add_u32 s90, s82, 74496
    buffer_load_dwordx4 v20, s[40:43], s90 offen  lds
    v_lshlrev_b32 v200, 16, v40
    s_lshl3_add_u32 s3, s85, s72
    v_lshlrev_b32 v201, 16, v41
    s_lshr_b32 s88, s76, 2
    v_lshlrev_b32 v202, 16, v42
    s_lshl2_add_u32 s88, s75, s88
    s_add_u32 m0, s78, 94208
    s_add_u32 s90, s82, 111360
    buffer_load_dwordx4 v20, s[40:43], s90 offen  lds
    v_lshlrev_b32 v203, 16, v43
    s_mul_i32 s88, s88, 589824
    v_lshlrev_b32 v204, 16, v44
    s_add_u32 s88, s88, 0x400000
    v_mul_f32 v23, v40, v40
    s_lshl_b32 s77, s3, 14
    s_add_u32 m0, s78, 98304
    s_add_u32 s90, s82, 148224
    buffer_load_dwordx4 v20, s[40:43], s90 offen  lds
    v_fmac_f32 v23, v41, v41
    s_add_u32 s77, s77, s88
    v_fmac_f32 v23, v42, v42
    s_lshl_b32 s79, s3, 11
    v_fmac_f32 v23, v43, v43
    s_add_u32 s79, s79, s88
    s_add_u32 m0, s78, 102400
    s_add_u32 s90, s82, 185088
    buffer_load_dwordx4 v20, s[40:43], s90 offen  lds
    v_fmac_f32 v23, v200, v200
    s_add_u32 s79, s79, 524288
    v_fmac_f32 v23, v201, v201
    s_mul_i32 s80, s3, 18432
    v_fmac_f32 v23, v202, v202
    s_add_u32 s80, s80, 0x40000
    s_add_u32 m0, s78, 106496
    s_add_u32 s90, s82, 221952
    buffer_load_dwordx4 v20, s[40:43], s90 offen  lds
    v_fmac_f32 v23, v203, v203
    s_mul_i32 s88, s85, 18432
    v_mov_b32 v69, v23
    s_add_u32 s88, s88, 0xd0000
    v_cmp_gt_u32 vcc, 32, v22
    s_lshl_b32 s71, s72, 11
    v_mov_b32 v70, 0
    s_add_u32 s81, s88, s71
    v_permlane32_swap_b32 v69, v23
    s_lshl_b32 s89, s72, 8
    v_add_f32 v23, v23, v69
    s_add_u32 s60, s88, s89
    v_fmac_f32 v23, v44, v44
    s_add_u32 s60, s60, 16384
    v_fmac_f32 v23, v204, v204
    s_add_u32 s70, s80, 16384
    v_cndmask_b32 v46, v44, v70, vcc
    s_cmp_lt_u32 s85, 2
    s_cselect_b32 s88, s77, s80
    s_cselect_b32 s80, s80, s77
    s_cselect_b32 s89, s79, s70
    s_cselect_b32 s70, s70, s79
    s_mov_b32 s77, s88
    s_mov_b32 s79, s89
    v_cndmask_b32 v44, 0, v44, vcc
    v_cvt_pk_bf16_f32 v234, v144, v145
    v_cvt_pk_bf16_f32 v235, v146, v147
    v_cvt_pk_bf16_f32 v232, v148, v149
    v_cvt_pk_bf16_f32 v233, v150, v151
    v_cvt_pk_bf16_f32 v238, v152, v153
    v_cvt_pk_bf16_f32 v239, v154, v155
    v_cvt_pk_bf16_f32 v236, v156, v157
    v_cvt_pk_bf16_f32 v237, v158, v159
    s_add_u32 s91, s86, 0
    buffer_store_dwordx4 v[216:219], v0, s[44:47], s91 offen sc1
    s_setprio 0
    ds_read_b64_tr_b16 v[136:137], v128 offset:8192
    s_waitcnt lgkmcnt(5)
    v_mfma_f32_16x16x32_bf16 v[172:175], v[24:27], v[196:199], v[172:175]
    ds_read_b64_tr_b16 v[138:139], v128 offset:10240
    v_mfma_f32_16x16x32_bf16 v[172:175], v[28:31], v[100:103], v[172:175]
    ds_read_b64_tr_b16 v[140:141], v128 offset:12288
    v_mfma_f32_16x16x32_bf16 v[168:171], v[24:27], v[124:127], v[168:171]
    ds_read_b64_tr_b16 v[142:143], v128 offset:14336
    v_mfma_f32_16x16x32_bf16 v[168:171], v[28:31], v[96:99], v[168:171]
    ds_read_b64_tr_b16 v[24:25], v128 offset:16384
    s_waitcnt lgkmcnt(7)
    v_mfma_f32_16x16x32_bf16 v[160:163], v[32:35], v[104:107], v[160:163]
    ds_read_b64_tr_b16 v[26:27], v128 offset:18432
    v_mfma_f32_16x16x32_bf16 v[164:167], v[32:35], v[108:111], v[164:167]
    ds_read_b64_tr_b16 v[28:29], v128 offset:20480
    s_waitcnt lgkmcnt(7)
    v_mfma_f32_16x16x32_bf16 v[168:171], v[36:39], v[104:107], v[168:171]
    ds_read_b64_tr_b16 v[30:31], v128 offset:22528
    v_mfma_f32_16x16x32_bf16 v[172:175], v[36:39], v[108:111], v[172:175]
    ds_read_b64_tr_b16 v[32:33], v128 offset:24576
    s_waitcnt lgkmcnt(5)
    v_mfma_f32_16x16x32_bf16 v[144:147], v[136:139], v[112:115], 0
    ds_read_b64_tr_b16 v[34:35], v128 offset:26624
    v_mfma_f32_16x16x32_bf16 v[144:147], v[140:143], v[72:75], v[144:147]
    ds_read_b64_tr_b16 v[36:37], v128 offset:28672
    v_mfma_f32_16x16x32_bf16 v[148:151], v[136:139], v[184:187], 0
    ds_read_b64_tr_b16 v[38:39], v128 offset:30720
    v_mfma_f32_16x16x32_bf16 v[148:151], v[140:143], v[76:79], v[148:151]
    ds_read_b64_tr_b16 v[136:137], v128 offset:32768
    s_waitcnt lgkmcnt(5)
    v_mfma_f32_16x16x32_bf16 v[148:151], v[24:27], v[188:191], v[148:151]
    ds_read_b64_tr_b16 v[138:139], v128 offset:34816
    v_mfma_f32_16x16x32_bf16 v[148:151], v[28:31], v[84:87], v[148:151]
    ds_read_b64_tr_b16 v[140:141], v128 offset:36864
    v_mfma_f32_16x16x32_bf16 v[144:147], v[24:27], v[116:119], v[144:147]
    ds_read_b64_tr_b16 v[142:143], v128 offset:38912
    v_mfma_f32_16x16x32_bf16 v[144:147], v[28:31], v[80:83], v[144:147]
    ds_read_b64_tr_b16 v[24:25], v129 offset:8192
    s_waitcnt lgkmcnt(5)
    v_mfma_f32_16x16x32_bf16 v[144:147], v[32:35], v[120:123], v[144:147]
    ds_read_b64_tr_b16 v[26:27], v129 offset:10240
    v_mfma_f32_16x16x32_bf16 v[144:147], v[36:39], v[88:91], v[144:147]
    ds_read_b64_tr_b16 v[28:29], v129 offset:12288
    v_mfma_f32_16x16x32_bf16 v[148:151], v[32:35], v[192:195], v[148:151]
    ds_read_b64_tr_b16 v[30:31], v129 offset:14336
    v_mfma_f32_16x16x32_bf16 v[148:151], v[36:39], v[92:95], v[148:151]
    ds_read_b64_tr_b16 v[32:33], v129 offset:16384
    s_waitcnt lgkmcnt(5)
    v_mfma_f32_16x16x32_bf16 v[148:151], v[136:139], v[196:199], v[148:151]
    ds_read_b64_tr_b16 v[34:35], v129 offset:18432
    v_mfma_f32_16x16x32_bf16 v[148:151], v[140:143], v[100:103], v[148:151]
    ds_read_b64_tr_b16 v[36:37], v129 offset:20480
    v_mfma_f32_16x16x32_bf16 v[144:147], v[136:139], v[124:127], v[144:147]
    ds_read_b64_tr_b16 v[38:39], v129 offset:22528
    v_mfma_f32_16x16x32_bf16 v[144:147], v[140:143], v[96:99], v[144:147]
    ds_read_b64_tr_b16 v[136:137], v129 offset:24576
    s_waitcnt lgkmcnt(5)
    v_mfma_f32_16x16x32_bf16 v[152:155], v[24:27], v[112:115], 0
    ds_read_b64_tr_b16 v[138:139], v129 offset:26624
    v_mfma_f32_16x16x32_bf16 v[152:155], v[28:31], v[72:75], v[152:155]
    ds_read_b64_tr_b16 v[140:141], v129 offset:28672
    v_mfma_f32_16x16x32_bf16 v[156:159], v[24:27], v[184:187], 0
    ds_read_b64_tr_b16 v[142:143], v129 offset:30720
    v_mfma_f32_16x16x32_bf16 v[156:159], v[28:31], v[76:79], v[156:159]
    ds_read_b64_tr_b16 v[24:25], v129 offset:32768
    s_waitcnt lgkmcnt(5)
    v_mfma_f32_16x16x32_bf16 v[156:159], v[32:35], v[188:191], v[156:159]
    ds_read_b64_tr_b16 v[26:27], v129 offset:34816
    v_mfma_f32_16x16x32_bf16 v[156:159], v[36:39], v[84:87], v[156:159]
    ds_read_b64_tr_b16 v[28:29], v129 offset:36864
    v_mfma_f32_16x16x32_bf16 v[152:155], v[32:35], v[116:119], v[152:155]
    ds_read_b64_tr_b16 v[30:31], v129 offset:38912
    v_mfma_f32_16x16x32_bf16 v[152:155], v[36:39], v[80:83], v[152:155]
    ds_read_b64_tr_b16 v[32:33], v128 offset:43008
    s_waitcnt lgkmcnt(5)
    v_mfma_f32_16x16x32_bf16 v[152:155], v[136:139], v[120:123], v[152:155]
    ds_read_b64_tr_b16 v[34:35], v128 offset:40960
    s_setprio 1
    v_mfma_f32_16x16x32_bf16 v[152:155], v[140:143], v[88:91], v[152:155]
    s_waitcnt vmcnt(7)
    s_barrier
    ds_read_b64_tr_b16 v[36:37], v129 offset:43008
    v_mfma_f32_16x16x32_bf16 v[156:159], v[136:139], v[192:195], v[156:159]
    ds_read_b64_tr_b16 v[38:39], v129 offset:40960
    v_mfma_f32_16x16x32_bf16 v[156:159], v[140:143], v[92:95], v[156:159]
    v_lshlrev_b32 v205, 2, v22
    buffer_load_dword v204, v205, s[48:51], 0 offen sc1
    s_add_u32 m0, s78, 131072
    s_add_u32 s90, s82, 111488
    buffer_load_dwordx4 v20, s[40:43], s90 offen  lds
    v_cvt_pk_bf16_f32 v242, v160, v161
    v_cvt_pk_bf16_f32 v243, v162, v163
    v_cvt_pk_bf16_f32 v240, v164, v165
    v_cvt_pk_bf16_f32 v241, v166, v167
    s_add_u32 m0, s78, 135168
    s_add_u32 s90, s82, 148352
    buffer_load_dwordx4 v20, s[40:43], s90 offen  lds
    v_cvt_pk_bf16_f32 v246, v168, v169
    v_cvt_pk_bf16_f32 v247, v170, v171
    v_cvt_pk_bf16_f32 v244, v172, v173
    v_cvt_pk_bf16_f32 v245, v174, v175
    s_add_u32 m0, s78, 139264
    s_add_u32 s90, s82, 185216
    buffer_load_dwordx4 v20, s[40:43], s90 offen  lds
    s_add_u32 s91, s86, 16384
    buffer_store_dwordx4 v[220:223], v0, s[44:47], s91 offen sc1
    v_mov_b32 v6, 0
    v_mov_b32 v7, 0
    v_mov_b32 v8, 0
    v_mov_b32 v9, 0
    v_mov_b32 v10, 0
    v_mov_b32 v11, 0
    v_mov_b32 v12, 0
    v_mov_b32 v13, 0
    v_mov_b32 v14, 0
    v_mov_b32 v15, 0
    v_mov_b32 v16, 0
    v_mov_b32 v17, 0
    v_mov_b32 v18, 0
    v_mov_b32 v19, 0
    v_mov_b32 v21, 0
    s_setprio 0
    ds_read_b64_tr_b16 v[136:137], v128 offset:45056
    s_waitcnt lgkmcnt(5)
    v_mfma_f32_16x16x32_bf16 v[156:159], v[24:27], v[196:199], v[156:159]
    ds_read_b64_tr_b16 v[138:139], v128 offset:47104
    v_mfma_f32_16x16x32_bf16 v[156:159], v[28:31], v[100:103], v[156:159]
    ds_read_b64_tr_b16 v[140:141], v128 offset:49152
    v_mfma_f32_16x16x32_bf16 v[152:155], v[24:27], v[124:127], v[152:155]
    ds_read_b64_tr_b16 v[142:143], v128 offset:51200
    v_mfma_f32_16x16x32_bf16 v[152:155], v[28:31], v[96:99], v[152:155]
    ds_read_b64_tr_b16 v[24:25], v128 offset:53248
    s_waitcnt lgkmcnt(7)
    v_mfma_f32_16x16x32_bf16 v[144:147], v[32:35], v[104:107], v[144:147]
    ds_read_b64_tr_b16 v[26:27], v128 offset:55296
    v_mfma_f32_16x16x32_bf16 v[148:151], v[32:35], v[108:111], v[148:151]
    ds_read_b64_tr_b16 v[28:29], v128 offset:57344
    s_waitcnt lgkmcnt(7)
    v_mfma_f32_16x16x32_bf16 v[152:155], v[36:39], v[104:107], v[152:155]
    ds_read_b64_tr_b16 v[30:31], v128 offset:59392
    v_mfma_f32_16x16x32_bf16 v[156:159], v[36:39], v[108:111], v[156:159]
    ds_read_b64_tr_b16 v[32:33], v128 offset:61440
    s_waitcnt lgkmcnt(5)
    v_mfma_f32_16x16x32_bf16 v[160:163], v[136:139], v[112:115], 0
    ds_read_b64_tr_b16 v[34:35], v128 offset:63488
    v_mfma_f32_16x16x32_bf16 v[160:163], v[140:143], v[72:75], v[160:163]
    ds_read_b64_tr_b16 v[36:37], v130
    v_mfma_f32_16x16x32_bf16 v[164:167], v[136:139], v[184:187], 0
    ds_read_b64_tr_b16 v[38:39], v130 offset:2048
    v_mfma_f32_16x16x32_bf16 v[164:167], v[140:143], v[76:79], v[164:167]
    ds_read_b64_tr_b16 v[136:137], v130 offset:4096
    s_waitcnt lgkmcnt(5)
    v_mfma_f32_16x16x32_bf16 v[164:167], v[24:27], v[188:191], v[164:167]
    ds_read_b64_tr_b16 v[138:139], v130 offset:6144
    v_mfma_f32_16x16x32_bf16 v[164:167], v[28:31], v[84:87], v[164:167]
    ds_read_b64_tr_b16 v[140:141], v130 offset:8192
    v_mfma_f32_16x16x32_bf16 v[160:163], v[24:27], v[116:119], v[160:163]
    ds_read_b64_tr_b16 v[142:143], v130 offset:10240
    v_mfma_f32_16x16x32_bf16 v[160:163], v[28:31], v[80:83], v[160:163]
    ds_read_b64_tr_b16 v[24:25], v129 offset:45056
    s_waitcnt lgkmcnt(5)
    v_mfma_f32_16x16x32_bf16 v[160:163], v[32:35], v[120:123], v[160:163]
    ds_read_b64_tr_b16 v[26:27], v129 offset:47104
    v_mfma_f32_16x16x32_bf16 v[160:163], v[36:39], v[88:91], v[160:163]
    ds_read_b64_tr_b16 v[28:29], v129 offset:49152
    v_mfma_f32_16x16x32_bf16 v[164:167], v[32:35], v[192:195], v[164:167]
    ds_read_b64_tr_b16 v[30:31], v129 offset:51200
    v_mfma_f32_16x16x32_bf16 v[164:167], v[36:39], v[92:95], v[164:167]
    ds_read_b64_tr_b16 v[32:33], v129 offset:53248
    s_waitcnt lgkmcnt(5)
    v_mfma_f32_16x16x32_bf16 v[164:167], v[136:139], v[196:199], v[164:167]
    ds_read_b64_tr_b16 v[34:35], v129 offset:55296
    v_mfma_f32_16x16x32_bf16 v[164:167], v[140:143], v[100:103], v[164:167]
    ds_read_b64_tr_b16 v[36:37], v129 offset:57344
    v_mfma_f32_16x16x32_bf16 v[160:163], v[136:139], v[124:127], v[160:163]
    ds_read_b64_tr_b16 v[38:39], v129 offset:59392
    v_mfma_f32_16x16x32_bf16 v[160:163], v[140:143], v[96:99], v[160:163]
    ds_read_b64_tr_b16 v[136:137], v129 offset:61440
    s_waitcnt lgkmcnt(5)
    v_mfma_f32_16x16x32_bf16 v[168:171], v[24:27], v[112:115], 0
    ds_read_b64_tr_b16 v[138:139], v129 offset:63488
    v_mfma_f32_16x16x32_bf16 v[168:171], v[28:31], v[72:75], v[168:171]
    ds_read_b64_tr_b16 v[140:141], v131
    v_mfma_f32_16x16x32_bf16 v[172:175], v[24:27], v[184:187], 0
    ds_read_b64_tr_b16 v[142:143], v131 offset:2048
    v_mfma_f32_16x16x32_bf16 v[172:175], v[28:31], v[76:79], v[172:175]
    ds_read_b64_tr_b16 v[24:25], v131 offset:4096
    s_waitcnt lgkmcnt(5)
    v_mfma_f32_16x16x32_bf16 v[172:175], v[32:35], v[188:191], v[172:175]
    ds_read_b64_tr_b16 v[26:27], v131 offset:6144
    v_mfma_f32_16x16x32_bf16 v[172:175], v[36:39], v[84:87], v[172:175]
    ds_read_b64_tr_b16 v[28:29], v131 offset:8192
    v_mfma_f32_16x16x32_bf16 v[168:171], v[32:35], v[116:119], v[168:171]
    ds_read_b64_tr_b16 v[30:31], v131 offset:10240
    v_mfma_f32_16x16x32_bf16 v[168:171], v[36:39], v[80:83], v[168:171]
    ds_read_b64_tr_b16 v[32:33], v130 offset:14336
    s_waitcnt lgkmcnt(5)
    v_mfma_f32_16x16x32_bf16 v[168:171], v[136:139], v[120:123], v[168:171]
    ds_read_b64_tr_b16 v[34:35], v130 offset:12288
    s_setprio 1
    v_mfma_f32_16x16x32_bf16 v[168:171], v[140:143], v[88:91], v[168:171]
    s_waitcnt vmcnt(6)
    s_barrier
    ds_read_b64_tr_b16 v[36:37], v131 offset:14336
    v_mfma_f32_16x16x32_bf16 v[172:175], v[136:139], v[192:195], v[172:175]
    ds_read_b64_tr_b16 v[38:39], v131 offset:12288
    v_mfma_f32_16x16x32_bf16 v[172:175], v[140:143], v[92:95], v[172:175]
    s_waitcnt vmcnt(4)
    v_cmp_eq_u32 vcc, 0, v204
    s_nop 0
    s_cmp_lg_u64 vcc, 0
    s_cbranch_scc1 L_far_21
L_back_22:
    v_readlane_b32 s68, v204, 2
    s_nop 0
    s_andn2_b32 s68, s68, 15
    s_add_u32 m0, s78, 8192
    s_add_u32 s90, s78, 8192
    buffer_load_dwordx4 v0, s[44:47], s90 offen sc1 lds
    v_cvt_pk_bf16_f32 v250, v144, v145
    v_cvt_pk_bf16_f32 v251, v146, v147
    s_add_u32 m0, s78, 16384
    s_add_u32 s90, s78, 16384
    buffer_load_dwordx4 v0, s[44:47], s90 offen sc1 lds
    v_cvt_pk_bf16_f32 v248, v148, v149
    v_cvt_pk_bf16_f32 v249, v150, v151
    s_add_u32 m0, s78, 24576
    s_add_u32 s90, s78, 24576
    buffer_load_dwordx4 v0, s[44:47], s90 offen sc1 lds
    v_cvt_pk_bf16_f32 v254, v152, v153
    v_cvt_pk_bf16_f32 v255, v154, v155
    v_cvt_pk_bf16_f32 v252, v156, v157
    s_add_u32 m0, s78, 32768
    s_add_u32 s90, s78, 32768
    buffer_load_dwordx4 v0, s[44:47], s90 offen sc1 lds
    v_cvt_pk_bf16_f32 v253, v158, v159
    s_add_u32 s91, s86, 65536
    buffer_store_dwordx4 v[224:227], v0, s[44:47], s91 offen sc1
    s_add_u32 m0, s78, 40960
    s_add_u32 s90, s78, 40960
    buffer_load_dwordx4 v0, s[44:47], s90 offen sc1 lds
    v_max_u32_dpp v204, v204, v204 row_ror:8 row_mask:0xf bank_mask:0xf
    s_nop 1
    v_max_u32_dpp v204, v204, v204 row_ror:4 row_mask:0xf bank_mask:0xf
    v_mov_b32 v200, v204
    s_add_u32 m0, s78, 49152
    s_add_u32 s90, s78, 49152
    buffer_load_dwordx4 v0, s[44:47], s90 offen sc1 lds
    v_permlane32_swap_b32 v200, v204
    v_max_u32 v204, v204, v200
    v_mov_b32 v200, v204
    s_nop 1
    v_permlane16_swap_b32 v200, v204
    v_max_u32 v204, v204, v200
    s_nop 0
    v_readlane_b32 s88, v204, 0
    v_readlane_b32 s89, v204, 1
    s_nop 0
    v_mov_b32 v200, s88
    v_add_f32 v200, s89, v200
    v_mul_f32 v200, v200, v23
    v_sqrt_f32 v200, v200
    v_mov_b32 v201, 0x3c23d70a
    v_fmamk_f32 v200, v200, 0x3f828f5c, v201
    v_mov_b32 v201, 0x42200000
    v_cmp_nle_f32 s[94:95], v200, v201
    v_mov_b32 v201, 0
    v_cvt_pk_bf16_f32 v200, -v200, v201
    v_cmp_gt_u32 vcc, 32, v22
    s_nop 1
    v_cndmask_b32 v45, 0, v200, vcc
    v_cndmask_b32 v47, v200, v201, vcc
    s_setprio 0
    ds_read_b64_tr_b16 v[136:137], v130 offset:16384
    s_waitcnt lgkmcnt(5)
    v_mfma_f32_16x16x32_bf16 v[172:175], v[24:27], v[196:199], v[172:175]
    ds_read_b64_tr_b16 v[138:139], v130 offset:18432
    v_mfma_f32_16x16x32_bf16 v[172:175], v[28:31], v[100:103], v[172:175]
    ds_read_b64_tr_b16 v[140:141], v130 offset:20480
    v_mfma_f32_16x16x32_bf16 v[168:171], v[24:27], v[124:127], v[168:171]
    ds_read_b64_tr_b16 v[142:143], v130 offset:22528
    v_mfma_f32_16x16x32_bf16 v[168:171], v[28:31], v[96:99], v[168:171]
    ds_read_b64_tr_b16 v[24:25], v130 offset:24576
    s_waitcnt lgkmcnt(7)
    v_mfma_f32_16x16x32_bf16 v[160:163], v[32:35], v[104:107], v[160:163]
    ds_read_b64_tr_b16 v[26:27], v130 offset:26624
    v_mfma_f32_16x16x32_bf16 v[164:167], v[32:35], v[108:111], v[164:167]
    ds_read_b64_tr_b16 v[28:29], v130 offset:28672
    s_waitcnt lgkmcnt(7)
    v_mfma_f32_16x16x32_bf16 v[168:171], v[36:39], v[104:107], v[168:171]
    ds_read_b64_tr_b16 v[30:31], v130 offset:30720
    v_mfma_f32_16x16x32_bf16 v[172:175], v[36:39], v[108:111], v[172:175]
    ds_read_b64_tr_b16 v[32:33], v130 offset:32768
    s_waitcnt lgkmcnt(5)
    v_mfma_f32_16x16x32_bf16 v[144:147], v[136:139], v[112:115], 0
    ds_read_b64_tr_b16 v[34:35], v130 offset:34816
    v_mfma_f32_16x16x32_bf16 v[144:147], v[140:143], v[72:75], v[144:147]
    ds_read_b64_tr_b16 v[36:37], v130 offset:36864
    v_mfma_f32_16x16x32_bf16 v[148:151], v[136:139], v[184:187], 0
    ds_read_b64_tr_b16 v[38:39], v130 offset:38912
    v_mfma_f32_16x16x32_bf16 v[148:151], v[140:143], v[76:79], v[148:151]
    ds_read_b64_tr_b16 v[136:137], v130 offset:40960
    s_waitcnt lgkmcnt(5)
    v_mfma_f32_16x16x32_bf16 v[148:151], v[24:27], v[188:191], v[148:151]
    ds_read_b64_tr_b16 v[138:139], v130 offset:43008
    v_mfma_f32_16x16x32_bf16 v[148:151], v[28:31], v[84:87], v[148:151]
    ds_read_b64_tr_b16 v[140:141], v130 offset:45056
    v_mfma_f32_16x16x32_bf16 v[144:147], v[24:27], v[116:119], v[144:147]
    ds_read_b64_tr_b16 v[142:143], v130 offset:47104
    v_mfma_f32_16x16x32_bf16 v[144:147], v[28:31], v[80:83], v[144:147]
    ds_read_b64_tr_b16 v[24:25], v131 offset:16384
    s_waitcnt lgkmcnt(5)
    v_mfma_f32_16x16x32_bf16 v[144:147], v[32:35], v[120:123], v[144:147]
    ds_read_b64_tr_b16 v[26:27], v131 offset:18432
    v_mfma_f32_16x16x32_bf16 v[144:147], v[36:39], v[88:91], v[144:147]
    ds_read_b64_tr_b16 v[28:29], v131 offset:20480
    v_mfma_f32_16x16x32_bf16 v[148:151], v[32:35], v[192:195], v[148:151]
    ds_read_b64_tr_b16 v[30:31], v131 offset:22528
    v_mfma_f32_16x16x32_bf16 v[148:151], v[36:39], v[92:95], v[148:151]
    ds_read_b64_tr_b16 v[32:33], v131 offset:24576
    s_waitcnt lgkmcnt(5)
    v_mfma_f32_16x16x32_bf16 v[148:151], v[136:139], v[196:199], v[148:151]
    ds_read_b64_tr_b16 v[34:35], v131 offset:26624
    v_mfma_f32_16x16x32_bf16 v[148:151], v[140:143], v[100:103], v[148:151]
    ds_read_b64_tr_b16 v[36:37], v131 offset:28672
    v_mfma_f32_16x16x32_bf16 v[144:147], v[136:139], v[124:127], v[144:147]
    ds_read_b64_tr_b16 v[38:39], v131 offset:30720
    v_mfma_f32_16x16x32_bf16 v[144:147], v[140:143], v[96:99], v[144:147]
    ds_read_b64_tr_b16 v[136:137], v131 offset:32768
    s_waitcnt lgkmcnt(5)
    v_mfma_f32_16x16x32_bf16 v[152:155], v[24:27], v[112:115], 0
    ds_read_b64_tr_b16 v[138:139], v131 offset:34816
    v_mfma_f32_16x16x32_bf16 v[152:155], v[28:31], v[72:75], v[152:155]
    ds_read_b64_tr_b16 v[140:141], v131 offset:36864
    v_mfma_f32_16x16x32_bf16 v[156:159], v[24:27], v[184:187], 0
    ds_read_b64_tr_b16 v[142:143], v131 offset:38912
    v_mfma_f32_16x16x32_bf16 v[156:159], v[28:31], v[76:79], v[156:159]
    ds_read_b64_tr_b16 v[24:25], v131 offset:40960
    s_waitcnt lgkmcnt(5)
    v_mfma_f32_16x16x32_bf16 v[156:159], v[32:35], v[188:191], v[156:159]
    ds_read_b64_tr_b16 v[26:27], v131 offset:43008
    v_mfma_f32_16x16x32_bf16 v[156:159], v[36:39], v[84:87], v[156:159]
    ds_read_b64_tr_b16 v[28:29], v131 offset:45056
    v_mfma_f32_16x16x32_bf16 v[152:155], v[32:35], v[116:119], v[152:155]
    ds_read_b64_tr_b16 v[30:31], v131 offset:47104
    v_mfma_f32_16x16x32_bf16 v[152:155], v[36:39], v[80:83], v[152:155]
    ds_read_b64_tr_b16 v[32:33], v130 offset:51200
    s_waitcnt lgkmcnt(5)
    v_mfma_f32_16x16x32_bf16 v[152:155], v[136:139], v[120:123], v[152:155]
    ds_read_b64_tr_b16 v[34:35], v130 offset:49152
L_page6:
    s_cbranch_execz L_probed
    s_setprio 1
    v_mfma_f32_16x16x32_bf16 v[152:155], v[140:143], v[88:91], v[152:155]
    s_waitcnt vmcnt(8)
    s_barrier
    ds_read_b64_tr_b16 v[36:37], v131 offset:51200
    v_mfma_f32_16x16x32_bf16 v[156:159], v[136:139], v[192:195], v[156:159]
    ds_read_b64_tr_b16 v[38:39], v131 offset:49152
    v_mfma_f32_16x16x32_bf16 v[156:159], v[140:143], v[92:95], v[156:159]
    s_add_u32 m0, s78, 57344
    s_add_u32 s90, s78, 57344
    buffer_load_dwordx4 v0, s[44:47], s90 offen sc1 lds
    s_add_u32 m0, s78, 65536
    s_add_u32 s90, s78, 65536
    buffer_load_dwordx4 v0, s[44:47], s90 offen sc1 lds
    v_cvt_pk_bf16_f32 v210, v160, v161
    s_add_u32 m0, s78, 73728
    s_add_u32 s90, s78, 73728
    buffer_load_dwordx4 v0, s[44:47], s90 offen sc1 lds
    v_cvt_pk_bf16_f32 v211, v162, v163
    s_add_u32 m0, s78, 81920
    s_add_u32 s90, s78, 81920
    buffer_load_dwordx4 v0, s[44:47], s90 offen sc1 lds
    v_cvt_pk_bf16_f32 v208, v164, v165
    s_add_u32 m0, s78, 90112
    s_add_u32 s90, s78, 90112
    buffer_load_dwordx4 v0, s[44:47], s90 offen sc1 lds
    v_cvt_pk_bf16_f32 v209, v166, v167
    s_add_u32 m0, s78, 98304
    s_add_u32 s90, s78, 98304
    buffer_load_dwordx4 v0, s[44:47], s90 offen sc1 lds
    v_cvt_pk_bf16_f32 v214, v168, v169
    v_cvt_pk_bf16_f32 v215, v170, v171
    v_cvt_pk_bf16_f32 v212, v172, v173
    v_cvt_pk_bf16_f32 v213, v174, v175
    s_add_u32 s91, s86, 81920
    buffer_store_dwordx4 v[228:231], v0, s[44:47], s91 offen sc1
    v_mov_b32 v20, 0
    s_setprio 0
    ds_read_b64_tr_b16 v[136:137], v130 offset:53248
    s_waitcnt lgkmcnt(5)
    v_mfma_f32_16x16x32_bf16 v[156:159], v[24:27], v[196:199], v[156:159]
    ds_read_b64_tr_b16 v[138:139], v130 offset:55296
    v_mfma_f32_16x16x32_bf16 v[156:159], v[28:31], v[100:103], v[156:159]
    ds_read_b64_tr_b16 v[140:141], v130 offset:57344
    v_mfma_f32_16x16x32_bf16 v[152:155], v[24:27], v[124:127], v[152:155]
    ds_read_b64_tr_b16 v[142:143], v130 offset:59392
    v_mfma_f32_16x16x32_bf16 v[152:155], v[28:31], v[96:99], v[152:155]
    ds_read_b64_tr_b16 v[24:25], v130 offset:61440
    s_waitcnt lgkmcnt(7)
    v_mfma_f32_16x16x32_bf16 v[144:147], v[32:35], v[104:107], v[144:147]
    ds_read_b64_tr_b16 v[26:27], v130 offset:63488
    v_mfma_f32_16x16x32_bf16 v[148:151], v[32:35], v[108:111], v[148:151]
    ds_read_b64_tr_b16 v[28:29], v132
    s_waitcnt lgkmcnt(7)
    v_mfma_f32_16x16x32_bf16 v[152:155], v[36:39], v[104:107], v[152:155]
    ds_read_b64_tr_b16 v[30:31], v132 offset:2048
    v_mfma_f32_16x16x32_bf16 v[156:159], v[36:39], v[108:111], v[156:159]
    ds_read_b64_tr_b16 v[32:33], v132 offset:4096
    s_waitcnt lgkmcnt(5)
    v_mfma_f32_16x16x32_bf16 v[160:163], v[136:139], v[112:115], 0
    ds_read_b64_tr_b16 v[34:35], v132 offset:6144
    v_mfma_f32_16x16x32_bf16 v[160:163], v[140:143], v[72:75], v[160:163]
    ds_read_b64_tr_b16 v[36:37], v132 offset:8192
    v_mfma_f32_16x16x32_bf16 v[164:167], v[136:139], v[184:187], 0
    ds_read_b64_tr_b16 v[38:39], v132 offset:10240
    v_mfma_f32_16x16x32_bf16 v[164:167], v[140:143], v[76:79], v[164:167]
    ds_read_b64_tr_b16 v[136:137], v132 offset:12288
    s_waitcnt lgkmcnt(5)
    v_mfma_f32_16x16x32_bf16 v[164:167], v[24:27], v[188:191], v[164:167]
    ds_read_b64_tr_b16 v[138:139], v132 offset:14336
    v_mfma_f32_16x16x32_bf16 v[164:167], v[28:31], v[84:87], v[164:167]
    ds_read_b64_tr_b16 v[140:141], v128
    v_mfma_f32_16x16x32_bf16 v[160:163], v[24:27], v[116:119], v[160:163]
    ds_read_b64_tr_b16 v[142:143], v128 offset:2048
    v_mfma_f32_16x16x32_bf16 v[160:163], v[28:31], v[80:83], v[160:163]
    ds_read_b64_tr_b16 v[24:25], v131 offset:53248
    s_waitcnt lgkmcnt(5)
    v_mfma_f32_16x16x32_bf16 v[160:163], v[32:35], v[120:123], v[160:163]
    ds_read_b64_tr_b16 v[26:27], v131 offset:55296
    v_mfma_f32_16x16x32_bf16 v[160:163], v[36:39], v[88:91], v[160:163]
    ds_read_b64_tr_b16 v[28:29], v131 offset:57344
    v_mfma_f32_16x16x32_bf16 v[164:167], v[32:35], v[192:195], v[164:167]
    ds_read_b64_tr_b16 v[30:31], v131 offset:59392
    v_mfma_f32_16x16x32_bf16 v[164:167], v[36:39], v[92:95], v[164:167]
    ds_read_b64_tr_b16 v[32:33], v131 offset:61440
    s_waitcnt lgkmcnt(5)
    v_mfma_f32_16x16x32_bf16 v[164:167], v[136:139], v[196:199], v[164:167]
    ds_read_b64_tr_b16 v[34:35], v131 offset:63488
    v_mfma_f32_16x16x32_bf16 v[164:167], v[140:143], v[100:103], v[164:167]
    ds_read_b64_tr_b16 v[36:37], v133
    v_mfma_f32_16x16x32_bf16 v[160:163], v[136:139], v[124:127], v[160:163]
    ds_read_b64_tr_b16 v[38:39], v133 offset:2048
    v_mfma_f32_16x16x32_bf16 v[160:163], v[140:143], v[96:99], v[160:163]
    ds_read_b64_tr_b16 v[136:137], v133 offset:4096
    s_waitcnt lgkmcnt(5)
    v_mfma_f32_16x16x32_bf16 v[168:171], v[24:27], v[112:115], 0
    ds_read_b64_tr_b16 v[138:139], v133 offset:6144
    v_mfma_f32_16x16x32_bf16 v[168:171], v[28:31], v[72:75], v[168:171]
    ds_read_b64_tr_b16 v[140:141], v133 offset:8192
    v_mfma_f32_16x16x32_bf16 v[172:175], v[24:27], v[184:187], 0
    ds_read_b64_tr_b16 v[142:143], v133 offset:10240
    v_mfma_f32_16x16x32_bf16 v[172:175], v[28:31], v[76:79], v[172:175]
    ds_read_b64_tr_b16 v[24:25], v133 offset:12288
    s_waitcnt lgkmcnt(5)
    v_mfma_f32_16x16x32_bf16 v[172:175], v[32:35], v[188:191], v[172:175]
    ds_read_b64_tr_b16 v[26:27], v133 offset:14336
    v_mfma_f32_16x16x32_bf16 v[172:175], v[36:39], v[84:87], v[172:175]
    ds_read_b64_tr_b16 v[28:29], v129
    v_mfma_f32_16x16x32_bf16 v[168:171], v[32:35], v[116:119], v[168:171]
    ds_read_b64_tr_b16 v[30:31], v129 offset:2048
    v_mfma_f32_16x16x32_bf16 v[168:171], v[36:39], v[80:83], v[168:171]
    ds_read_b64_tr_b16 v[32:33], v128 offset:6144
    s_waitcnt lgkmcnt(5)
    v_mfma_f32_16x16x32_bf16 v[168:171], v[136:139], v[120:123], v[168:171]
    ds_read_b64_tr_b16 v[34:35], v128 offset:4096
    v_mfma_f32_16x16x32_bf16 v[168:171], v[140:143], v[88:91], v[168:171]
    ds_read_b64_tr_b16 v[36:37], v129 offset:6144
    v_mfma_f32_16x16x32_bf16 v[172:175], v[136:139], v[192:195], v[172:175]
    v_cvt_pk_bf16_f32 v218, v144, v145
    ds_read_b64_tr_b16 v[38:39], v129 offset:4096
    v_mfma_f32_16x16x32_bf16 v[172:175], v[140:143], v[92:95], v[172:175]
    v_cvt_pk_bf16_f32 v219, v146, v147
    s_waitcnt lgkmcnt(4)
    v_mfma_f32_16x16x32_bf16 v[172:175], v[24:27], v[196:199], v[172:175]
    v_cvt_pk_bf16_f32 v216, v148, v149
    v_mfma_f32_16x16x32_bf16 v[172:175], v[28:31], v[100:103], v[172:175]
    v_cvt_pk_bf16_f32 v217, v150, v151
    v_mfma_f32_16x16x32_bf16 v[168:171], v[24:27], v[124:127], v[168:171]
    v_cvt_pk_bf16_f32 v222, v152, v153
    v_mfma_f32_16x16x32_bf16 v[168:171], v[28:31], v[96:99], v[168:171]
    v_cvt_pk_bf16_f32 v223, v154, v155
    s_waitcnt lgkmcnt(2)
    v_mfma_f32_16x16x32_bf16 v[160:163], v[32:35], v[104:107], v[160:163]
    v_cvt_pk_bf16_f32 v220, v156, v157
    v_mfma_f32_16x16x32_bf16 v[164:167], v[32:35], v[108:111], v[164:167]
    v_cvt_pk_bf16_f32 v221, v158, v159
    s_waitcnt lgkmcnt(0)
    v_mfma_f32_16x16x32_bf16 v[168:171], v[36:39], v[104:107], v[168:171]
    s_setprio 1
    s_waitcnt vmcnt(7)
    s_barrier
    v_mfma_f32_16x16x32_bf16 v[172:175], v[36:39], v[108:111], v[172:175]
    v_cvt_pk_bf16_f32 v226, v160, v161
    v_cvt_pk_bf16_f32 v227, v162, v163
    v_cvt_pk_bf16_f32 v224, v164, v165
    v_cvt_pk_bf16_f32 v225, v166, v167
    v_cvt_pk_bf16_f32 v230, v168, v169
    v_cvt_pk_bf16_f32 v231, v170, v171
    s_nop 1
    v_cvt_pk_bf16_f32 v228, v172, v173
    v_cvt_pk_bf16_f32 v229, v174, v175
    s_setprio 0
    s_branch L_join
L_half0:
L_page1:
    s_cbranch_execz L_page5
    s_waitcnt lgkmcnt(0)
    s_barrier
    s_lshr_b32 s88, s76, 2
    s_cmp_eq_u32 s88, s73
    s_cbranch_scc0 L_skip_31
    ds_read_b128 v[84:87], v6 offset:2048
    ds_read_b128 v[88:91], v6 offset:2112
L_skip_31:
    ds_read_b128 v[112:115], v72
    ds_read_b128 v[184:187], v74
    ds_read_b128 v[116:119], v73
    ds_read_b128 v[188:191], v75
    ds_read_b128 v[40:43], v6
    ds_read_b128 v[48:51], v6 offset:64
    ds_read_b64_tr_b16 v[104:105], v2
    ds_read_b64_tr_b16 v[106:107], v2 offset:512
    ds_read_b64_tr_b16 v[108:109], v2 offset:4096
    ds_read_b64_tr_b16 v[110:111], v2 offset:4608
    ds_read_b64_tr_b16 v[24:25], v3
    ds_read_b64_tr_b16 v[26:27], v3 offset:512
    ds_read_b64_tr_b16 v[28:29], v3 offset:4096
    ds_read_b64_tr_b16 v[30:31], v3 offset:4608
    s_add_u32 m0, s78, 139264
    s_lshl_b32 s91, s81, 7
    s_add_u32 s91, s91, s77
    buffer_load_dwordx4 v76, s[32:35], s91 offen  lds
    s_add_u32 m0, s78, 147456
    s_add_u32 s91, s91, 73728
    buffer_load_dwordx4 v76, s[32:35], s91 offen  lds
    s_add_u32 m0, s78, 24576
    s_mul_i32 s60, s81, 589824
    s_add_u32 s60, s60, s79
    buffer_load_dwordx4 v7, s[36:39], s60 offen  lds
    s_add_u32 s81, s81, 1
    s_cmp_eq_u32 s81, 9
    s_cselect_b32 s81, 0, s81
    s_and_b32 s89, s76, 1
    s_mov_b32 s42, 5308416
    s_mov_b32 s43, 0x20000
    s_mov_b32 s50, 256
    s_mov_b32 s51, 0x20000
    s_mov_b32 s54, 2359296
    s_mov_b32 s55, 0x20000
    s_mov_b32 s58, 663552
    s_mov_b32 s59, 0x20000
    s_mov_b32 s66, 1152
    s_mov_b32 s67, 0x20000
    s_mul_i32 s88, s95, 576
    s_xor_b32 s3, s89, 1
    s_lshl_b32 s3, s3, 9
    s_add_u32 s88, s88, s3
    s_mul_i32 s80, s73, 147456
    s_add_u32 s80, s80, s88
    s_sub_u32 s80, s80, s79
    s_lshl4_add_u32 s88, s73, s88
    s_mul_i32 s83, s88, 576
    s_lshl4_add_u32 s88, s73, s86
    s_mul_i32 s82, s88, 576
    s_lshl2_add_u32 s88, s75, s73
    s_mul_i32 s86, s88, 589824
    s_lshl_b32 s3, s74, 15
    s_add_u32 s86, s86, s3
    s_lshl_b32 s3, s76, 10
    s_add_u32 s86, s86, s3
    s_add_u32 s86, s86, 0x400000
    s_lshl1_add_u32 s84, s88, s74
    s_lshl4_add_u32 s84, s84, s76
    s_lshl_b32 s84, s84, 5
    s_add_u32 s84, s84, 0x340000
    s_mul_i32 s87, s88, 36
    s_lshl1_add_u32 s87, s94, s87
    s_add_u32 s87, s87, s74
    s_lshl_b32 s87, s87, 10
    s_add_u32 s87, s87, 0x100000
    v_lshrrev_b32 v96, 5, v22
    v_bfe_u32 v97, v22, 3, 2
    v_mad_u32_u24 v96, v96, 18, v97
    s_mul_i32 s88, s76, 36
    s_lshl_b32 s89, s73, 2
    s_add_u32 s88, s88, s89
    s_mul_i32 s88, s88, 1152
    s_lshl_b32 s89, s75, 7
    s_add_u32 s68, s88, s89
    s_cmp_ge_u32 s75, 9
    s_cbranch_scc0 L_skip_50
    v_lshrrev_b32 v96, 5, v22
    v_bfe_u32 v97, v22, 4, 1
    v_lshl_add_u32 v96, v96, 2, v97
    v_bfe_u32 v97, v22, 3, 1
    v_mad_u32_u24 v96, v96, 18, v97
    s_sub_u32 s88, s75, 9
    s_lshl_b32 s88, s88, 1
    s_and_b32 s89, s73, 1
    s_add_u32 s88, s88, s89
    s_lshl_b32 s88, s88, 3
    s_and_b32 s89, s73, 2
    s_add_u32 s88, s88, s89
    s_mul_i32 s88, s88, 18
    s_add_u32 s88, s88, 16
    s_mul_i32 s88, s88, 1152
    s_lshl_b32 s89, s76, 7
    s_add_u32 s68, s88, s89
L_skip_50:
    v_mul_u32_u24 v96, 1152, v96
    v_add_u32 v101, v101, v96
    v_bfe_u32 v96, v22, 3, 2
    v_xor_b32 v96, s73, v96
    v_lshlrev_b32 v96, 5, v96
    v_and_b32 v97, 3, v22
    v_lshl_add_u32 v96, v97, 3, v96
    v_lshrrev_b32 v97, 2, v22
    v_lshl_add_u32 v96, v97, 7, v96
    v_add_u32 v102, 159744, v96
    s_add_u32 s88, s75, 7
    s_cmp_ge_u32 s75, 9
    s_cselect_b32 s88, s88, s76
    s_cselect_b32 s89, s76, s75
    s_lshl_b32 s89, s89, 2
    s_add_u32 s89, s89, s73
    s_mul_i32 s89, s89, 18
    s_add_u32 s88, s88, s89
    s_lshl_b32 s88, s88, 10
    s_add_u32 s69, s88, 0x40000
    s_cmp_lt_u32 s76, 9
    s_cselect_b32 s88, 11, 9
    s_cmp_lt_u32 s75, s88
    s_cselect_b32 s69, s69, 0x4000000
    s_cselect_b32 s68, s68, 663552
    s_mov_b64 exec, 0
    s_cmp_eq_u32 s73, 0
    s_cbranch_scc1 L_h0page0
    s_cmp_eq_u32 s73, 1
    s_cbranch_scc1 L_h0page1
    s_cmp_eq_u32 s73, 2
    s_cbranch_scc1 L_h0page2
    s_cmp_eq_u32 s73, 3
    s_cbranch_scc1 L_h0page3
L_probed0:
    s_mov_b64 exec, -1
    s_waitcnt vmcnt(6) lgkmcnt(10)
    s_barrier
    s_lshr_b32 s88, s76, 2
    s_cmp_eq_u32 s88, s73
    s_cbranch_scc0 L_skip_32
    v_mfma_f32_16x16x32_bf16 v[80:83], v[84:87], v[112:115], 0
    v_mfma_f32_16x16x32_bf16 v[80:83], v[88:91], v[116:119], v[80:83]
    ds_read_b128 v[84:87], v6 offset:2176
    ds_read_b128 v[88:91], v6 offset:2240
L_skip_32:
    ds_read_b128 v[120:123], v72 offset:16384
    ds_read_b128 v[192:195], v74 offset:16384
    ds_read_b128 v[124:127], v73 offset:16384
    ds_read_b128 v[196:199], v75 offset:16384
    ds_read_b64_tr_b16 v[32:33], v2 offset:8192
    s_waitcnt lgkmcnt(9)
    v_mfma_f32_16x16x32_bf16 v[44:47], v[104:107], v[184:187], v[40:43]
    ds_read_b64_tr_b16 v[34:35], v2 offset:8704
    v_mfma_f32_16x16x32_bf16 v[44:47], v[108:111], v[188:191], v[44:47]
    ds_read_b64_tr_b16 v[36:37], v2 offset:12288
    v_mfma_f32_16x16x32_bf16 v[40:43], v[104:107], v[112:115], v[40:43]
    ds_read_b64_tr_b16 v[38:39], v2 offset:12800
    v_mfma_f32_16x16x32_bf16 v[40:43], v[108:111], v[116:119], v[40:43]
    ds_read_b64_tr_b16 v[104:105], v3 offset:8192
    s_waitcnt lgkmcnt(9)
    v_mfma_f32_16x16x32_bf16 v[52:55], v[24:27], v[184:187], v[48:51]
    ds_read_b64_tr_b16 v[106:107], v3 offset:8704
    v_mfma_f32_16x16x32_bf16 v[52:55], v[28:31], v[188:191], v[52:55]
    ds_read_b64_tr_b16 v[108:109], v3 offset:12288
    v_mfma_f32_16x16x32_bf16 v[48:51], v[24:27], v[112:115], v[48:51]
    ds_read_b64_tr_b16 v[110:111], v3 offset:12800
    v_mfma_f32_16x16x32_bf16 v[48:51], v[28:31], v[116:119], v[48:51]
    s_add_u32 m0, s78, 90112
    s_lshl_b32 s91, s81, 7
    s_add_u32 s91, s91, s77
    buffer_load_dwordx4 v76, s[32:35], s91 offen  lds
    s_add_u32 m0, s78, 98304
    s_add_u32 s91, s91, 73728
    buffer_load_dwordx4 v76, s[32:35], s91 offen  lds
    s_add_u32 m0, s78, 32768
    s_mul_i32 s61, s81, 589824
    s_add_u32 s61, s61, s79
    buffer_load_dwordx4 v7, s[36:39], s61 offen  lds
    s_add_u32 s81, s81, 1
    s_cmp_eq_u32 s81, 9
    s_cselect_b32 s81, 0, s81
    s_waitcnt vmcnt(6) lgkmcnt(0)
    s_barrier
    ds_read_b64_tr_b16 v[24:25], v2 offset:16384
    v_mfma_f32_16x16x32_bf16 v[40:43], v[32:35], v[120:123], v[40:43]
    ds_read_b64_tr_b16 v[26:27], v2 offset:16896
    v_mfma_f32_16x16x32_bf16 v[40:43], v[36:39], v[124:127], v[40:43]
    ds_read_b64_tr_b16 v[28:29], v2 offset:20480
    v_mfma_f32_16x16x32_bf16 v[44:47], v[32:35], v[192:195], v[44:47]
    ds_read_b64_tr_b16 v[30:31], v2 offset:20992
    v_mfma_f32_16x16x32_bf16 v[44:47], v[36:39], v[196:199], v[44:47]
    ds_read_b64_tr_b16 v[32:33], v3 offset:16384
    v_mfma_f32_16x16x32_bf16 v[48:51], v[104:107], v[120:123], v[48:51]
    ds_read_b64_tr_b16 v[34:35], v3 offset:16896
    v_mfma_f32_16x16x32_bf16 v[48:51], v[108:111], v[124:127], v[48:51]
    ds_read_b64_tr_b16 v[36:37], v3 offset:20480
    v_mfma_f32_16x16x32_bf16 v[52:55], v[104:107], v[192:195], v[52:55]
    ds_read_b64_tr_b16 v[38:39], v3 offset:20992
    v_mfma_f32_16x16x32_bf16 v[52:55], v[108:111], v[196:199], v[52:55]
    ds_read_b128 v[128:131], v72 offset:32768
    ds_read_b128 v[200:203], v74 offset:32768
    ds_read_b128 v[132:135], v73 offset:32768
    ds_read_b128 v[204:207], v75 offset:32768
    s_lshr_b32 s88, s76, 2
    s_cmp_eq_u32 s88, s73
    s_cbranch_scc0 L_skip_33
    v_mfma_f32_16x16x32_bf16 v[80:83], v[84:87], v[120:123], v[80:83]
    v_mfma_f32_16x16x32_bf16 v[80:83], v[88:91], v[124:127], v[80:83]
    ds_read_b128 v[84:87], v6 offset:2304
    ds_read_b128 v[88:91], v6 offset:2368
L_skip_33:
    s_add_u32 m0, s78, 106496
    s_lshl_b32 s91, s81, 7
    s_add_u32 s91, s91, s77
    buffer_load_dwordx4 v76, s[32:35], s91 offen  lds
    s_add_u32 m0, s78, 114688
    s_add_u32 s91, s91, 73728
    buffer_load_dwordx4 v76, s[32:35], s91 offen  lds
    s_add_u32 m0, s78, 40960
    s_mul_i32 s62, s81, 589824
    s_add_u32 s62, s62, s79
    buffer_load_dwordx4 v7, s[36:39], s62 offen  lds
    s_add_u32 s81, s81, 1
    s_cmp_eq_u32 s81, 9
    s_cselect_b32 s81, 0, s81
    s_waitcnt vmcnt(6) lgkmcnt(0)
    s_barrier
    ds_read_b64_tr_b16 v[104:105], v2 offset:24576
    v_mfma_f32_16x16x32_bf16 v[40:43], v[24:27], v[128:131], v[40:43]
    ds_read_b64_tr_b16 v[106:107], v2 offset:25088
    v_mfma_f32_16x16x32_bf16 v[40:43], v[28:31], v[132:135], v[40:43]
    ds_read_b64_tr_b16 v[108:109], v2 offset:28672
    v_mfma_f32_16x16x32_bf16 v[44:47], v[24:27], v[200:203], v[44:47]
    ds_read_b64_tr_b16 v[110:111], v2 offset:29184
    v_mfma_f32_16x16x32_bf16 v[44:47], v[28:31], v[204:207], v[44:47]
    ds_read_b64_tr_b16 v[24:25], v3 offset:24576
    v_mfma_f32_16x16x32_bf16 v[48:51], v[32:35], v[128:131], v[48:51]
    ds_read_b64_tr_b16 v[26:27], v3 offset:25088
    v_mfma_f32_16x16x32_bf16 v[48:51], v[36:39], v[132:135], v[48:51]
    ds_read_b64_tr_b16 v[28:29], v3 offset:28672
    v_mfma_f32_16x16x32_bf16 v[52:55], v[32:35], v[200:203], v[52:55]
    ds_read_b64_tr_b16 v[30:31], v3 offset:29184
    v_mfma_f32_16x16x32_bf16 v[52:55], v[36:39], v[204:207], v[52:55]
    ds_read_b128 v[136:139], v72 offset:49152
    ds_read_b128 v[208:211], v74 offset:49152
    ds_read_b128 v[140:143], v73 offset:49152
    ds_read_b128 v[212:215], v75 offset:49152
    s_lshr_b32 s88, s76, 2
    s_cmp_eq_u32 s88, s73
    s_cbranch_scc0 L_skip_34
    s_waitcnt lgkmcnt(12)
    v_mfma_f32_16x16x32_bf16 v[80:83], v[84:87], v[128:131], v[80:83]
    s_waitcnt lgkmcnt(12)
    v_mfma_f32_16x16x32_bf16 v[80:83], v[88:91], v[132:135], v[80:83]
    ds_read_b128 v[84:87], v6 offset:2432
    ds_read_b128 v[88:91], v6 offset:2496
L_skip_34:
    s_add_u32 m0, s78, 122880
    s_lshl_b32 s91, s81, 7
    s_add_u32 s91, s91, s77
    buffer_load_dwordx4 v76, s[32:35], s91 offen  lds
    s_add_u32 m0, s78, 131072
    s_add_u32 s91, s91, 73728
    buffer_load_dwordx4 v76, s[32:35], s91 offen  lds
    s_add_u32 m0, s78, 49152
    s_mul_i32 s63, s81, 589824
    s_add_u32 s63, s63, s79
    buffer_load_dwordx4 v7, s[36:39], s63 offen  lds
    s_add_u32 s81, s81, 1
    s_cmp_eq_u32 s81, 9
    s_cselect_b32 s81, 0, s81
    s_waitcnt vmcnt(6) lgkmcnt(0)
    s_barrier
    ds_read_b64_tr_b16 v[32:33], v2 offset:32768
    v_mfma_f32_16x16x32_bf16 v[40:43], v[104:107], v[136:139], v[40:43]
    ds_read_b64_tr_b16 v[34:35], v2 offset:33280
    v_mfma_f32_16x16x32_bf16 v[40:43], v[108:111], v[140:143], v[40:43]
    ds_read_b64_tr_b16 v[36:37], v2 offset:36864
    v_mfma_f32_16x16x32_bf16 v[44:47], v[104:107], v[208:211], v[44:47]
    ds_read_b64_tr_b16 v[38:39], v2 offset:37376
    v_mfma_f32_16x16x32_bf16 v[44:47], v[108:111], v[212:215], v[44:47]
    ds_read_b64_tr_b16 v[104:105], v3 offset:32768
    v_mfma_f32_16x16x32_bf16 v[48:51], v[24:27], v[136:139], v[48:51]
    ds_read_b64_tr_b16 v[106:107], v3 offset:33280
    v_mfma_f32_16x16x32_bf16 v[48:51], v[28:31], v[140:143], v[48:51]
    ds_read_b64_tr_b16 v[108:109], v3 offset:36864
    v_mfma_f32_16x16x32_bf16 v[52:55], v[24:27], v[208:211], v[52:55]
    ds_read_b64_tr_b16 v[110:111], v3 offset:37376
    v_mfma_f32_16x16x32_bf16 v[52:55], v[28:31], v[212:215], v[52:55]
    ds_read_b128 v[144:147], v72
    ds_read_b128 v[216:219], v74
    ds_read_b128 v[148:151], v73
    ds_read_b128 v[220:223], v75
    s_lshr_b32 s88, s76, 2
    s_cmp_eq_u32 s88, s73
    s_cbranch_scc0 L_skip_35
    s_waitcnt lgkmcnt(12)
    v_mfma_f32_16x16x32_bf16 v[80:83], v[84:87], v[136:139], v[80:83]
    s_waitcnt lgkmcnt(12)
    v_mfma_f32_16x16x32_bf16 v[80:83], v[88:91], v[140:143], v[80:83]
    ds_read_b128 v[84:87], v6 offset:2560
    ds_read_b128 v[88:91], v6 offset:2624
L_skip_35:
    s_add_u32 m0, s78, 139264
    s_lshl_b32 s91, s81, 7
    s_add_u32 s91, s91, s77
    buffer_load_dwordx4 v76, s[32:35], s91 offen  lds
    s_add_u32 m0, s78, 147456
    s_add_u32 s91, s91, 73728
    buffer_load_dwordx4 v76, s[32:35], s91 offen  lds
    s_add_u32 m0, s78, 57344
    s_mul_i32 s70, s81, 589824
    s_add_u32 s70, s70, s79
    buffer_load_dwordx4 v7, s[36:39], s70 offen  lds
    s_add_u32 s81, s81, 1
    s_cmp_eq_u32 s81, 9
    s_cselect_b32 s81, 0, s81
    s_waitcnt vmcnt(6) lgkmcnt(0)
    s_barrier
    ds_read_b64_tr_b16 v[24:25], v2 offset:40960
    v_mfma_f32_16x16x32_bf16 v[40:43], v[32:35], v[144:147], v[40:43]
    ds_read_b64_tr_b16 v[26:27], v2 offset:41472
    v_mfma_f32_16x16x32_bf16 v[40:43], v[36:39], v[148:151], v[40:43]
    ds_read_b64_tr_b16 v[28:29], v2 offset:45056
    v_mfma_f32_16x16x32_bf16 v[44:47], v[32:35], v[216:219], v[44:47]
    ds_read_b64_tr_b16 v[30:31], v2 offset:45568
    v_mfma_f32_16x16x32_bf16 v[44:47], v[36:39], v[220:223], v[44:47]
    ds_read_b64_tr_b16 v[32:33], v3 offset:40960
    v_mfma_f32_16x16x32_bf16 v[48:51], v[104:107], v[144:147], v[48:51]
    ds_read_b64_tr_b16 v[34:35], v3 offset:41472
    v_mfma_f32_16x16x32_bf16 v[48:51], v[108:111], v[148:151], v[48:51]
    ds_read_b64_tr_b16 v[36:37], v3 offset:45056
    v_mfma_f32_16x16x32_bf16 v[52:55], v[104:107], v[216:219], v[52:55]
    ds_read_b64_tr_b16 v[38:39], v3 offset:45568
    v_mfma_f32_16x16x32_bf16 v[52:55], v[108:111], v[220:223], v[52:55]
    ds_read_b128 v[152:155], v72 offset:16384
    ds_read_b128 v[224:227], v74 offset:16384
    ds_read_b128 v[156:159], v73 offset:16384
    ds_read_b128 v[228:231], v75 offset:16384
    s_lshr_b32 s88, s76, 2
    s_cmp_eq_u32 s88, s73
    s_cbranch_scc0 L_skip_36
    s_waitcnt lgkmcnt(12)
    v_mfma_f32_16x16x32_bf16 v[80:83], v[84:87], v[144:147], v[80:83]
    s_waitcnt lgkmcnt(12)
    v_mfma_f32_16x16x32_bf16 v[80:83], v[88:91], v[148:151], v[80:83]
    ds_read_b128 v[84:87], v6 offset:2688
    ds_read_b128 v[88:91], v6 offset:2752
L_skip_36:
    s_add_u32 m0, s78, 90112
    s_lshl_b32 s91, s81, 7
    s_add_u32 s91, s91, s77
    buffer_load_dwordx4 v76, s[32:35], s91 offen  lds
    s_add_u32 m0, s78, 98304
    s_add_u32 s91, s91, 73728
    buffer_load_dwordx4 v76, s[32:35], s91 offen  lds
    s_add_u32 m0, s78, 65536
    s_mul_i32 s71, s81, 589824
    s_add_u32 s71, s71, s79
    buffer_load_dwordx4 v7, s[36:39], s71 offen  lds
    s_add_u32 s81, s81, 1
    s_cmp_eq_u32 s81, 9
    s_cselect_b32 s81, 0, s81
    s_waitcnt vmcnt(6) lgkmcnt(0)
    s_barrier
    ds_read_b64_tr_b16 v[104:105], v2 offset:49152
    v_mfma_f32_16x16x32_bf16 v[40:43], v[24:27], v[152:155], v[40:43]
    ds_read_b64_tr_b16 v[106:107], v2 offset:49664
    v_mfma_f32_16x16x32_bf16 v[40:43], v[28:31], v[156:159], v[40:43]
    ds_read_b64_tr_b16 v[108:109], v2 offset:53248
    v_mfma_f32_16x16x32_bf16 v[44:47], v[24:27], v[224:227], v[44:47]
    ds_read_b64_tr_b16 v[110:111], v2 offset:53760
    v_mfma_f32_16x16x32_bf16 v[44:47], v[28:31], v[228:231], v[44:47]
    ds_read_b64_tr_b16 v[24:25], v3 offset:49152
    v_mfma_f32_16x16x32_bf16 v[48:51], v[32:35], v[152:155], v[48:51]
    ds_read_b64_tr_b16 v[26:27], v3 offset:49664
    v_mfma_f32_16x16x32_bf16 v[48:51], v[36:39], v[156:159], v[48:51]
    ds_read_b64_tr_b16 v[28:29], v3 offset:53248
    v_mfma_f32_16x16x32_bf16 v[52:55], v[32:35], v[224:227], v[52:55]
    ds_read_b64_tr_b16 v[30:31], v3 offset:53760
    v_mfma_f32_16x16x32_bf16 v[52:55], v[36:39], v[228:231], v[52:55]
    ds_read_b128 v[160:163], v72 offset:32768
    ds_read_b128 v[232:235], v74 offset:32768
    ds_read_b128 v[164:167], v73 offset:32768
    ds_read_b128 v[236:239], v75 offset:32768
    s_lshr_b32 s88, s76, 2
    s_cmp_eq_u32 s88, s73
    s_cbranch_scc0 L_skip_37
    s_waitcnt lgkmcnt(12)
    v_mfma_f32_16x16x32_bf16 v[80:83], v[84:87], v[152:155], v[80:83]
    s_waitcnt lgkmcnt(12)
    v_mfma_f32_16x16x32_bf16 v[80:83], v[88:91], v[156:159], v[80:83]
    ds_read_b128 v[84:87], v6 offset:2816
    ds_read_b128 v[88:91], v6 offset:2880
L_skip_37:
    s_add_u32 m0, s78, 73728
    s_add_u32 s90, s0, 128
    buffer_load_dwordx4 v7, s[36:39], s90 offen  lds
    s_add_u32 m0, s78, 81920
    s_add_u32 s90, s1, 128
    buffer_load_dwordx4 v7, s[36:39], s90 offen  lds
    s_add_u32 m0, s78, 106496
    s_add_u32 s90, s92, 128
    buffer_load_dwordx4 v7, s[36:39], s90 offen  lds
    ds_read_b128 v[56:59], v6 offset:256
    s_waitcnt vmcnt(6) lgkmcnt(1)
    s_barrier
    ds_read_b64_tr_b16 v[32:33], v2 offset:57344
    v_mfma_f32_16x16x32_bf16 v[40:43], v[104:107], v[160:163], v[40:43]
    ds_read_b64_tr_b16 v[34:35], v2 offset:57856
    v_mfma_f32_16x16x32_bf16 v[40:43], v[108:111], v[164:167], v[40:43]
    ds_read_b64_tr_b16 v[36:37], v2 offset:61440
    v_mfma_f32_16x16x32_bf16 v[44:47], v[104:107], v[232:235], v[44:47]
    ds_read_b64_tr_b16 v[38:39], v2 offset:61952
    v_mfma_f32_16x16x32_bf16 v[44:47], v[108:111], v[236:239], v[44:47]
    ds_read_b64_tr_b16 v[104:105], v3 offset:57344
    v_mfma_f32_16x16x32_bf16 v[48:51], v[24:27], v[160:163], v[48:51]
    ds_read_b64_tr_b16 v[106:107], v3 offset:57856
    v_mfma_f32_16x16x32_bf16 v[48:51], v[28:31], v[164:167], v[48:51]
    ds_read_b64_tr_b16 v[108:109], v3 offset:61440
    v_mfma_f32_16x16x32_bf16 v[52:55], v[24:27], v[232:235], v[52:55]
    ds_read_b64_tr_b16 v[110:111], v3 offset:61952
    v_mfma_f32_16x16x32_bf16 v[52:55], v[28:31], v[236:239], v[52:55]
    ds_read_b128 v[168:171], v72 offset:49152
    ds_read_b128 v[240:243], v74 offset:49152
    ds_read_b128 v[172:175], v73 offset:49152
    ds_read_b128 v[244:247], v75 offset:49152
    s_lshr_b32 s88, s76, 2
    s_cmp_eq_u32 s88, s73
    s_cbranch_scc0 L_skip_38
    s_waitcnt lgkmcnt(13)
    v_mfma_f32_16x16x32_bf16 v[80:83], v[84:87], v[160:163], v[80:83]
    s_waitcnt lgkmcnt(13)
    v_mfma_f32_16x16x32_bf16 v[80:83], v[88:91], v[164:167], v[80:83]
    ds_read_b128 v[84:87], v6 offset:2944
    ds_read_b128 v[88:91], v6 offset:3008
L_skip_38:
    s_add_u32 m0, s78, 114688
    s_add_u32 s90, s60, 128
    buffer_load_dwordx4 v7, s[36:39], s90 offen  lds
    s_add_u32 m0, s78, 0
    s_add_u32 s90, s61, 128
    buffer_load_dwordx4 v7, s[36:39], s90 offen  lds
    ds_read_b128 v[64:67], v6 offset:320
    s_waitcnt vmcnt(5) lgkmcnt(1)
    s_barrier
    ds_read_b64_tr_b16 v[24:25], v4
    v_mfma_f32_16x16x32_bf16 v[40:43], v[32:35], v[168:171], v[40:43]
    ds_read_b64_tr_b16 v[26:27], v4 offset:512
    v_mfma_f32_16x16x32_bf16 v[40:43], v[36:39], v[172:175], v[40:43]
    ds_read_b64_tr_b16 v[28:29], v4 offset:4096
    v_mfma_f32_16x16x32_bf16 v[44:47], v[32:35], v[240:243], v[44:47]
    ds_read_b64_tr_b16 v[30:31], v4 offset:4608
    v_mfma_f32_16x16x32_bf16 v[44:47], v[36:39], v[244:247], v[44:47]
    ds_read_b64_tr_b16 v[32:33], v5
L_page7:
    s_cbranch_execz L_probed
    v_mfma_f32_16x16x32_bf16 v[48:51], v[104:107], v[168:171], v[48:51]
    ds_read_b64_tr_b16 v[34:35], v5 offset:512
    v_mfma_f32_16x16x32_bf16 v[48:51], v[108:111], v[172:175], v[48:51]
    ds_read_b64_tr_b16 v[36:37], v5 offset:4096
    v_mfma_f32_16x16x32_bf16 v[52:55], v[104:107], v[240:243], v[52:55]
    ds_read_b64_tr_b16 v[38:39], v5 offset:4608
    v_mfma_f32_16x16x32_bf16 v[52:55], v[108:111], v[244:247], v[52:55]
    ds_read_b128 v[176:179], v72
    ds_read_b128 v[248:251], v74
    ds_read_b128 v[180:183], v73
    ds_read_b128 v[252:255], v75
    s_lshr_b32 s88, s76, 2
    s_cmp_eq_u32 s88, s73
    s_cbranch_scc0 L_skip_39
    s_waitcnt lgkmcnt(13)
    v_mfma_f32_16x16x32_bf16 v[80:83], v[84:87], v[168:171], v[80:83]
    s_waitcnt lgkmcnt(13)
    v_mfma_f32_16x16x32_bf16 v[80:83], v[88:91], v[172:175], v[80:83]
    ds_read_b128 v[84:87], v6 offset:3072
    ds_read_b128 v[88:91], v6 offset:3136
L_skip_39:
    s_add_u32 m0, s78, 8192
    s_add_u32 s90, s62, 128
    buffer_load_dwordx4 v7, s[36:39], s90 offen  lds
    s_add_u32 m0, s78, 16384
    s_add_u32 s90, s63, 128
    buffer_load_dwordx4 v7, s[36:39], s90 offen  lds
    s_add_u32 m0, s78, 24576
    s_add_u32 s90, s70, 128
    buffer_load_dwordx4 v7, s[36:39], s90 offen  lds
    s_waitcnt vmcnt(5) lgkmcnt(0)
    s_barrier
    ds_read_b64_tr_b16 v[104:105], v4 offset:8192
    v_mfma_f32_16x16x32_bf16 v[40:43], v[24:27], v[176:179], v[40:43]
    ds_read_b64_tr_b16 v[106:107], v4 offset:8704
    s_add_u32 m0, s78, 32768
    v_mfma_f32_16x16x32_bf16 v[40:43], v[28:31], v[180:183], v[40:43]
    ds_read_b64_tr_b16 v[108:109], v4 offset:12288
    v_mfma_f32_16x16x32_bf16 v[44:47], v[24:27], v[248:251], v[44:47]
    ds_read_b64_tr_b16 v[110:111], v4 offset:12800
    v_mfma_f32_16x16x32_bf16 v[44:47], v[28:31], v[252:255], v[44:47]
    ds_read_b64_tr_b16 v[24:25], v4 offset:16384
    v_mfma_f32_16x16x32_bf16 v[48:51], v[32:35], v[176:179], v[48:51]
    ds_read_b64_tr_b16 v[26:27], v4 offset:16896
    v_mfma_f32_16x16x32_bf16 v[48:51], v[36:39], v[180:183], v[48:51]
    ds_read_b64_tr_b16 v[28:29], v4 offset:20480
    v_mfma_f32_16x16x32_bf16 v[52:55], v[32:35], v[248:251], v[52:55]
    ds_read_b64_tr_b16 v[30:31], v4 offset:20992
    s_add_u32 s90, s71, 128
    v_mfma_f32_16x16x32_bf16 v[52:55], v[36:39], v[252:255], v[52:55]
    ds_read_b64_tr_b16 v[32:33], v4 offset:40960
    s_waitcnt lgkmcnt(5)
    v_mfma_f32_16x16x32_bf16 v[60:63], v[104:107], v[184:187], v[56:59]
    ds_read_b64_tr_b16 v[34:35], v4 offset:41472
    v_mfma_f32_16x16x32_bf16 v[60:63], v[108:111], v[188:191], v[60:63]
    ds_read_b64_tr_b16 v[36:37], v4 offset:45056
    v_mfma_f32_16x16x32_bf16 v[56:59], v[104:107], v[112:115], v[56:59]
    ds_read_b64_tr_b16 v[38:39], v4 offset:45568
    v_mfma_f32_16x16x32_bf16 v[56:59], v[108:111], v[116:119], v[56:59]
    ds_read_b64_tr_b16 v[104:105], v5 offset:8192
    s_waitcnt lgkmcnt(5)
    v_mfma_f32_16x16x32_bf16 v[56:59], v[24:27], v[120:123], v[56:59]
    ds_read_b64_tr_b16 v[106:107], v5 offset:8704
    v_mfma_f32_16x16x32_bf16 v[56:59], v[28:31], v[124:127], v[56:59]
    ds_read_b64_tr_b16 v[108:109], v5 offset:12288
    buffer_load_dwordx4 v7, s[36:39], s90 offen  lds
    v_mfma_f32_16x16x32_bf16 v[60:63], v[24:27], v[192:195], v[60:63]
    ds_read_b64_tr_b16 v[110:111], v5 offset:12800
    v_mfma_f32_16x16x32_bf16 v[60:63], v[28:31], v[196:199], v[60:63]
    ds_read_b64_tr_b16 v[24:25], v5 offset:16384
    s_waitcnt lgkmcnt(5)
    v_mfma_f32_16x16x32_bf16 v[60:63], v[32:35], v[200:203], v[60:63]
    ds_read_b64_tr_b16 v[26:27], v5 offset:16896
    v_mfma_f32_16x16x32_bf16 v[60:63], v[36:39], v[204:207], v[60:63]
    ds_read_b64_tr_b16 v[28:29], v5 offset:20480
    v_mfma_f32_16x16x32_bf16 v[56:59], v[32:35], v[128:131], v[56:59]
    ds_read_b64_tr_b16 v[30:31], v5 offset:20992
    v_mfma_f32_16x16x32_bf16 v[56:59], v[36:39], v[132:135], v[56:59]
    ds_read_b64_tr_b16 v[32:33], v5 offset:40960
    s_waitcnt lgkmcnt(5)
    v_mfma_f32_16x16x32_bf16 v[68:71], v[104:107], v[184:187], v[64:67]
    ds_read_b64_tr_b16 v[34:35], v5 offset:41472
    v_mfma_f32_16x16x32_bf16 v[68:71], v[108:111], v[188:191], v[68:71]
    ds_read_b64_tr_b16 v[36:37], v5 offset:45056
    v_mfma_f32_16x16x32_bf16 v[64:67], v[104:107], v[112:115], v[64:67]
    ds_read_b64_tr_b16 v[38:39], v5 offset:45568
    v_mfma_f32_16x16x32_bf16 v[64:67], v[108:111], v[116:119], v[64:67]
    s_lshr_b32 s88, s76, 2
    s_cmp_eq_u32 s88, s73
    s_cbranch_scc0 L_skip_40
    v_mfma_f32_16x16x32_bf16 v[80:83], v[84:87], v[176:179], v[80:83]
    v_mfma_f32_16x16x32_bf16 v[80:83], v[88:91], v[180:183], v[80:83]
L_skip_40:
    s_add_u32 m0, s78, 40960
    s_add_u32 s90, s0, 256
    buffer_load_dwordx4 v7, s[36:39], s90 offen  lds
    v_mul_f32 v12, v40, v40
    v_mul_f32 v13, v41, v41
    v_mul_f32 v14, v42, v42
    v_mul_f32 v15, v43, v43
    v_fmamk_f32 v12, v12, 0xbdd2d3e8, v1
    v_fmamk_f32 v13, v13, 0xbdd2d3e8, v1
    v_fmamk_f32 v14, v14, 0xbdd2d3e8, v1
    s_add_u32 m0, s78, 49152
    s_add_u32 s90, s1, 256
    buffer_load_dwordx4 v7, s[36:39], s90 offen  lds
    v_fmamk_f32 v15, v15, 0xbdd2d3e8, v1
    v_mul_f32 v12, v12, v40
    v_mul_f32 v13, v13, v41
    v_mul_f32 v14, v14, v42
    v_mul_f32 v15, v15, v43
    v_exp_f32 v12, v12
    v_exp_f32 v13, v13
    s_add_u32 m0, s78, 57344
    s_add_u32 s90, s92, 256
    buffer_load_dwordx4 v7, s[36:39], s90 offen  lds
    v_exp_f32 v14, v14
    v_exp_f32 v15, v15
    v_add_f32 v12, 1.0, v12
    v_add_f32 v13, 1.0, v13
    v_add_f32 v14, 1.0, v14
    v_add_f32 v15, 1.0, v15
    v_rcp_f32 v12, v12
    v_rcp_f32 v13, v13
    v_rcp_f32 v14, v14
    v_rcp_f32 v15, v15
    v_mul_f32 v12, v12, v40
    v_mul_f32 v13, v13, v41
    v_mul_f32 v14, v14, v42
    v_mul_f32 v15, v15, v43
    v_cvt_pk_bf16_f32 v72, v12, v13
    v_cvt_pk_bf16_f32 v73, v14, v15
    v_mul_f32 v12, v48, v48
    v_mul_f32 v13, v49, v49
    v_mul_f32 v14, v50, v50
    v_mul_f32 v15, v51, v51
    v_fmamk_f32 v12, v12, 0xbdd2d3e8, v1
    v_fmamk_f32 v13, v13, 0xbdd2d3e8, v1
    v_fmamk_f32 v14, v14, 0xbdd2d3e8, v1
    v_fmamk_f32 v15, v15, 0xbdd2d3e8, v1
    v_mul_f32 v12, v12, v48
    v_mul_f32 v13, v13, v49
    v_mul_f32 v14, v14, v50
    v_mul_f32 v15, v15, v51
    v_mul_f32 v80, 0xbfb8aa3b, v80
    v_and_b32 v81, 15, v22
    v_exp_f32 v80, v80
    s_lshl_b32 s88, s73, 7
    s_add_u32 s88, s88, 158848
    v_lshl_add_u32 v81, v81, 2, s88
    v_add_f32 v80, 1.0, v80
    v_rcp_f32 v80, v80
    s_nop 0
    ds_write_b32 v81, v80
    s_waitcnt vmcnt(6) lgkmcnt(1)
    s_barrier
    ds_read_b64_tr_b16 v[104:105], v4 offset:49152
    v_mfma_f32_16x16x32_bf16 v[64:67], v[24:27], v[120:123], v[64:67]
    ds_read_b64_tr_b16 v[106:107], v4 offset:49664
    ds_read_b128 v[40:43], v6 offset:512
    v_mfma_f32_16x16x32_bf16 v[64:67], v[28:31], v[124:127], v[64:67]
    ds_read_b64_tr_b16 v[108:109], v4 offset:53248
    s_add_u32 m0, s78, 65536
    v_mfma_f32_16x16x32_bf16 v[68:71], v[24:27], v[192:195], v[68:71]
    ds_read_b64_tr_b16 v[110:111], v4 offset:53760
    v_mfma_f32_16x16x32_bf16 v[68:71], v[28:31], v[196:199], v[68:71]
    ds_read_b64_tr_b16 v[24:25], v2
    v_mfma_f32_16x16x32_bf16 v[68:71], v[32:35], v[200:203], v[68:71]
    ds_read_b64_tr_b16 v[26:27], v2 offset:512
    v_mfma_f32_16x16x32_bf16 v[68:71], v[36:39], v[204:207], v[68:71]
    ds_read_b64_tr_b16 v[28:29], v2 offset:4096
    v_mfma_f32_16x16x32_bf16 v[64:67], v[32:35], v[128:131], v[64:67]
    ds_read_b64_tr_b16 v[30:31], v2 offset:4608
    s_add_u32 s90, s60, 256
    v_mfma_f32_16x16x32_bf16 v[64:67], v[36:39], v[132:135], v[64:67]
    ds_read_b64_tr_b16 v[32:33], v2 offset:8192
    s_waitcnt lgkmcnt(5)
    v_mfma_f32_16x16x32_bf16 v[56:59], v[104:107], v[136:139], v[56:59]
    ds_read_b64_tr_b16 v[34:35], v2 offset:8704
    v_mfma_f32_16x16x32_bf16 v[56:59], v[108:111], v[140:143], v[56:59]
    ds_read_b64_tr_b16 v[36:37], v2 offset:12288
    v_mfma_f32_16x16x32_bf16 v[60:63], v[104:107], v[208:211], v[60:63]
    ds_read_b64_tr_b16 v[38:39], v2 offset:12800
    v_mfma_f32_16x16x32_bf16 v[60:63], v[108:111], v[212:215], v[60:63]
    ds_read_b64_tr_b16 v[104:105], v5 offset:49152
    s_waitcnt lgkmcnt(5)
    v_mfma_f32_16x16x32_bf16 v[60:63], v[24:27], v[216:219], v[60:63]
    ds_read_b64_tr_b16 v[106:107], v5 offset:49664
    v_mfma_f32_16x16x32_bf16 v[60:63], v[28:31], v[220:223], v[60:63]
    ds_read_b64_tr_b16 v[108:109], v5 offset:53248
    buffer_load_dwordx4 v7, s[36:39], s90 offen  lds
    v_mfma_f32_16x16x32_bf16 v[56:59], v[24:27], v[144:147], v[56:59]
    ds_read_b64_tr_b16 v[110:111], v5 offset:53760
    v_mfma_f32_16x16x32_bf16 v[56:59], v[28:31], v[148:151], v[56:59]
    ds_read_b64_tr_b16 v[24:25], v3
    s_waitcnt lgkmcnt(5)
    v_mfma_f32_16x16x32_bf16 v[56:59], v[32:35], v[152:155], v[56:59]
    ds_read_b64_tr_b16 v[26:27], v3 offset:512
    v_mfma_f32_16x16x32_bf16 v[56:59], v[36:39], v[156:159], v[56:59]
    ds_read_b64_tr_b16 v[28:29], v3 offset:4096
    v_mfma_f32_16x16x32_bf16 v[60:63], v[32:35], v[224:227], v[60:63]
    ds_read_b64_tr_b16 v[30:31], v3 offset:4608
    v_mfma_f32_16x16x32_bf16 v[60:63], v[36:39], v[228:231], v[60:63]
    ds_read_b64_tr_b16 v[32:33], v3 offset:8192
    s_waitcnt lgkmcnt(5)
    v_mfma_f32_16x16x32_bf16 v[64:67], v[104:107], v[136:139], v[64:67]
    ds_read_b64_tr_b16 v[34:35], v3 offset:8704
    v_mfma_f32_16x16x32_bf16 v[64:67], v[108:111], v[140:143], v[64:67]
    ds_read_b64_tr_b16 v[36:37], v3 offset:12288
    v_mfma_f32_16x16x32_bf16 v[68:71], v[104:107], v[208:211], v[68:71]
    ds_read_b64_tr_b16 v[38:39], v3 offset:12800
    v_mfma_f32_16x16x32_bf16 v[68:71], v[108:111], v[212:215], v[68:71]
    s_add_u32 m0, s78, 159744
    s_nop 0
    buffer_load_dwordx4 v101, s[56:59], s68 offen lds
    s_add_u32 m0, s78, 73728
    s_add_u32 s90, s61, 256
    buffer_load_dwordx4 v7, s[36:39], s90 offen  lds
    v_exp_f32 v12, v12
    v_exp_f32 v13, v13
    v_exp_f32 v14, v14
    v_exp_f32 v15, v15
    v_add_f32 v12, 1.0, v12
    v_add_f32 v13, 1.0, v13
    s_add_u32 m0, s78, 90112
    s_add_u32 s90, s62, 256
    buffer_load_dwordx4 v7, s[36:39], s90 offen  lds
    v_add_f32 v14, 1.0, v14
    v_add_f32 v15, 1.0, v15
    v_rcp_f32 v12, v12
    v_rcp_f32 v13, v13
    v_rcp_f32 v14, v14
    v_rcp_f32 v15, v15
    s_add_u32 m0, s78, 98304
    s_add_u32 s90, s63, 256
    buffer_load_dwordx4 v7, s[36:39], s90 offen  lds
    v_mul_f32 v12, v12, v48
    v_mul_f32 v13, v13, v49
    v_mul_f32 v14, v14, v50
    v_mul_f32 v15, v15, v51
    v_cvt_pk_bf16_f32 v74, v12, v13
    v_cvt_pk_bf16_f32 v75, v14, v15
    ds_write_b128 v21, v[72:75] offset:32768
    v_mul_f32 v12, v44, v44
    v_mul_f32 v13, v45, v45
    v_mul_f32 v14, v46, v46
    v_mul_f32 v15, v47, v47
    v_fmamk_f32 v12, v12, 0xbdd2d3e8, v1
    v_fmamk_f32 v13, v13, 0xbdd2d3e8, v1
    v_fmamk_f32 v14, v14, 0xbdd2d3e8, v1
    v_fmamk_f32 v15, v15, 0xbdd2d3e8, v1
    v_mul_f32 v12, v12, v44
    v_mul_f32 v13, v13, v45
    v_mul_f32 v14, v14, v46
    v_mul_f32 v15, v15, v47
    v_exp_f32 v12, v12
    v_exp_f32 v13, v13
    v_exp_f32 v14, v14
    v_exp_f32 v15, v15
    v_add_f32 v12, 1.0, v12
    v_add_f32 v13, 1.0, v13
    v_add_f32 v14, 1.0, v14
    v_add_f32 v15, 1.0, v15
    s_waitcnt vmcnt(8) lgkmcnt(1)
    s_barrier
    ds_read_b64_tr_b16 v[104:105], v2 offset:16384
    v_mfma_f32_16x16x32_bf16 v[68:71], v[24:27], v[216:219], v[68:71]
    ds_read_b64_tr_b16 v[106:107], v2 offset:16896
    ds_read_b128 v[48:51], v6 offset:576
    v_mfma_f32_16x16x32_bf16 v[68:71], v[28:31], v[220:223], v[68:71]
    ds_read_b64_tr_b16 v[108:109], v2 offset:20480
    s_add_u32 m0, s78, 106496
    v_mfma_f32_16x16x32_bf16 v[64:67], v[24:27], v[144:147], v[64:67]
    ds_read_b64_tr_b16 v[110:111], v2 offset:20992
    v_mfma_f32_16x16x32_bf16 v[64:67], v[28:31], v[148:151], v[64:67]
    ds_read_b64_tr_b16 v[24:25], v2 offset:24576
    v_mfma_f32_16x16x32_bf16 v[64:67], v[32:35], v[152:155], v[64:67]
    ds_read_b64_tr_b16 v[26:27], v2 offset:25088
    v_mfma_f32_16x16x32_bf16 v[64:67], v[36:39], v[156:159], v[64:67]
    ds_read_b64_tr_b16 v[28:29], v2 offset:28672
    v_mfma_f32_16x16x32_bf16 v[68:71], v[32:35], v[224:227], v[68:71]
    ds_read_b64_tr_b16 v[30:31], v2 offset:29184
    s_add_u32 s90, s70, 256
    v_mfma_f32_16x16x32_bf16 v[68:71], v[36:39], v[228:231], v[68:71]
    ds_read_b64_tr_b16 v[32:33], v2 offset:32768
    s_waitcnt lgkmcnt(5)
    v_mfma_f32_16x16x32_bf16 v[56:59], v[104:107], v[160:163], v[56:59]
    ds_read_b64_tr_b16 v[34:35], v2 offset:33280
    v_mfma_f32_16x16x32_bf16 v[56:59], v[108:111], v[164:167], v[56:59]
    ds_read_b64_tr_b16 v[36:37], v2 offset:36864
    v_mfma_f32_16x16x32_bf16 v[60:63], v[104:107], v[232:235], v[60:63]
    ds_read_b64_tr_b16 v[38:39], v2 offset:37376
    v_mfma_f32_16x16x32_bf16 v[60:63], v[108:111], v[236:239], v[60:63]
    ds_read_b64_tr_b16 v[104:105], v3 offset:16384
    s_waitcnt lgkmcnt(5)
    v_mfma_f32_16x16x32_bf16 v[60:63], v[24:27], v[240:243], v[60:63]
    ds_read_b64_tr_b16 v[106:107], v3 offset:16896
    v_mfma_f32_16x16x32_bf16 v[60:63], v[28:31], v[244:247], v[60:63]
    ds_read_b64_tr_b16 v[108:109], v3 offset:20480
    buffer_load_dwordx4 v7, s[36:39], s90 offen  lds
    v_mfma_f32_16x16x32_bf16 v[56:59], v[24:27], v[168:171], v[56:59]
    ds_read_b64_tr_b16 v[110:111], v3 offset:20992
    v_mfma_f32_16x16x32_bf16 v[56:59], v[28:31], v[172:175], v[56:59]
    ds_read_b64_tr_b16 v[24:25], v3 offset:24576
    s_waitcnt lgkmcnt(5)
    v_mfma_f32_16x16x32_bf16 v[56:59], v[32:35], v[176:179], v[56:59]
    ds_read_b64_tr_b16 v[26:27], v3 offset:25088
    v_mfma_f32_16x16x32_bf16 v[56:59], v[36:39], v[180:183], v[56:59]
    ds_read_b64_tr_b16 v[28:29], v3 offset:28672
    v_mfma_f32_16x16x32_bf16 v[60:63], v[32:35], v[248:251], v[60:63]
    ds_read_b64_tr_b16 v[30:31], v3 offset:29184
    v_mfma_f32_16x16x32_bf16 v[60:63], v[36:39], v[252:255], v[60:63]
    ds_read_b64_tr_b16 v[32:33], v3 offset:32768
    s_waitcnt lgkmcnt(5)
    v_mfma_f32_16x16x32_bf16 v[64:67], v[104:107], v[160:163], v[64:67]
    ds_read_b64_tr_b16 v[34:35], v3 offset:33280
    v_mfma_f32_16x16x32_bf16 v[64:67], v[108:111], v[164:167], v[64:67]
    ds_read_b64_tr_b16 v[36:37], v3 offset:36864
    v_mfma_f32_16x16x32_bf16 v[68:71], v[104:107], v[232:235], v[68:71]
    ds_read_b64_tr_b16 v[38:39], v3 offset:37376
    v_mfma_f32_16x16x32_bf16 v[68:71], v[108:111], v[236:239], v[68:71]
    s_add_u32 m0, s78, 114688
    s_add_u32 s90, s71, 256
    buffer_load_dwordx4 v7, s[36:39], s90 offen  lds
    v_rcp_f32 v12, v12
    v_rcp_f32 v13, v13
    v_rcp_f32 v14, v14
    v_rcp_f32 v15, v15
    v_mul_f32 v12, v12, v44
    v_mul_f32 v13, v13, v45
    v_mul_f32 v14, v14, v46
    v_mul_f32 v15, v15, v47
    v_cvt_pk_bf16_f32 v76, v12, v13
    v_cvt_pk_bf16_f32 v77, v14, v15
    s_add_u32 m0, s78, 81920
    s_add_u32 s90, s0, 384
    buffer_load_dwordx4 v7, s[36:39], s90 offen  lds
    v_mul_f32 v12, v52, v52
    v_mul_f32 v13, v53, v53
    v_mul_f32 v14, v54, v54
    v_mul_f32 v15, v55, v55
    v_fmamk_f32 v12, v12, 0xbdd2d3e8, v1
    v_fmamk_f32 v13, v13, 0xbdd2d3e8, v1
    v_fmamk_f32 v14, v14, 0xbdd2d3e8, v1
    v_fmamk_f32 v15, v15, 0xbdd2d3e8, v1
    v_mul_f32 v12, v12, v52
    v_mul_f32 v13, v13, v53
    v_mul_f32 v14, v14, v54
    v_mul_f32 v15, v15, v55
    v_exp_f32 v12, v12
    v_exp_f32 v13, v13
    v_exp_f32 v14, v14
    v_exp_f32 v15, v15
    v_add_f32 v12, 1.0, v12
    v_add_f32 v13, 1.0, v13
    v_add_f32 v14, 1.0, v14
    v_add_f32 v15, 1.0, v15
    v_rcp_f32 v12, v12
    v_rcp_f32 v13, v13
    v_rcp_f32 v14, v14
    v_rcp_f32 v15, v15
    v_mul_f32 v12, v12, v52
    v_mul_f32 v13, v13, v53
    v_mul_f32 v14, v14, v54
    v_mul_f32 v15, v15, v55
    v_cvt_pk_bf16_f32 v78, v12, v13
    v_cvt_pk_bf16_f32 v79, v14, v15
    ds_write_b128 v21, v[76:79] offset:40960
    s_waitcnt vmcnt(8) lgkmcnt(1)
    s_barrier
    ds_read_b64_tr_b16 v[104:105], v2 offset:40960
    v_mfma_f32_16x16x32_bf16 v[68:71], v[24:27], v[240:243], v[68:71]
    ds_read_b64_tr_b16 v[106:107], v2 offset:41472
    s_add_u32 m0, s78, 0
    v_mfma_f32_16x16x32_bf16 v[68:71], v[28:31], v[244:247], v[68:71]
    ds_read_b64_tr_b16 v[108:109], v2 offset:45056
    v_mfma_f32_16x16x32_bf16 v[64:67], v[24:27], v[168:171], v[64:67]
    ds_read_b64_tr_b16 v[110:111], v2 offset:45568
    v_mfma_f32_16x16x32_bf16 v[64:67], v[28:31], v[172:175], v[64:67]
    ds_read_b64_tr_b16 v[24:25], v2 offset:49152
    v_mfma_f32_16x16x32_bf16 v[64:67], v[32:35], v[176:179], v[64:67]
    ds_read_b64_tr_b16 v[26:27], v2 offset:49664
    v_mfma_f32_16x16x32_bf16 v[64:67], v[36:39], v[180:183], v[64:67]
    ds_read_b64_tr_b16 v[28:29], v2 offset:53248
    v_mfma_f32_16x16x32_bf16 v[68:71], v[32:35], v[248:251], v[68:71]
    ds_read_b64_tr_b16 v[30:31], v2 offset:53760
    s_add_u32 s90, s1, 384
    v_mfma_f32_16x16x32_bf16 v[68:71], v[36:39], v[252:255], v[68:71]
    ds_read_b64_tr_b16 v[32:33], v2 offset:57344
    s_waitcnt lgkmcnt(5)
    v_mfma_f32_16x16x32_bf16 v[44:47], v[104:107], v[184:187], v[40:43]
    ds_read_b64_tr_b16 v[34:35], v2 offset:57856
    v_mfma_f32_16x16x32_bf16 v[44:47], v[108:111], v[188:191], v[44:47]
    ds_read_b64_tr_b16 v[36:37], v2 offset:61440
    v_mfma_f32_16x16x32_bf16 v[40:43], v[104:107], v[112:115], v[40:43]
    ds_read_b64_tr_b16 v[38:39], v2 offset:61952
    v_mfma_f32_16x16x32_bf16 v[40:43], v[108:111], v[116:119], v[40:43]
    ds_read_b64_tr_b16 v[104:105], v3 offset:40960
    s_waitcnt lgkmcnt(5)
    v_mfma_f32_16x16x32_bf16 v[40:43], v[24:27], v[120:123], v[40:43]
    ds_read_b64_tr_b16 v[106:107], v3 offset:41472
    v_mfma_f32_16x16x32_bf16 v[40:43], v[28:31], v[124:127], v[40:43]
    ds_read_b64_tr_b16 v[108:109], v3 offset:45056
    buffer_load_dwordx4 v7, s[36:39], s90 offen  lds
    v_mfma_f32_16x16x32_bf16 v[44:47], v[24:27], v[192:195], v[44:47]
    ds_read_b64_tr_b16 v[110:111], v3 offset:45568
    v_mfma_f32_16x16x32_bf16 v[44:47], v[28:31], v[196:199], v[44:47]
    ds_read_b64_tr_b16 v[24:25], v3 offset:49152
    s_waitcnt lgkmcnt(5)
    v_mfma_f32_16x16x32_bf16 v[44:47], v[32:35], v[200:203], v[44:47]
    ds_read_b64_tr_b16 v[26:27], v3 offset:49664
    v_mfma_f32_16x16x32_bf16 v[44:47], v[36:39], v[204:207], v[44:47]
    ds_read_b64_tr_b16 v[28:29], v3 offset:53248
    v_mfma_f32_16x16x32_bf16 v[40:43], v[32:35], v[128:131], v[40:43]
    ds_read_b64_tr_b16 v[30:31], v3 offset:53760
    v_mfma_f32_16x16x32_bf16 v[40:43], v[36:39], v[132:135], v[40:43]
    ds_read_b64_tr_b16 v[32:33], v3 offset:57344
    s_waitcnt lgkmcnt(5)
    v_mfma_f32_16x16x32_bf16 v[52:55], v[104:107], v[184:187], v[48:51]
    ds_read_b64_tr_b16 v[34:35], v3 offset:57856
    v_mfma_f32_16x16x32_bf16 v[52:55], v[108:111], v[188:191], v[52:55]
    ds_read_b64_tr_b16 v[36:37], v3 offset:61440
    v_mfma_f32_16x16x32_bf16 v[48:51], v[104:107], v[112:115], v[48:51]
    ds_read_b64_tr_b16 v[38:39], v3 offset:61952
    v_mfma_f32_16x16x32_bf16 v[48:51], v[108:111], v[116:119], v[48:51]
    s_add_u32 m0, s78, 8192
    s_add_u32 s90, s92, 384
    buffer_load_dwordx4 v7, s[36:39], s90 offen  lds
    v_mul_f32 v12, v56, v56
    v_mul_f32 v13, v57, v57
    v_mul_f32 v14, v58, v58
    v_mul_f32 v15, v59, v59
    v_fmamk_f32 v12, v12, 0xbdd2d3e8, v1
    v_fmamk_f32 v13, v13, 0xbdd2d3e8, v1
    v_fmamk_f32 v14, v14, 0xbdd2d3e8, v1
    v_fmamk_f32 v15, v15, 0xbdd2d3e8, v1
    v_mul_f32 v12, v12, v56
    v_mul_f32 v13, v13, v57
    s_add_u32 m0, s78, 16384
    s_add_u32 s90, s60, 384
    buffer_load_dwordx4 v7, s[36:39], s90 offen  lds
    v_mul_f32 v14, v14, v58
    v_mul_f32 v15, v15, v59
    v_exp_f32 v12, v12
    v_exp_f32 v13, v13
    v_exp_f32 v14, v14
    v_exp_f32 v15, v15
    v_add_f32 v12, 1.0, v12
    v_add_f32 v13, 1.0, v13
    v_add_f32 v14, 1.0, v14
    v_add_f32 v15, 1.0, v15
    v_rcp_f32 v12, v12
    v_rcp_f32 v13, v13
    v_rcp_f32 v14, v14
    v_rcp_f32 v15, v15
    v_mul_f32 v12, v12, v56
    v_mul_f32 v13, v13, v57
    v_mul_f32 v14, v14, v58
    v_mul_f32 v15, v15, v59
    v_cvt_pk_bf16_f32 v80, v12, v13
    v_cvt_pk_bf16_f32 v81, v14, v15
    v_mul_f32 v12, v64, v64
    v_mul_f32 v13, v65, v65
    v_mul_f32 v14, v66, v66
    v_mul_f32 v15, v67, v67
    v_fmamk_f32 v12, v12, 0xbdd2d3e8, v1
    v_fmamk_f32 v13, v13, 0xbdd2d3e8, v1
    v_fmamk_f32 v14, v14, 0xbdd2d3e8, v1
    v_fmamk_f32 v15, v15, 0xbdd2d3e8, v1
    v_mul_f32 v12, v12, v64
    v_mul_f32 v13, v13, v65
    v_mul_f32 v14, v14, v66
    v_mul_f32 v15, v15, v67
    s_waitcnt vmcnt(7) lgkmcnt(0)
    s_barrier
    ds_read_b64_tr_b16 v[104:105], v4
    v_mfma_f32_16x16x32_bf16 v[48:51], v[24:27], v[120:123], v[48:51]
    ds_read_b64_tr_b16 v[106:107], v4 offset:512
    ds_read_b128 v[56:59], v6 offset:768
    v_mfma_f32_16x16x32_bf16 v[48:51], v[28:31], v[124:127], v[48:51]
    ds_read_b64_tr_b16 v[108:109], v4 offset:4096
    ds_read_b64_tr_b16 v[92:93], v102
    v_mfma_f32_16x16x32_bf16 v[52:55], v[24:27], v[192:195], v[52:55]
    ds_read_b64_tr_b16 v[110:111], v4 offset:4608
    ds_read_b64_tr_b16 v[94:95], v102 offset:2048
    v_mfma_f32_16x16x32_bf16 v[52:55], v[28:31], v[196:199], v[52:55]
    ds_read_b64_tr_b16 v[24:25], v4 offset:8192
    v_mfma_f32_16x16x32_bf16 v[52:55], v[32:35], v[200:203], v[52:55]
    ds_read_b64_tr_b16 v[26:27], v4 offset:8704
    s_add_u32 m0, s78, 24576
    v_mfma_f32_16x16x32_bf16 v[52:55], v[36:39], v[204:207], v[52:55]
    ds_read_b64_tr_b16 v[28:29], v4 offset:12288
    v_mfma_f32_16x16x32_bf16 v[48:51], v[32:35], v[128:131], v[48:51]
    ds_read_b64_tr_b16 v[30:31], v4 offset:12800
    v_mfma_f32_16x16x32_bf16 v[48:51], v[36:39], v[132:135], v[48:51]
    ds_read_b64_tr_b16 v[32:33], v4 offset:24576
    s_waitcnt lgkmcnt(6)
    v_mfma_f32_16x16x32_bf16 v[40:43], v[104:107], v[136:139], v[40:43]
    ds_read_b64_tr_b16 v[34:35], v4 offset:25088
    v_mfma_f32_16x16x32_bf16 v[40:43], v[108:111], v[140:143], v[40:43]
    ds_read_b64_tr_b16 v[36:37], v4 offset:28672
    s_add_u32 s90, s61, 384
    v_mfma_f32_16x16x32_bf16 v[44:47], v[104:107], v[208:211], v[44:47]
    ds_read_b64_tr_b16 v[38:39], v4 offset:29184
    v_mfma_f32_16x16x32_bf16 v[44:47], v[108:111], v[212:215], v[44:47]
    ds_read_b64_tr_b16 v[104:105], v5
    s_waitcnt lgkmcnt(5)
    v_mfma_f32_16x16x32_bf16 v[44:47], v[24:27], v[216:219], v[44:47]
    ds_read_b64_tr_b16 v[106:107], v5 offset:512
    v_mfma_f32_16x16x32_bf16 v[44:47], v[28:31], v[220:223], v[44:47]
    ds_read_b64_tr_b16 v[108:109], v5 offset:4096
    v_mfma_f32_16x16x32_bf16 v[40:43], v[24:27], v[144:147], v[40:43]
    ds_read_b64_tr_b16 v[110:111], v5 offset:4608
    buffer_load_dwordx4 v7, s[36:39], s90 offen  lds
    v_mfma_f32_16x16x32_bf16 v[40:43], v[28:31], v[148:151], v[40:43]
    ds_read_b64_tr_b16 v[24:25], v5 offset:8192
    s_waitcnt lgkmcnt(5)
    v_mfma_f32_16x16x32_bf16 v[40:43], v[32:35], v[152:155], v[40:43]
    ds_read_b64_tr_b16 v[26:27], v5 offset:8704
    v_mfma_f32_16x16x32_bf16 v[40:43], v[36:39], v[156:159], v[40:43]
    ds_read_b64_tr_b16 v[28:29], v5 offset:12288
    v_mfma_f32_16x16x32_bf16 v[44:47], v[32:35], v[224:227], v[44:47]
    ds_read_b64_tr_b16 v[30:31], v5 offset:12800
    v_mfma_f32_16x16x32_bf16 v[44:47], v[36:39], v[228:231], v[44:47]
    ds_read_b64_tr_b16 v[32:33], v5 offset:24576
    s_waitcnt lgkmcnt(5)
    v_mfma_f32_16x16x32_bf16 v[48:51], v[104:107], v[136:139], v[48:51]
    ds_read_b64_tr_b16 v[34:35], v5 offset:25088
    v_mfma_f32_16x16x32_bf16 v[48:51], v[108:111], v[140:143], v[48:51]
    ds_read_b64_tr_b16 v[36:37], v5 offset:28672
    v_mfma_f32_16x16x32_bf16 v[52:55], v[104:107], v[208:211], v[52:55]
    ds_read_b64_tr_b16 v[38:39], v5 offset:29184
    v_mfma_f32_16x16x32_bf16 v[52:55], v[108:111], v[212:215], v[52:55]
    s_bfm_b64 exec, 11, 0
    s_mov_b32 m0, 157184
    s_nop 0
    buffer_load_dword v100, s[40:43], 0 offen lds
    s_mov_b64 exec, -1
    s_add_u32 m0, s78, 32768
    s_add_u32 s90, s62, 384
    buffer_load_dwordx4 v7, s[36:39], s90 offen  lds
    v_exp_f32 v12, v12
    v_exp_f32 v13, v13
    v_exp_f32 v14, v14
    v_exp_f32 v15, v15
    v_add_f32 v12, 1.0, v12
    v_add_f32 v13, 1.0, v13
    v_add_f32 v14, 1.0, v14
    v_add_f32 v15, 1.0, v15
    v_rcp_f32 v12, v12
    s_add_u32 m0, s78, 40960
    s_add_u32 s90, s63, 384
    buffer_load_dwordx4 v7, s[36:39], s90 offen  lds
    v_rcp_f32 v13, v13
    v_rcp_f32 v14, v14
    v_rcp_f32 v15, v15
    v_mul_f32 v12, v12, v64
    v_mul_f32 v13, v13, v65
    v_mul_f32 v14, v14, v66
    v_mul_f32 v15, v15, v67
    v_cvt_pk_bf16_f32 v82, v12, v13
    v_cvt_pk_bf16_f32 v83, v14, v15
    ds_write_b128 v21, v[80:83] offset:16384
    v_mul_f32 v12, v60, v60
    v_mul_f32 v13, v61, v61
    v_mul_f32 v14, v62, v62
    v_mul_f32 v15, v63, v63
    v_fmamk_f32 v12, v12, 0xbdd2d3e8, v1
    v_fmamk_f32 v13, v13, 0xbdd2d3e8, v1
    v_fmamk_f32 v14, v14, 0xbdd2d3e8, v1
    v_fmamk_f32 v15, v15, 0xbdd2d3e8, v1
    v_mul_f32 v12, v12, v60
    v_mul_f32 v13, v13, v61
    v_mul_f32 v14, v14, v62
    v_mul_f32 v15, v15, v63
    v_exp_f32 v12, v12
    v_exp_f32 v13, v13
    v_exp_f32 v14, v14
    v_exp_f32 v15, v15
    v_add_f32 v12, 1.0, v12
    v_add_f32 v13, 1.0, v13
    v_add_f32 v14, 1.0, v14
    v_add_f32 v15, 1.0, v15
    buffer_store_dwordx4 v[92:95], v0, s[44:47], s69 offen sc1
    s_waitcnt vmcnt(9) lgkmcnt(1)
    s_barrier
    ds_read_b64_tr_b16 v[104:105], v4 offset:32768
    v_mfma_f32_16x16x32_bf16 v[52:55], v[24:27], v[216:219], v[52:55]
    ds_read_b64_tr_b16 v[106:107], v4 offset:33280
    ds_read_b128 v[64:67], v6 offset:832
    v_mfma_f32_16x16x32_bf16 v[52:55], v[28:31], v[220:223], v[52:55]
    ds_read_b64_tr_b16 v[108:109], v4 offset:36864
    s_add_u32 m0, s78, 49152
    v_mfma_f32_16x16x32_bf16 v[48:51], v[24:27], v[144:147], v[48:51]
    ds_read_b64_tr_b16 v[110:111], v4 offset:37376
    v_mfma_f32_16x16x32_bf16 v[48:51], v[28:31], v[148:151], v[48:51]
    ds_read_b64_tr_b16 v[24:25], v4 offset:40960
    v_mfma_f32_16x16x32_bf16 v[48:51], v[32:35], v[152:155], v[48:51]
    ds_read_b64_tr_b16 v[26:27], v4 offset:41472
    v_mfma_f32_16x16x32_bf16 v[48:51], v[36:39], v[156:159], v[48:51]
    ds_read_b64_tr_b16 v[28:29], v4 offset:45056
    v_mfma_f32_16x16x32_bf16 v[52:55], v[32:35], v[224:227], v[52:55]
    ds_read_b64_tr_b16 v[30:31], v4 offset:45568
    s_add_u32 s90, s70, 384
    v_mfma_f32_16x16x32_bf16 v[52:55], v[36:39], v[228:231], v[52:55]
    ds_read_b64_tr_b16 v[32:33], v4 offset:49152
    s_waitcnt lgkmcnt(5)
    v_mfma_f32_16x16x32_bf16 v[40:43], v[104:107], v[160:163], v[40:43]
    ds_read_b64_tr_b16 v[34:35], v4 offset:49664
    v_mfma_f32_16x16x32_bf16 v[40:43], v[108:111], v[164:167], v[40:43]
    ds_read_b64_tr_b16 v[36:37], v4 offset:53248
    v_mfma_f32_16x16x32_bf16 v[44:47], v[104:107], v[232:235], v[44:47]
    ds_read_b64_tr_b16 v[38:39], v4 offset:53760
    v_mfma_f32_16x16x32_bf16 v[44:47], v[108:111], v[236:239], v[44:47]
    ds_read_b64_tr_b16 v[104:105], v5 offset:32768
    s_waitcnt lgkmcnt(5)
    v_mfma_f32_16x16x32_bf16 v[44:47], v[24:27], v[240:243], v[44:47]
    ds_read_b64_tr_b16 v[106:107], v5 offset:33280
    v_mfma_f32_16x16x32_bf16 v[44:47], v[28:31], v[244:247], v[44:47]
    ds_read_b64_tr_b16 v[108:109], v5 offset:36864
L_h0page0:
    s_cbranch_execz L_h0page4
    buffer_load_dwordx4 v7, s[36:39], s90 offen  lds
    v_mfma_f32_16x16x32_bf16 v[40:43], v[24:27], v[168:171], v[40:43]
    ds_read_b64_tr_b16 v[110:111], v5 offset:37376
    v_mfma_f32_16x16x32_bf16 v[40:43], v[28:31], v[172:175], v[40:43]
    ds_read_b64_tr_b16 v[24:25], v5 offset:40960
    s_waitcnt lgkmcnt(5)
    v_mfma_f32_16x16x32_bf16 v[40:43], v[32:35], v[176:179], v[40:43]
    ds_read_b64_tr_b16 v[26:27], v5 offset:41472
    v_mfma_f32_16x16x32_bf16 v[40:43], v[36:39], v[180:183], v[40:43]
    ds_read_b64_tr_b16 v[28:29], v5 offset:45056
    v_mfma_f32_16x16x32_bf16 v[44:47], v[32:35], v[248:251], v[44:47]
    ds_read_b64_tr_b16 v[30:31], v5 offset:45568
    v_mfma_f32_16x16x32_bf16 v[44:47], v[36:39], v[252:255], v[44:47]
    ds_read_b64_tr_b16 v[32:33], v5 offset:49152
    s_waitcnt lgkmcnt(5)
    v_mfma_f32_16x16x32_bf16 v[48:51], v[104:107], v[160:163], v[48:51]
    ds_read_b64_tr_b16 v[34:35], v5 offset:49664
    v_mfma_f32_16x16x32_bf16 v[48:51], v[108:111], v[164:167], v[48:51]
    ds_read_b64_tr_b16 v[36:37], v5 offset:53248
    v_mfma_f32_16x16x32_bf16 v[52:55], v[104:107], v[232:235], v[52:55]
    ds_read_b64_tr_b16 v[38:39], v5 offset:53760
    v_mfma_f32_16x16x32_bf16 v[52:55], v[108:111], v[236:239], v[52:55]
    s_add_u32 m0, s78, 57344
    s_add_u32 s90, s71, 384
    buffer_load_dwordx4 v7, s[36:39], s90 offen  lds
    v_rcp_f32 v12, v12
    v_rcp_f32 v13, v13
    v_rcp_f32 v14, v14
    v_rcp_f32 v15, v15
    v_mul_f32 v12, v12, v60
    v_mul_f32 v13, v13, v61
    v_mul_f32 v14, v14, v62
    v_mul_f32 v15, v15, v63
    v_cvt_pk_bf16_f32 v84, v12, v13
    v_cvt_pk_bf16_f32 v85, v14, v15
    s_add_u32 m0, s78, 69632
    s_add_u32 s90, s1, s80
    buffer_load_dwordx4 v23, s[36:39], s90 offen  lds
    v_mul_f32 v12, v68, v68
    v_mul_f32 v13, v69, v69
    v_mul_f32 v14, v70, v70
    v_mul_f32 v15, v71, v71
    v_fmamk_f32 v12, v12, 0xbdd2d3e8, v1
    v_fmamk_f32 v13, v13, 0xbdd2d3e8, v1
    v_fmamk_f32 v14, v14, 0xbdd2d3e8, v1
    v_fmamk_f32 v15, v15, 0xbdd2d3e8, v1
    v_mul_f32 v12, v12, v68
    v_mul_f32 v13, v13, v69
    v_mul_f32 v14, v14, v70
    v_mul_f32 v15, v15, v71
    v_exp_f32 v12, v12
    v_exp_f32 v13, v13
    v_exp_f32 v14, v14
    v_exp_f32 v15, v15
    v_add_f32 v12, 1.0, v12
    v_add_f32 v13, 1.0, v13
    v_add_f32 v14, 1.0, v14
    v_add_f32 v15, 1.0, v15
    v_rcp_f32 v12, v12
    v_rcp_f32 v13, v13
    v_rcp_f32 v14, v14
    v_rcp_f32 v15, v15
    v_mul_f32 v12, v12, v68
    v_mul_f32 v13, v13, v69
    v_mul_f32 v14, v14, v70
    v_mul_f32 v15, v15, v71
    v_cvt_pk_bf16_f32 v86, v12, v13
    v_cvt_pk_bf16_f32 v87, v14, v15
    ds_write_b128 v21, v[84:87] offset:24576
    s_waitcnt vmcnt(9) lgkmcnt(1)
    s_barrier
    ds_read_b64_tr_b16 v[104:105], v4 offset:16384
    v_mfma_f32_16x16x32_bf16 v[52:55], v[24:27], v[240:243], v[52:55]
    ds_read_b64_tr_b16 v[106:107], v4 offset:16896
    s_add_u32 m0, s78, 94208
    v_mfma_f32_16x16x32_bf16 v[52:55], v[28:31], v[244:247], v[52:55]
    ds_read_b64_tr_b16 v[108:109], v4 offset:20480
    v_mfma_f32_16x16x32_bf16 v[48:51], v[24:27], v[168:171], v[48:51]
    ds_read_b64_tr_b16 v[110:111], v4 offset:20992
    v_mfma_f32_16x16x32_bf16 v[48:51], v[28:31], v[172:175], v[48:51]
    ds_read_b64_tr_b16 v[24:25], v2
    v_mfma_f32_16x16x32_bf16 v[48:51], v[32:35], v[176:179], v[48:51]
    ds_read_b64_tr_b16 v[26:27], v2 offset:512
    v_mfma_f32_16x16x32_bf16 v[48:51], v[36:39], v[180:183], v[48:51]
    ds_read_b64_tr_b16 v[28:29], v2 offset:4096
    v_mfma_f32_16x16x32_bf16 v[52:55], v[32:35], v[248:251], v[52:55]
    ds_read_b64_tr_b16 v[30:31], v2 offset:4608
    s_add_u32 s90, s62, s80
    v_mfma_f32_16x16x32_bf16 v[52:55], v[36:39], v[252:255], v[52:55]
    ds_read_b64_tr_b16 v[32:33], v2 offset:8192
    s_waitcnt lgkmcnt(5)
    v_mfma_f32_16x16x32_bf16 v[60:63], v[104:107], v[184:187], v[56:59]
    ds_read_b64_tr_b16 v[34:35], v2 offset:8704
    v_mfma_f32_16x16x32_bf16 v[60:63], v[108:111], v[188:191], v[60:63]
    ds_read_b64_tr_b16 v[36:37], v2 offset:12288
    v_mfma_f32_16x16x32_bf16 v[56:59], v[104:107], v[112:115], v[56:59]
    ds_read_b64_tr_b16 v[38:39], v2 offset:12800
    v_mfma_f32_16x16x32_bf16 v[56:59], v[108:111], v[116:119], v[56:59]
    ds_read_b64_tr_b16 v[104:105], v5 offset:16384
    s_waitcnt lgkmcnt(5)
    v_mfma_f32_16x16x32_bf16 v[56:59], v[24:27], v[120:123], v[56:59]
    ds_read_b64_tr_b16 v[106:107], v5 offset:16896
    v_mfma_f32_16x16x32_bf16 v[56:59], v[28:31], v[124:127], v[56:59]
    ds_read_b64_tr_b16 v[108:109], v5 offset:20480
    buffer_load_dwordx4 v23, s[36:39], s90 offen  lds
    v_mfma_f32_16x16x32_bf16 v[60:63], v[24:27], v[192:195], v[60:63]
    ds_read_b64_tr_b16 v[110:111], v5 offset:20992
    v_mfma_f32_16x16x32_bf16 v[60:63], v[28:31], v[196:199], v[60:63]
    ds_read_b64_tr_b16 v[24:25], v3
    s_waitcnt lgkmcnt(5)
    v_mfma_f32_16x16x32_bf16 v[60:63], v[32:35], v[200:203], v[60:63]
    ds_read_b64_tr_b16 v[26:27], v3 offset:512
    v_mfma_f32_16x16x32_bf16 v[60:63], v[36:39], v[204:207], v[60:63]
    ds_read_b64_tr_b16 v[28:29], v3 offset:4096
    v_mfma_f32_16x16x32_bf16 v[56:59], v[32:35], v[128:131], v[56:59]
    ds_read_b64_tr_b16 v[30:31], v3 offset:4608
    v_mfma_f32_16x16x32_bf16 v[56:59], v[36:39], v[132:135], v[56:59]
    ds_read_b64_tr_b16 v[32:33], v3 offset:8192
    s_waitcnt lgkmcnt(5)
    v_mfma_f32_16x16x32_bf16 v[68:71], v[104:107], v[184:187], v[64:67]
    ds_read_b64_tr_b16 v[34:35], v3 offset:8704
    v_mfma_f32_16x16x32_bf16 v[68:71], v[108:111], v[188:191], v[68:71]
    ds_read_b64_tr_b16 v[36:37], v3 offset:12288
    v_mfma_f32_16x16x32_bf16 v[64:67], v[104:107], v[112:115], v[64:67]
    ds_read_b64_tr_b16 v[38:39], v3 offset:12800
    v_mfma_f32_16x16x32_bf16 v[64:67], v[108:111], v[116:119], v[64:67]
    s_add_u32 m0, s78, 98304
    s_add_u32 s90, s63, s80
    buffer_load_dwordx4 v23, s[36:39], s90 offen  lds
    v_mul_f32 v12, v40, v40
    v_mul_f32 v13, v41, v41
    v_mul_f32 v14, v42, v42
    v_mul_f32 v15, v43, v43
    v_fmamk_f32 v12, v12, 0xbdd2d3e8, v1
    v_fmamk_f32 v13, v13, 0xbdd2d3e8, v1
    v_fmamk_f32 v14, v14, 0xbdd2d3e8, v1
    v_fmamk_f32 v15, v15, 0xbdd2d3e8, v1
    v_mul_f32 v12, v12, v40
    v_mul_f32 v13, v13, v41
    s_add_u32 m0, s78, 102400
    s_add_u32 s90, s70, s80
    buffer_load_dwordx4 v23, s[36:39], s90 offen  lds
    v_mul_f32 v14, v14, v42
    v_mul_f32 v15, v15, v43
    v_exp_f32 v12, v12
    v_exp_f32 v13, v13
    v_exp_f32 v14, v14
    v_exp_f32 v15, v15
    v_add_f32 v12, 1.0, v12
    v_add_f32 v13, 1.0, v13
    v_add_f32 v14, 1.0, v14
    v_add_f32 v15, 1.0, v15
    v_rcp_f32 v12, v12
    v_rcp_f32 v13, v13
    v_rcp_f32 v14, v14
    v_rcp_f32 v15, v15
    v_mul_f32 v12, v12, v40
    v_mul_f32 v13, v13, v41
    v_mul_f32 v14, v14, v42
    v_mul_f32 v15, v15, v43
    v_cvt_pk_bf16_f32 v88, v12, v13
    v_cvt_pk_bf16_f32 v89, v14, v15
    v_mul_f32 v12, v48, v48
    v_mul_f32 v13, v49, v49
    v_mul_f32 v14, v50, v50
    v_mul_f32 v15, v51, v51
    v_fmamk_f32 v12, v12, 0xbdd2d3e8, v1
    v_fmamk_f32 v13, v13, 0xbdd2d3e8, v1
    v_fmamk_f32 v14, v14, 0xbdd2d3e8, v1
    v_fmamk_f32 v15, v15, 0xbdd2d3e8, v1
    v_mul_f32 v12, v12, v48
    v_mul_f32 v13, v13, v49
    v_mul_f32 v14, v14, v50
    v_mul_f32 v15, v15, v51
    s_waitcnt vmcnt(8) lgkmcnt(0)
    s_barrier
    ds_read_b64_tr_b16 v[104:105], v2 offset:16384
    v_mfma_f32_16x16x32_bf16 v[64:67], v[24:27], v[120:123], v[64:67]
    ds_read_b64_tr_b16 v[106:107], v2 offset:16896
    ds_read_b128 v[40:43], v6 offset:1024
    v_mfma_f32_16x16x32_bf16 v[64:67], v[28:31], v[124:127], v[64:67]
    ds_read_b64_tr_b16 v[108:109], v2 offset:20480
    s_add_u32 m0, s78, 86016
    v_mfma_f32_16x16x32_bf16 v[68:71], v[24:27], v[192:195], v[68:71]
    ds_read_b64_tr_b16 v[110:111], v2 offset:20992
    v_mfma_f32_16x16x32_bf16 v[68:71], v[28:31], v[196:199], v[68:71]
    ds_read_b64_tr_b16 v[24:25], v2 offset:24576
    v_mfma_f32_16x16x32_bf16 v[68:71], v[32:35], v[200:203], v[68:71]
    ds_read_b64_tr_b16 v[26:27], v2 offset:25088
    s_add_u32 s81, s81, 1
    v_mfma_f32_16x16x32_bf16 v[68:71], v[36:39], v[204:207], v[68:71]
    ds_read_b64_tr_b16 v[28:29], v2 offset:28672
    v_mfma_f32_16x16x32_bf16 v[64:67], v[32:35], v[128:131], v[64:67]
    ds_read_b64_tr_b16 v[30:31], v2 offset:29184
    s_cmp_eq_u32 s81, 9
    v_mfma_f32_16x16x32_bf16 v[64:67], v[36:39], v[132:135], v[64:67]
    ds_read_b64_tr_b16 v[32:33], v2 offset:32768
    s_waitcnt lgkmcnt(5)
    v_mfma_f32_16x16x32_bf16 v[56:59], v[104:107], v[136:139], v[56:59]
    ds_read_b64_tr_b16 v[34:35], v2 offset:33280
    v_mfma_f32_16x16x32_bf16 v[56:59], v[108:111], v[140:143], v[56:59]
    ds_read_b64_tr_b16 v[36:37], v2 offset:36864
    global_load_lds_dwordx4 v[16:17], off
    v_mfma_f32_16x16x32_bf16 v[60:63], v[104:107], v[208:211], v[60:63]
    ds_read_b64_tr_b16 v[38:39], v2 offset:37376
    v_mfma_f32_16x16x32_bf16 v[60:63], v[108:111], v[212:215], v[60:63]
    ds_read_b64_tr_b16 v[104:105], v3 offset:16384
    s_waitcnt lgkmcnt(5)
    v_mfma_f32_16x16x32_bf16 v[60:63], v[24:27], v[216:219], v[60:63]
    ds_read_b64_tr_b16 v[106:107], v3 offset:16896
    s_cselect_b32 s90, -8, 1
    v_mfma_f32_16x16x32_bf16 v[60:63], v[28:31], v[220:223], v[60:63]
    ds_read_b64_tr_b16 v[108:109], v3 offset:20480
    v_mfma_f32_16x16x32_bf16 v[56:59], v[24:27], v[144:147], v[56:59]
    ds_read_b64_tr_b16 v[110:111], v3 offset:20992
    s_cselect_b32 s81, 0, s81
    v_mfma_f32_16x16x32_bf16 v[56:59], v[28:31], v[148:151], v[56:59]
    ds_read_b64_tr_b16 v[24:25], v3 offset:24576
    s_waitcnt lgkmcnt(5)
    v_mfma_f32_16x16x32_bf16 v[56:59], v[32:35], v[152:155], v[56:59]
    ds_read_b64_tr_b16 v[26:27], v3 offset:25088
    v_mfma_f32_16x16x32_bf16 v[56:59], v[36:39], v[156:159], v[56:59]
    ds_read_b64_tr_b16 v[28:29], v3 offset:28672
    v_mad_i64_i32 v[16:17], vcc, v18, s90, v[16:17]
    v_mfma_f32_16x16x32_bf16 v[60:63], v[32:35], v[224:227], v[60:63]
    ds_read_b64_tr_b16 v[30:31], v3 offset:29184
    v_mfma_f32_16x16x32_bf16 v[60:63], v[36:39], v[228:231], v[60:63]
    ds_read_b64_tr_b16 v[32:33], v3 offset:32768
    s_waitcnt lgkmcnt(5)
    v_mfma_f32_16x16x32_bf16 v[64:67], v[104:107], v[136:139], v[64:67]
    ds_read_b64_tr_b16 v[34:35], v3 offset:33280
    v_mfma_f32_16x16x32_bf16 v[64:67], v[108:111], v[140:143], v[64:67]
    ds_read_b64_tr_b16 v[36:37], v3 offset:36864
    v_mfma_f32_16x16x32_bf16 v[68:71], v[104:107], v[208:211], v[68:71]
    ds_read_b64_tr_b16 v[38:39], v3 offset:37376
    v_mfma_f32_16x16x32_bf16 v[68:71], v[108:111], v[212:215], v[68:71]
    s_bfm_b64 exec, 10, 11
    s_mov_b32 m0, 157184
    s_nop 0
    buffer_load_dword v100, s[40:43], 0 offen lds
    s_mov_b64 exec, -1
    v_exp_f32 v12, v12
    v_exp_f32 v13, v13
    v_exp_f32 v14, v14
    v_exp_f32 v15, v15
    v_add_f32 v12, 1.0, v12
    v_add_f32 v13, 1.0, v13
    v_add_f32 v14, 1.0, v14
    v_add_f32 v15, 1.0, v15
    v_rcp_f32 v12, v12
    v_rcp_f32 v13, v13
    v_rcp_f32 v14, v14
    v_rcp_f32 v15, v15
    v_mul_f32 v12, v12, v48
    v_mul_f32 v13, v13, v49
    v_mul_f32 v14, v14, v50
    v_mul_f32 v15, v15, v51
    v_cvt_pk_bf16_f32 v90, v12, v13
    v_cvt_pk_bf16_f32 v91, v14, v15
    ds_write_b128 v21, v[88:91]
    v_mul_f32 v12, v44, v44
    v_mul_f32 v13, v45, v45
    v_mul_f32 v14, v46, v46
    v_mul_f32 v15, v47, v47
    v_fmamk_f32 v12, v12, 0xbdd2d3e8, v1
    v_fmamk_f32 v13, v13, 0xbdd2d3e8, v1
    v_fmamk_f32 v14, v14, 0xbdd2d3e8, v1
    v_fmamk_f32 v15, v15, 0xbdd2d3e8, v1
    v_mul_f32 v12, v12, v44
    v_mul_f32 v13, v13, v45
    v_mul_f32 v14, v14, v46
    v_mul_f32 v15, v15, v47
    v_exp_f32 v12, v12
    v_exp_f32 v13, v13
    v_exp_f32 v14, v14
    v_exp_f32 v15, v15
    v_add_f32 v12, 1.0, v12
    v_add_f32 v13, 1.0, v13
    v_add_f32 v14, 1.0, v14
    v_add_f32 v15, 1.0, v15
    s_waitcnt vmcnt(6) lgkmcnt(1)
    s_barrier
    ds_read_b64_tr_b16 v[104:105], v2 offset:40960
    v_mfma_f32_16x16x32_bf16 v[68:71], v[24:27], v[216:219], v[68:71]
    ds_read_b64_tr_b16 v[106:107], v2 offset:41472
    s_add_u32 m0, s78, 4096
    v_mfma_f32_16x16x32_bf16 v[68:71], v[28:31], v[220:223], v[68:71]
    ds_read_b64_tr_b16 v[108:109], v2 offset:45056
    v_mfma_f32_16x16x32_bf16 v[64:67], v[24:27], v[144:147], v[64:67]
    ds_read_b64_tr_b16 v[110:111], v2 offset:45568
    s_add_u32 s81, s81, 1
    v_mfma_f32_16x16x32_bf16 v[64:67], v[28:31], v[148:151], v[64:67]
    ds_read_b64_tr_b16 v[24:25], v2 offset:49152
    v_mfma_f32_16x16x32_bf16 v[64:67], v[32:35], v[152:155], v[64:67]
    ds_read_b64_tr_b16 v[26:27], v2 offset:49664
    v_mfma_f32_16x16x32_bf16 v[64:67], v[36:39], v[156:159], v[64:67]
    ds_read_b64_tr_b16 v[28:29], v2 offset:53248
    s_cmp_eq_u32 s81, 9
    v_mfma_f32_16x16x32_bf16 v[68:71], v[32:35], v[224:227], v[68:71]
    ds_read_b64_tr_b16 v[30:31], v2 offset:53760
    v_mfma_f32_16x16x32_bf16 v[68:71], v[36:39], v[228:231], v[68:71]
    ds_read_b64_tr_b16 v[32:33], v2 offset:57344
    s_waitcnt lgkmcnt(5)
    v_mfma_f32_16x16x32_bf16 v[56:59], v[104:107], v[160:163], v[56:59]
    ds_read_b64_tr_b16 v[34:35], v2 offset:57856
    global_load_lds_dwordx4 v[16:17], off
    v_mfma_f32_16x16x32_bf16 v[56:59], v[108:111], v[164:167], v[56:59]
    ds_read_b64_tr_b16 v[36:37], v2 offset:61440
    v_mfma_f32_16x16x32_bf16 v[60:63], v[104:107], v[232:235], v[60:63]
    ds_read_b64_tr_b16 v[38:39], v2 offset:61952
    s_cselect_b32 s90, -8, 1
    v_mfma_f32_16x16x32_bf16 v[60:63], v[108:111], v[236:239], v[60:63]
    ds_read_b64_tr_b16 v[104:105], v3 offset:40960
    s_waitcnt lgkmcnt(5)
    v_mfma_f32_16x16x32_bf16 v[60:63], v[24:27], v[240:243], v[60:63]
    ds_read_b64_tr_b16 v[106:107], v3 offset:41472
    v_mfma_f32_16x16x32_bf16 v[60:63], v[28:31], v[244:247], v[60:63]
    ds_read_b64_tr_b16 v[108:109], v3 offset:45056
    s_cselect_b32 s81, 0, s81
    v_mfma_f32_16x16x32_bf16 v[56:59], v[24:27], v[168:171], v[56:59]
    ds_read_b64_tr_b16 v[110:111], v3 offset:45568
    v_mfma_f32_16x16x32_bf16 v[56:59], v[28:31], v[172:175], v[56:59]
    ds_read_b64_tr_b16 v[24:25], v3 offset:49152
    s_waitcnt lgkmcnt(5)
    v_mfma_f32_16x16x32_bf16 v[56:59], v[32:35], v[176:179], v[56:59]
    ds_read_b64_tr_b16 v[26:27], v3 offset:49664
    v_mad_i64_i32 v[16:17], vcc, v18, s90, v[16:17]
    v_mfma_f32_16x16x32_bf16 v[56:59], v[36:39], v[180:183], v[56:59]
    ds_read_b64_tr_b16 v[28:29], v3 offset:53248
    v_mfma_f32_16x16x32_bf16 v[60:63], v[32:35], v[248:251], v[60:63]
    ds_read_b64_tr_b16 v[30:31], v3 offset:53760
    v_mfma_f32_16x16x32_bf16 v[60:63], v[36:39], v[252:255], v[60:63]
    ds_read_b64_tr_b16 v[32:33], v3 offset:57344
    s_waitcnt lgkmcnt(5)
    v_mfma_f32_16x16x32_bf16 v[64:67], v[104:107], v[160:163], v[64:67]
    ds_read_b64_tr_b16 v[34:35], v3 offset:57856
    v_mfma_f32_16x16x32_bf16 v[64:67], v[108:111], v[164:167], v[64:67]
    ds_read_b64_tr_b16 v[36:37], v3 offset:61440
    v_mfma_f32_16x16x32_bf16 v[68:71], v[104:107], v[232:235], v[68:71]
    ds_read_b64_tr_b16 v[38:39], v3 offset:61952
    v_mfma_f32_16x16x32_bf16 v[68:71], v[108:111], v[236:239], v[68:71]
    s_add_u32 m0, s78, 12288
    s_add_u32 s81, s81, 1
    s_cmp_eq_u32 s81, 9
    global_load_lds_dwordx4 v[16:17], off
    s_cselect_b32 s90, -8, 1
    s_cselect_b32 s81, 0, s81
    v_mad_i64_i32 v[16:17], vcc, v18, s90, v[16:17]
    v_rcp_f32 v12, v12
    v_rcp_f32 v13, v13
    v_rcp_f32 v14, v14
    v_rcp_f32 v15, v15
    v_mul_f32 v12, v12, v44
    v_mul_f32 v13, v13, v45
    v_mul_f32 v14, v14, v46
    v_mul_f32 v15, v15, v47
    v_cvt_pk_bf16_f32 v92, v12, v13
    v_cvt_pk_bf16_f32 v93, v14, v15
    s_add_u32 m0, s78, 20480
    s_add_u32 s81, s81, 1
    s_cmp_eq_u32 s81, 9
    global_load_lds_dwordx4 v[16:17], off
    s_cselect_b32 s90, -8, 1
    s_cselect_b32 s81, 0, s81
    v_mad_i64_i32 v[16:17], vcc, v18, s90, v[16:17]
    v_mul_f32 v12, v52, v52
    v_mul_f32 v13, v53, v53
    v_mul_f32 v14, v54, v54
    v_mul_f32 v15, v55, v55
    v_fmamk_f32 v12, v12, 0xbdd2d3e8, v1
    v_fmamk_f32 v13, v13, 0xbdd2d3e8, v1
    v_fmamk_f32 v14, v14, 0xbdd2d3e8, v1
    v_fmamk_f32 v15, v15, 0xbdd2d3e8, v1
    v_mul_f32 v12, v12, v52
    v_mul_f32 v13, v13, v53
    v_mul_f32 v14, v14, v54
    v_mul_f32 v15, v15, v55
    v_exp_f32 v12, v12
    v_exp_f32 v13, v13
    v_exp_f32 v14, v14
    v_exp_f32 v15, v15
    v_add_f32 v12, 1.0, v12
    v_add_f32 v13, 1.0, v13
    v_add_f32 v14, 1.0, v14
    v_add_f32 v15, 1.0, v15
    v_rcp_f32 v12, v12
    v_rcp_f32 v13, v13
    v_rcp_f32 v14, v14
    v_rcp_f32 v15, v15
    v_mul_f32 v12, v12, v52
    v_mul_f32 v13, v13, v53
    v_mul_f32 v14, v14, v54
    v_mul_f32 v15, v15, v55
    v_cvt_pk_bf16_f32 v94, v12, v13
    v_cvt_pk_bf16_f32 v95, v14, v15
    ds_write_b128 v21, v[92:95] offset:8192
    v_add_u32 v8, 0x10000, v8
    s_waitcnt vmcnt(8) lgkmcnt(1)
    s_barrier
    ds_read_b64_tr_b16 v[104:105], v8
    v_mfma_f32_16x16x32_bf16 v[68:71], v[24:27], v[240:243], v[68:71]
    ds_read_b64_tr_b16 v[106:107], v8 offset:256
    s_add_u32 m0, s78, 28672
    v_mfma_f32_16x16x32_bf16 v[68:71], v[28:31], v[244:247], v[68:71]
    ds_read_b64_tr_b16 v[108:109], v8 offset:2048
    s_add_u32 s81, s81, 1
    v_mfma_f32_16x16x32_bf16 v[64:67], v[24:27], v[168:171], v[64:67]
    ds_read_b64_tr_b16 v[110:111], v8 offset:2304
    s_cmp_eq_u32 s81, 9
    v_mfma_f32_16x16x32_bf16 v[64:67], v[28:31], v[172:175], v[64:67]
    ds_read_b64_tr_b16 v[24:25], v8 offset:4096
    v_mfma_f32_16x16x32_bf16 v[64:67], v[32:35], v[176:179], v[64:67]
    ds_read_b64_tr_b16 v[26:27], v8 offset:4352
    global_load_lds_dwordx4 v[16:17], off
    v_mfma_f32_16x16x32_bf16 v[64:67], v[36:39], v[180:183], v[64:67]
    ds_read_b64_tr_b16 v[28:29], v8 offset:6144
    v_mfma_f32_16x16x32_bf16 v[68:71], v[32:35], v[248:251], v[68:71]
    ds_read_b64_tr_b16 v[30:31], v8 offset:6400
    s_cselect_b32 s90, -8, 1
    v_mfma_f32_16x16x32_bf16 v[68:71], v[36:39], v[252:255], v[68:71]
    ds_read_b64_tr_b16 v[32:33], v8 offset:8192
    s_waitcnt lgkmcnt(5)
    v_mfma_f32_16x16x32_bf16 v[44:47], v[104:107], v[184:187], v[40:43]
    ds_read_b64_tr_b16 v[34:35], v8 offset:8448
    s_cselect_b32 s81, 0, s81
    v_mfma_f32_16x16x32_bf16 v[44:47], v[108:111], v[188:191], v[44:47]
    ds_read_b64_tr_b16 v[36:37], v8 offset:10240
    v_mad_i64_i32 v[16:17], vcc, v18, s90, v[16:17]
    v_mfma_f32_16x16x32_bf16 v[40:43], v[104:107], v[112:115], v[40:43]
    ds_read_b64_tr_b16 v[38:39], v8 offset:10496
    v_mfma_f32_16x16x32_bf16 v[40:43], v[108:111], v[116:119], v[40:43]
    ds_read_b64_tr_b16 v[104:105], v8 offset:12288
    s_waitcnt lgkmcnt(5)
    v_mfma_f32_16x16x32_bf16 v[40:43], v[24:27], v[120:123], v[40:43]
    ds_read_b64_tr_b16 v[106:107], v8 offset:12544
    v_mfma_f32_16x16x32_bf16 v[40:43], v[28:31], v[124:127], v[40:43]
    ds_read_b64_tr_b16 v[108:109], v8 offset:14336
    v_mfma_f32_16x16x32_bf16 v[44:47], v[24:27], v[192:195], v[44:47]
    ds_read_b64_tr_b16 v[110:111], v8 offset:14592
    v_mfma_f32_16x16x32_bf16 v[44:47], v[28:31], v[196:199], v[44:47]
    s_add_u32 m0, s78, 36864
    s_add_u32 s81, s81, 1
    s_cmp_eq_u32 s81, 9
    global_load_lds_dwordx4 v[16:17], off
    s_cselect_b32 s90, -8, 1
    s_cselect_b32 s81, 0, s81
    v_mad_i64_i32 v[16:17], vcc, v18, s90, v[16:17]
    v_mul_f32 v12, v56, v56
    v_mul_f32 v13, v57, v57
    v_mul_f32 v14, v58, v58
    v_mul_f32 v15, v59, v59
    v_fmamk_f32 v12, v12, 0xbdd2d3e8, v1
    v_fmamk_f32 v13, v13, 0xbdd2d3e8, v1
    v_fmamk_f32 v14, v14, 0xbdd2d3e8, v1
    s_add_u32 m0, s78, 45056
    s_add_u32 s81, s81, 1
    s_cmp_eq_u32 s81, 9
    global_load_lds_dwordx4 v[16:17], off
    s_cselect_b32 s90, -8, 1
    s_cselect_b32 s81, 0, s81
    v_mad_i64_i32 v[16:17], vcc, v18, s90, v[16:17]
    v_fmamk_f32 v15, v15, 0xbdd2d3e8, v1
    v_mul_f32 v12, v12, v56
    v_mul_f32 v13, v13, v57
    v_mul_f32 v14, v14, v58
    v_mul_f32 v15, v15, v59
    v_exp_f32 v12, v12
    v_exp_f32 v13, v13
    v_exp_f32 v14, v14
    v_exp_f32 v15, v15
    v_add_f32 v12, 1.0, v12
    v_add_f32 v13, 1.0, v13
    v_add_f32 v14, 1.0, v14
    v_add_f32 v15, 1.0, v15
    v_rcp_f32 v12, v12
    v_rcp_f32 v13, v13
    v_rcp_f32 v14, v14
    v_rcp_f32 v15, v15
    v_mul_f32 v12, v12, v56
    v_mul_f32 v13, v13, v57
    v_mul_f32 v14, v14, v58
    v_mul_f32 v15, v15, v59
    v_cvt_pk_bf16_f32 v96, v12, v13
    v_cvt_pk_bf16_f32 v97, v14, v15
    s_waitcnt vmcnt(8) lgkmcnt(0)
    s_barrier
    ds_read_b64_tr_b16 v[24:25], v8 offset:24576
    v_mfma_f32_16x16x32_bf16 v[44:47], v[32:35], v[200:203], v[44:47]
    ds_read_b64_tr_b16 v[26:27], v8 offset:24832
    s_add_u32 m0, s78, 53248
    v_mfma_f32_16x16x32_bf16 v[44:47], v[36:39], v[204:207], v[44:47]
    ds_read_b64_tr_b16 v[28:29], v8 offset:26624
    s_add_u32 s81, s81, 1
    v_mfma_f32_16x16x32_bf16 v[40:43], v[32:35], v[128:131], v[40:43]
    ds_read_b64_tr_b16 v[30:31], v8 offset:26880
    v_mfma_f32_16x16x32_bf16 v[40:43], v[36:39], v[132:135], v[40:43]
    ds_read_b64_tr_b16 v[32:33], v8 offset:28672
    v_mfma_f32_16x16x32_bf16 v[40:43], v[104:107], v[136:139], v[40:43]
    ds_read_b64_tr_b16 v[34:35], v8 offset:28928
    s_cmp_eq_u32 s81, 9
    v_mfma_f32_16x16x32_bf16 v[40:43], v[108:111], v[140:143], v[40:43]
    ds_read_b64_tr_b16 v[36:37], v8 offset:30720
    v_mfma_f32_16x16x32_bf16 v[44:47], v[104:107], v[208:211], v[44:47]
    ds_read_b64_tr_b16 v[38:39], v8 offset:30976
    global_load_lds_dwordx4 v[16:17], off
    v_mfma_f32_16x16x32_bf16 v[44:47], v[108:111], v[212:215], v[44:47]
    ds_read_b64_tr_b16 v[104:105], v8 offset:32768
    s_waitcnt lgkmcnt(5)
    v_mfma_f32_16x16x32_bf16 v[44:47], v[24:27], v[216:219], v[44:47]
    ds_read_b64_tr_b16 v[106:107], v8 offset:33024
    s_cselect_b32 s90, -8, 1
    v_mfma_f32_16x16x32_bf16 v[44:47], v[28:31], v[220:223], v[44:47]
    ds_read_b64_tr_b16 v[108:109], v8 offset:34816
    v_mfma_f32_16x16x32_bf16 v[40:43], v[24:27], v[144:147], v[40:43]
    ds_read_b64_tr_b16 v[110:111], v8 offset:35072
    s_cselect_b32 s81, 0, s81
    v_mfma_f32_16x16x32_bf16 v[40:43], v[28:31], v[148:151], v[40:43]
    ds_read_b64_tr_b16 v[24:25], v8 offset:36864
    s_waitcnt lgkmcnt(5)
    v_mfma_f32_16x16x32_bf16 v[40:43], v[32:35], v[152:155], v[40:43]
    ds_read_b64_tr_b16 v[26:27], v8 offset:37120
    v_mfma_f32_16x16x32_bf16 v[40:43], v[36:39], v[156:159], v[40:43]
    ds_read_b64_tr_b16 v[28:29], v8 offset:38912
    v_mad_i64_i32 v[16:17], vcc, v18, s90, v[16:17]
    v_mfma_f32_16x16x32_bf16 v[44:47], v[32:35], v[224:227], v[44:47]
    ds_read_b64_tr_b16 v[30:31], v8 offset:39168
    v_mfma_f32_16x16x32_bf16 v[44:47], v[36:39], v[228:231], v[44:47]
    ds_read_b64_tr_b16 v[32:33], v8 offset:16384
    s_waitcnt lgkmcnt(5)
    v_mfma_f32_16x16x32_bf16 v[44:47], v[104:107], v[232:235], v[44:47]
    ds_read_b64_tr_b16 v[34:35], v8 offset:16640
    v_mfma_f32_16x16x32_bf16 v[44:47], v[108:111], v[236:239], v[44:47]
    ds_read_b64_tr_b16 v[36:37], v8 offset:18432
    v_mfma_f32_16x16x32_bf16 v[40:43], v[104:107], v[160:163], v[40:43]
    ds_read_b64_tr_b16 v[38:39], v8 offset:18688
    v_mfma_f32_16x16x32_bf16 v[40:43], v[108:111], v[164:167], v[40:43]
    s_add_u32 m0, s78, 61440
    s_nop 0
    global_load_lds_dwordx4 v[16:17], off
    v_mul_f32 v12, v64, v64
    v_mul_f32 v13, v65, v65
    v_mul_f32 v14, v66, v66
    v_mul_f32 v15, v67, v67
    v_fmamk_f32 v12, v12, 0xbdd2d3e8, v1
    v_fmamk_f32 v13, v13, 0xbdd2d3e8, v1
    v_fmamk_f32 v14, v14, 0xbdd2d3e8, v1
    s_add_u32 m0, s78, 69632
    s_add_u32 s90, s82, 1024
    buffer_load_dwordx4 v20, s[40:43], s90 offen  lds
    v_fmamk_f32 v15, v15, 0xbdd2d3e8, v1
    v_mul_f32 v12, v12, v64
    v_mul_f32 v13, v13, v65
    v_mul_f32 v14, v14, v66
    v_mul_f32 v15, v15, v67
    v_exp_f32 v12, v12
    v_exp_f32 v13, v13
    v_exp_f32 v14, v14
    v_exp_f32 v15, v15
    v_add_f32 v12, 1.0, v12
    v_add_f32 v13, 1.0, v13
    v_add_f32 v14, 1.0, v14
    v_add_f32 v15, 1.0, v15
    v_rcp_f32 v12, v12
    v_rcp_f32 v13, v13
    v_rcp_f32 v14, v14
    v_rcp_f32 v15, v15
    v_mul_f32 v12, v12, v64
    v_mul_f32 v13, v13, v65
    v_mul_f32 v14, v14, v66
    v_mul_f32 v15, v15, v67
    v_cvt_pk_bf16_f32 v98, v12, v13
    v_cvt_pk_bf16_f32 v99, v14, v15
    v_add_u32 v10, 0x15000, v10
    v_add_u32 v9, 0x15000, v9
    s_waitcnt vmcnt(7) lgkmcnt(0)
    s_barrier
    ds_read_b64_tr_b16 v[104:105], v9
    v_mfma_f32_16x16x32_bf16 v[40:43], v[24:27], v[168:171], v[40:43]
    ds_read_b64_tr_b16 v[106:107], v9 offset:512
    v_mfma_f32_16x16x32_bf16 v[40:43], v[28:31], v[172:175], v[40:43]
    v_add_u32 v9, 0xfffeb000, v9
    ds_read_b64_tr_b16 v[108:109], v9
    v_mfma_f32_16x16x32_bf16 v[44:47], v[24:27], v[240:243], v[44:47]
    ds_read_b64_tr_b16 v[110:111], v9 offset:512
    v_mfma_f32_16x16x32_bf16 v[44:47], v[28:31], v[244:247], v[44:47]
    ds_read_b64_tr_b16 v[24:25], v10
    v_mfma_f32_16x16x32_bf16 v[44:47], v[32:35], v[248:251], v[44:47]
    ds_read_b64_tr_b16 v[26:27], v10 offset:512
    v_mfma_f32_16x16x32_bf16 v[44:47], v[36:39], v[252:255], v[44:47]
    v_add_u32 v10, 0xfffeb000, v10
    ds_read_b64_tr_b16 v[28:29], v10
    v_mfma_f32_16x16x32_bf16 v[40:43], v[32:35], v[176:179], v[40:43]
    ds_read_b64_tr_b16 v[30:31], v10 offset:512
    v_mfma_f32_16x16x32_bf16 v[40:43], v[36:39], v[180:183], v[40:43]
    ds_read_b64_tr_b16 v[32:33], v9 offset:4096
    s_waitcnt lgkmcnt(5)
    v_mfma_f32_16x16x32_bf16 v[48:51], v[104:107], v[112:115], 0
    ds_read_b64_tr_b16 v[34:35], v9 offset:4608
    v_mfma_f32_16x16x32_bf16 v[48:51], v[108:111], v[116:119], v[48:51]
    ds_read_b64_tr_b16 v[36:37], v9 offset:8192
    v_mfma_f32_16x16x32_bf16 v[52:55], v[104:107], v[184:187], 0
    ds_read_b64_tr_b16 v[38:39], v9 offset:8704
    v_mfma_f32_16x16x32_bf16 v[52:55], v[108:111], v[188:191], v[52:55]
    ds_read_b64_tr_b16 v[104:105], v10 offset:4096
    s_waitcnt lgkmcnt(5)
    v_mfma_f32_16x16x32_bf16 v[56:59], v[24:27], v[112:115], 0
    ds_read_b64_tr_b16 v[106:107], v10 offset:4608
    ds_read_b64_tr_b16 v[108:109], v10 offset:8192
    v_mfma_f32_16x16x32_bf16 v[56:59], v[28:31], v[116:119], v[56:59]
    ds_read_b64_tr_b16 v[110:111], v10 offset:8704
    ds_read_b64_tr_b16 v[24:25], v9 offset:12288
    s_waitcnt lgkmcnt(5)
    v_mfma_f32_16x16x32_bf16 v[48:51], v[32:35], v[120:123], v[48:51]
    ds_read_b64_tr_b16 v[26:27], v9 offset:12800
    v_mfma_f32_16x16x32_bf16 v[48:51], v[36:39], v[124:127], v[48:51]
    ds_read_b64_tr_b16 v[28:29], v9 offset:16384
    v_mfma_f32_16x16x32_bf16 v[52:55], v[32:35], v[192:195], v[52:55]
    ds_read_b64_tr_b16 v[30:31], v9 offset:16896
    v_mfma_f32_16x16x32_bf16 v[52:55], v[36:39], v[196:199], v[52:55]
    ds_read_b64_tr_b16 v[32:33], v10 offset:12288
    ds_read_b64_tr_b16 v[34:35], v10 offset:12800
    s_waitcnt lgkmcnt(6)
    v_mfma_f32_16x16x32_bf16 v[56:59], v[104:107], v[120:123], v[56:59]
    ds_read_b64_tr_b16 v[36:37], v10 offset:16384
    ds_read_b64_tr_b16 v[38:39], v10 offset:16896
    v_mfma_f32_16x16x32_bf16 v[56:59], v[108:111], v[124:127], v[56:59]
    s_add_u32 m0, s78, 94208
    s_add_u32 s90, s82, 148480
    buffer_load_dwordx4 v20, s[40:43], s90 offen  lds
    v_mul_f32 v12, v60, v60
    v_mul_f32 v13, v61, v61
    v_mul_f32 v14, v62, v62
    v_mul_f32 v15, v63, v63
    v_fmamk_f32 v12, v12, 0xbdd2d3e8, v1
    v_fmamk_f32 v13, v13, 0xbdd2d3e8, v1
    v_fmamk_f32 v14, v14, 0xbdd2d3e8, v1
    s_add_u32 m0, s78, 98304
    s_add_u32 s90, s82, 185344
    buffer_load_dwordx4 v20, s[40:43], s90 offen  lds
L_h1page0:
    s_cbranch_execz L_h1page4
    v_fmamk_f32 v15, v15, 0xbdd2d3e8, v1
    v_mul_f32 v12, v12, v60
    v_mul_f32 v13, v13, v61
    v_mul_f32 v14, v14, v62
    v_mul_f32 v15, v15, v63
    v_exp_f32 v12, v12
    v_exp_f32 v13, v13
    v_exp_f32 v14, v14
    v_exp_f32 v15, v15
    v_add_f32 v12, 1.0, v12
    v_add_f32 v13, 1.0, v13
    v_add_f32 v14, 1.0, v14
    v_add_f32 v15, 1.0, v15
    v_rcp_f32 v12, v12
    v_rcp_f32 v13, v13
    v_rcp_f32 v14, v14
    v_rcp_f32 v15, v15
    v_mul_f32 v12, v12, v60
    v_mul_f32 v13, v13, v61
    v_mul_f32 v14, v14, v62
    v_mul_f32 v15, v15, v63
    v_cvt_pk_bf16_f32 v100, v12, v13
    v_cvt_pk_bf16_f32 v101, v14, v15
    s_waitcnt vmcnt(6) lgkmcnt(0)
    s_barrier
    ds_read_b64_tr_b16 v[124:125], v9 offset:20480
    ds_read_b64_tr_b16 v[126:127], v9 offset:20992
    v_mfma_f32_16x16x32_bf16 v[48:51], v[24:27], v[128:131], v[48:51]
    ds_read_b64_tr_b16 v[196:197], v9 offset:24576
    ds_read_b128 v[112:115], v21 offset:45056
    v_mfma_f32_16x16x32_bf16 v[48:51], v[28:31], v[132:135], v[48:51]
    ds_read_b64_tr_b16 v[198:199], v9 offset:25088
    ds_read_b128 v[184:187], v21 offset:36864
    v_mfma_f32_16x16x32_bf16 v[52:55], v[24:27], v[200:203], v[52:55]
    ds_read_b128 v[116:119], v21 offset:28672
    v_mfma_f32_16x16x32_bf16 v[52:55], v[28:31], v[204:207], v[52:55]
    ds_read_b64_tr_b16 v[24:25], v10 offset:20480
    v_mfma_f32_16x16x32_bf16 v[56:59], v[32:35], v[128:131], v[56:59]
    ds_read_b64_tr_b16 v[26:27], v10 offset:20992
    ds_read_b64_tr_b16 v[28:29], v10 offset:24576
    v_mfma_f32_16x16x32_bf16 v[56:59], v[36:39], v[132:135], v[56:59]
    ds_read_b64_tr_b16 v[30:31], v10 offset:25088
    ds_read_b64_tr_b16 v[32:33], v9 offset:28672
    s_waitcnt lgkmcnt(7)
    v_mfma_f32_16x16x32_bf16 v[48:51], v[124:127], v[136:139], v[48:51]
    ds_read_b64_tr_b16 v[34:35], v9 offset:29184
    v_mfma_f32_16x16x32_bf16 v[48:51], v[196:199], v[140:143], v[48:51]
    ds_read_b64_tr_b16 v[36:37], v9 offset:32768
    ds_read_b128 v[188:191], v21 offset:20480
    v_mfma_f32_16x16x32_bf16 v[52:55], v[124:127], v[208:211], v[52:55]
    ds_read_b64_tr_b16 v[38:39], v9 offset:33280
    ds_read_b128 v[120:123], v21 offset:12288
    v_mfma_f32_16x16x32_bf16 v[52:55], v[196:199], v[212:215], v[52:55]
    ds_read_b64_tr_b16 v[124:125], v10 offset:28672
    s_waitcnt lgkmcnt(7)
    v_mfma_f32_16x16x32_bf16 v[56:59], v[24:27], v[136:139], v[56:59]
    ds_read_b64_tr_b16 v[126:127], v10 offset:29184
    ds_read_b64_tr_b16 v[196:197], v10 offset:32768
    v_mfma_f32_16x16x32_bf16 v[56:59], v[28:31], v[140:143], v[56:59]
    ds_read_b64_tr_b16 v[198:199], v10 offset:33280
    ds_read_b64_tr_b16 v[24:25], v9 offset:36864
    s_waitcnt lgkmcnt(6)
    v_mfma_f32_16x16x32_bf16 v[48:51], v[32:35], v[144:147], v[48:51]
    ds_read_b64_tr_b16 v[26:27], v9 offset:37376
    ds_read_b128 v[192:195], v21 offset:4096
    v_mfma_f32_16x16x32_bf16 v[48:51], v[36:39], v[148:151], v[48:51]
    ds_read_b64_tr_b16 v[28:29], v9 offset:40960
    v_mfma_f32_16x16x32_bf16 v[52:55], v[32:35], v[216:219], v[52:55]
    ds_read_b64_tr_b16 v[30:31], v9 offset:41472
    v_mfma_f32_16x16x32_bf16 v[52:55], v[36:39], v[220:223], v[52:55]
    ds_read_b64_tr_b16 v[32:33], v10 offset:36864
    ds_read_b64_tr_b16 v[34:35], v10 offset:37376
    s_waitcnt lgkmcnt(7)
    v_mfma_f32_16x16x32_bf16 v[56:59], v[124:127], v[144:147], v[56:59]
    ds_read_b64_tr_b16 v[36:37], v10 offset:40960
    ds_read_b64_tr_b16 v[38:39], v10 offset:41472
    v_mfma_f32_16x16x32_bf16 v[56:59], v[196:199], v[148:151], v[56:59]
    s_add_u32 m0, s78, 81920
    s_add_u32 s90, s82, 73728
    buffer_load_dwordx4 v20, s[40:43], s90 offen  lds
    v_mul_f32 v12, v68, v68
    v_mul_f32 v13, v69, v69
    v_mul_f32 v14, v70, v70
    v_mul_f32 v15, v71, v71
    v_fmamk_f32 v12, v12, 0xbdd2d3e8, v1
    v_fmamk_f32 v13, v13, 0xbdd2d3e8, v1
    v_fmamk_f32 v14, v14, 0xbdd2d3e8, v1
    v_fmamk_f32 v15, v15, 0xbdd2d3e8, v1
    v_mul_f32 v12, v12, v68
    s_add_u32 m0, s78, 86016
    s_add_u32 s90, s82, 110592
    buffer_load_dwordx4 v20, s[40:43], s90 offen  lds
    v_mul_f32 v13, v13, v69
    v_mul_f32 v14, v14, v70
    v_mul_f32 v15, v15, v71
    v_exp_f32 v12, v12
    v_exp_f32 v13, v13
    v_exp_f32 v14, v14
    v_exp_f32 v15, v15
    v_add_f32 v12, 1.0, v12
    v_add_f32 v13, 1.0, v13
    v_add_f32 v14, 1.0, v14
    v_add_f32 v15, 1.0, v15
    v_rcp_f32 v12, v12
    v_rcp_f32 v13, v13
    v_rcp_f32 v14, v14
    v_rcp_f32 v15, v15
    v_mul_f32 v12, v12, v68
    v_mul_f32 v13, v13, v69
    v_mul_f32 v14, v14, v70
    v_mul_f32 v15, v15, v71
    v_cvt_pk_bf16_f32 v102, v12, v13
    v_cvt_pk_bf16_f32 v103, v14, v15
    v_and_b32 v134, 0x300, v0
    v_mad_i32_i24 v128, v134, -2, v2
    v_mad_i32_i24 v129, v134, -2, v3
    v_mad_i32_i24 v130, v134, -2, v4
    v_mad_i32_i24 v131, v134, -2, v5
    v_add_u32 v132, 0x20000, v128
    v_add_u32 v133, 0x20000, v129
    v_add_u32 v10, 0xb000, v10
    v_add_u32 v9, 0xb000, v9
    s_waitcnt vmcnt(5) lgkmcnt(0)
    s_barrier
    ds_read_b64_tr_b16 v[136:137], v9
    ds_read_b64_tr_b16 v[138:139], v9 offset:512
    v_mfma_f32_16x16x32_bf16 v[48:51], v[24:27], v[152:155], v[48:51]
    ds_read_b64_tr_b16 v[140:141], v9 offset:4096
    v_mfma_f32_16x16x32_bf16 v[48:51], v[28:31], v[156:159], v[48:51]
    ds_read_b64_tr_b16 v[142:143], v9 offset:4608
    v_mfma_f32_16x16x32_bf16 v[52:55], v[24:27], v[224:227], v[52:55]
    v_mfma_f32_16x16x32_bf16 v[52:55], v[28:31], v[228:231], v[52:55]
    ds_read_b64_tr_b16 v[24:25], v10
    v_mfma_f32_16x16x32_bf16 v[56:59], v[32:35], v[152:155], v[56:59]
    ds_read_b64_tr_b16 v[26:27], v10 offset:512
    ds_read_b64_tr_b16 v[28:29], v10 offset:4096
    v_mfma_f32_16x16x32_bf16 v[56:59], v[36:39], v[156:159], v[56:59]
    ds_read_b64_tr_b16 v[30:31], v10 offset:4608
    ds_read_b64_tr_b16 v[32:33], v9 offset:8192
    s_waitcnt lgkmcnt(5)
    v_mfma_f32_16x16x32_bf16 v[48:51], v[136:139], v[160:163], v[48:51]
    ds_read_b64_tr_b16 v[34:35], v9 offset:8704
    v_mfma_f32_16x16x32_bf16 v[48:51], v[140:143], v[164:167], v[48:51]
    ds_read_b64_tr_b16 v[36:37], v9 offset:12288
    v_mfma_f32_16x16x32_bf16 v[52:55], v[136:139], v[232:235], v[52:55]
    ds_read_b64_tr_b16 v[38:39], v9 offset:12800
    v_mfma_f32_16x16x32_bf16 v[52:55], v[140:143], v[236:239], v[52:55]
    ds_read_b64_tr_b16 v[136:137], v10 offset:8192
    s_waitcnt lgkmcnt(5)
    v_mfma_f32_16x16x32_bf16 v[56:59], v[24:27], v[160:163], v[56:59]
    ds_read_b64_tr_b16 v[138:139], v10 offset:8704
    ds_read_b64_tr_b16 v[140:141], v10 offset:12288
    v_mfma_f32_16x16x32_bf16 v[56:59], v[28:31], v[164:167], v[56:59]
    ds_read_b64_tr_b16 v[142:143], v10 offset:12800
    ds_read_b64_tr_b16 v[24:25], v9 offset:16384
    s_waitcnt lgkmcnt(5)
    v_mfma_f32_16x16x32_bf16 v[48:51], v[32:35], v[168:171], v[48:51]
    ds_read_b64_tr_b16 v[26:27], v9 offset:16896
    v_mfma_f32_16x16x32_bf16 v[48:51], v[36:39], v[172:175], v[48:51]
    ds_read_b64_tr_b16 v[28:29], v9 offset:20480
    v_mfma_f32_16x16x32_bf16 v[52:55], v[32:35], v[240:243], v[52:55]
    ds_read_b64_tr_b16 v[30:31], v9 offset:20992
    v_mfma_f32_16x16x32_bf16 v[52:55], v[36:39], v[244:247], v[52:55]
    ds_read_b64_tr_b16 v[32:33], v10 offset:16384
    s_waitcnt lgkmcnt(5)
    v_mfma_f32_16x16x32_bf16 v[56:59], v[136:139], v[168:171], v[56:59]
    ds_read_b64_tr_b16 v[34:35], v10 offset:16896
    ds_read_b64_tr_b16 v[36:37], v10 offset:20480
    v_mfma_f32_16x16x32_bf16 v[56:59], v[140:143], v[172:175], v[56:59]
    ds_read_b64_tr_b16 v[38:39], v10 offset:20992
    s_add_u32 m0, s78, 4096
    s_add_u32 s90, s82, 259072
    buffer_load_dwordx4 v20, s[40:43], s90 offen  lds
    v_mul_f32 v12, v40, v40
    v_mul_f32 v13, v41, v41
    v_mul_f32 v14, v42, v42
    v_mul_f32 v15, v43, v43
    v_fmamk_f32 v12, v12, 0xbdd2d3e8, v1
    s_add_u32 m0, s78, 8192
    s_add_u32 s90, s82, 221184
    buffer_load_dwordx4 v20, s[40:43], s90 offen  lds
    v_fmamk_f32 v13, v13, 0xbdd2d3e8, v1
    v_fmamk_f32 v14, v14, 0xbdd2d3e8, v1
    v_fmamk_f32 v15, v15, 0xbdd2d3e8, v1
    v_mul_f32 v12, v12, v40
    v_mul_f32 v13, v13, v41
    s_add_u32 m0, s78, 12288
    s_add_u32 s90, s82, 258048
    buffer_load_dwordx4 v20, s[40:43], s90 offen  lds
    v_mul_f32 v14, v14, v42
    v_mul_f32 v15, v15, v43
    v_exp_f32 v12, v12
    v_exp_f32 v13, v13
    v_exp_f32 v14, v14
    v_exp_f32 v15, v15
    v_add_f32 v12, 1.0, v12
    v_add_f32 v13, 1.0, v13
    v_add_f32 v14, 1.0, v14
    v_add_f32 v15, 1.0, v15
    v_rcp_f32 v12, v12
    v_rcp_f32 v13, v13
    v_rcp_f32 v14, v14
    v_rcp_f32 v15, v15
    v_mul_f32 v12, v12, v40
    v_mul_f32 v13, v13, v41
    v_mul_f32 v14, v14, v42
    v_mul_f32 v15, v15, v43
    v_cvt_pk_bf16_f32 v104, v12, v13
    v_cvt_pk_bf16_f32 v105, v14, v15
    s_waitcnt vmcnt(5) lgkmcnt(0)
    s_barrier
    ds_read_b64_tr_b16 v[136:137], v130 offset:4096
    v_mfma_f32_16x16x32_bf16 v[48:51], v[24:27], v[176:179], v[48:51]
    ds_read_b64_tr_b16 v[138:139], v130 offset:6144
    v_mfma_f32_16x16x32_bf16 v[48:51], v[28:31], v[180:183], v[48:51]
    ds_read_b64_tr_b16 v[140:141], v130 offset:8192
    v_mfma_f32_16x16x32_bf16 v[52:55], v[24:27], v[248:251], v[52:55]
    ds_read_b64_tr_b16 v[142:143], v130 offset:10240
    v_mfma_f32_16x16x32_bf16 v[52:55], v[28:31], v[252:255], v[52:55]
    ds_read_b64_tr_b16 v[24:25], v130 offset:12288
    v_mfma_f32_16x16x32_bf16 v[56:59], v[32:35], v[176:179], v[56:59]
    ds_read_b64_tr_b16 v[26:27], v130 offset:14336
    ds_read_b64_tr_b16 v[28:29], v130 offset:24576
    v_mfma_f32_16x16x32_bf16 v[56:59], v[36:39], v[180:183], v[56:59]
    ds_read_b64_tr_b16 v[30:31], v130 offset:26624
    ds_read_b64_tr_b16 v[32:33], v130 offset:28672
    s_waitcnt lgkmcnt(5)
    v_mfma_f32_16x16x32_bf16 v[144:147], v[136:139], v[72:75], 0
    ds_read_b64_tr_b16 v[34:35], v130 offset:30720
    v_mfma_f32_16x16x32_bf16 v[144:147], v[140:143], v[112:115], v[144:147]
    ds_read_b64_tr_b16 v[36:37], v130 offset:32768
    v_mfma_f32_16x16x32_bf16 v[148:151], v[136:139], v[76:79], 0
    ds_read_b64_tr_b16 v[38:39], v130 offset:34816
    v_mfma_f32_16x16x32_bf16 v[148:151], v[140:143], v[184:187], v[148:151]
    ds_read_b64_tr_b16 v[136:137], v131 offset:4096
    s_waitcnt lgkmcnt(5)
    v_mfma_f32_16x16x32_bf16 v[148:151], v[24:27], v[84:87], v[148:151]
    ds_read_b64_tr_b16 v[138:139], v131 offset:6144
    v_mfma_f32_16x16x32_bf16 v[148:151], v[28:31], v[188:191], v[148:151]
    ds_read_b64_tr_b16 v[140:141], v131 offset:8192
    v_mfma_f32_16x16x32_bf16 v[144:147], v[24:27], v[80:83], v[144:147]
    ds_read_b64_tr_b16 v[142:143], v131 offset:10240
    v_mfma_f32_16x16x32_bf16 v[144:147], v[28:31], v[116:119], v[144:147]
    ds_read_b64_tr_b16 v[24:25], v131 offset:12288
    s_waitcnt lgkmcnt(5)
    v_mfma_f32_16x16x32_bf16 v[144:147], v[32:35], v[88:91], v[144:147]
    ds_read_b64_tr_b16 v[26:27], v131 offset:14336
    v_mfma_f32_16x16x32_bf16 v[144:147], v[36:39], v[120:123], v[144:147]
    ds_read_b64_tr_b16 v[28:29], v131 offset:24576
    v_mfma_f32_16x16x32_bf16 v[148:151], v[32:35], v[92:95], v[148:151]
    ds_read_b64_tr_b16 v[30:31], v131 offset:26624
    v_mfma_f32_16x16x32_bf16 v[148:151], v[36:39], v[192:195], v[148:151]
    ds_read_b64_tr_b16 v[32:33], v131 offset:28672
    s_waitcnt lgkmcnt(5)
    v_mfma_f32_16x16x32_bf16 v[152:155], v[136:139], v[72:75], 0
    ds_read_b64_tr_b16 v[34:35], v131 offset:30720
    v_mfma_f32_16x16x32_bf16 v[152:155], v[140:143], v[112:115], v[152:155]
    ds_read_b64_tr_b16 v[36:37], v131 offset:32768
    v_mfma_f32_16x16x32_bf16 v[156:159], v[136:139], v[76:79], 0
    ds_read_b64_tr_b16 v[38:39], v131 offset:34816
    v_mfma_f32_16x16x32_bf16 v[156:159], v[140:143], v[184:187], v[156:159]
    ds_read_b64_tr_b16 v[136:137], v130 offset:36864
    s_waitcnt lgkmcnt(5)
    v_mfma_f32_16x16x32_bf16 v[156:159], v[24:27], v[84:87], v[156:159]
    ds_read_b64_tr_b16 v[138:139], v130 offset:38912
    v_mfma_f32_16x16x32_bf16 v[156:159], v[28:31], v[188:191], v[156:159]
    ds_read_b64_tr_b16 v[140:141], v128
    v_mfma_f32_16x16x32_bf16 v[152:155], v[24:27], v[80:83], v[152:155]
    ds_read_b64_tr_b16 v[142:143], v128 offset:2048
    v_mfma_f32_16x16x32_bf16 v[152:155], v[28:31], v[116:119], v[152:155]
    ds_read_b64_tr_b16 v[24:25], v131 offset:36864
    s_waitcnt lgkmcnt(5)
    v_mfma_f32_16x16x32_bf16 v[152:155], v[32:35], v[88:91], v[152:155]
    ds_read_b64_tr_b16 v[26:27], v131 offset:38912
    v_mfma_f32_16x16x32_bf16 v[152:155], v[36:39], v[120:123], v[152:155]
    ds_read_b64_tr_b16 v[28:29], v129
    v_mfma_f32_16x16x32_bf16 v[156:159], v[32:35], v[92:95], v[156:159]
    ds_read_b64_tr_b16 v[30:31], v129 offset:2048
    v_mfma_f32_16x16x32_bf16 v[156:159], v[36:39], v[192:195], v[156:159]
    ds_write_b128 v21, v[96:99] offset:12288
    ds_write_b128 v21, v[100:103] offset:20480
    v_and_b32 v64, 15, v22
    v_lshrrev_b32 v65, 4, v22
    s_mul_i32 s88, s73, 3328
    s_add_u32 s88, s88, 143360
    v_mov_b32 v67, 0x3eae1a93
    v_cmp_eq_u32 vcc, 0, v65
    v_mul_u32_u24 v66, 104, v64
    v_add_u32 v66, s88, v66
    v_cndmask_b32 v69, 1.0, v67, vcc
    v_lshl_add_u32 v68, v65, 3, v66
    v_mul_f32 v56, v56, v69
    v_mul_f32 v57, v57, v69
    v_mul_f32 v58, v58, v69
    v_mul_f32 v59, v59, v69
    v_cvt_pk_bf16_f32 v204, v56, v57
    v_cvt_pk_bf16_f32 v205, v58, v59
    ds_write_b64 v68, v[204:205] offset:64
    s_cmp_lt_u32 s85, 4
    s_cbranch_scc0 L_skip_30
    s_cmp_ge_u32 s85, 2
    s_cbranch_scc0 L_skip_28
    v_and_b32 v69, 3, v22
    v_min_u32 v69, 2, v69
    v_lshl_add_u32 v69, v69, 3, s88
    v_bfe_u32 v70, v22, 2, 3
    v_and_b32 v200, 4, v70
    v_add_u32 v70, v70, v200
    v_mul_u32_u24 v70, 104, v70
    v_add_u32 v69, v69, v70
    ds_read_b64_tr_b16 v[200:201], v69 offset:72
    ds_read_b64_tr_b16 v[202:203], v69 offset:488
L_skip_28:
    s_cmp_lt_u32 s85, 2
    s_cbranch_scc0 L_skip_29
    ds_read2_b64 v[200:203], v66 offset0:9 offset1:10
    v_mov_b32 v70, 0
    s_mov_b32 exec_lo, 0xffff0000
    s_mov_b32 exec_hi, 0x0000ffff
    v_fmac_f32 v70, v56, v56
    v_fmac_f32 v70, v57, v57
    s_cmp_eq_u32 s85, 0
    s_cselect_b32 exec_hi, -1, exec_hi
    v_fmac_f32 v70, v58, v58
    v_fmac_f32 v70, v59, v59
    s_mov_b64 exec, -1
    v_mov_b32 v69, v70
    s_nop 1
    v_permlane32_swap_b32 v69, v70
    v_add_f32 v70, v69, v70
    v_mov_b32 v69, v70
    s_nop 1
    v_permlane16_swap_b32 v69, v70
    v_add_f32 v70, v69, v70
    s_nop 1
    v_max_f32_dpp v70, v70, v70 row_ror:8 row_mask:0xf bank_mask:0xf
    s_nop 1
    v_max_f32_dpp v70, v70, v70 row_ror:4 row_mask:0xf bank_mask:0xf
    s_nop 1
    v_max_f32_dpp v70, v70, v70 row_ror:2 row_mask:0xf bank_mask:0xf
    s_nop 1
    v_max_f32_dpp v70, v70, v70 row_ror:1 row_mask:0xf bank_mask:0xf
    s_lshl2_add_u32 s89, s72, 157440
    v_mov_b32 v69, s89
    ds_write_b32 v69, v70
L_skip_29:
L_skip_30:
    s_add_u32 m0, s78, 36864
    s_add_u32 s90, s82, 110720
    buffer_load_dwordx4 v20, s[40:43], s90 offen  lds
    s_add_u32 m0, s78, 40960
    s_add_u32 s90, s82, 147584
    buffer_load_dwordx4 v20, s[40:43], s90 offen  lds
    s_add_u32 m0, s78, 45056
    s_add_u32 s90, s82, 184448
    buffer_load_dwordx4 v20, s[40:43], s90 offen  lds
    s_add_u32 m0, s78, 49152
    s_add_u32 s90, s82, 221312
    buffer_load_dwordx4 v20, s[40:43], s90 offen  lds
    buffer_store_dword v205, v19, s[44:47], 0 offen sc1
    s_waitcnt lgkmcnt(0)
    buffer_store_dwordx4 v[200:203], v11, s[44:47], 0 offen sc1
    s_waitcnt vmcnt(6)
    s_barrier
    ds_read_b64_tr_b16 v[32:33], v130 offset:16384
    v_mfma_f32_16x16x32_bf16 v[160:163], v[136:139], v[72:75], 0
    ds_read_b64_tr_b16 v[34:35], v130 offset:18432
    ds_read_b128 v[124:127], v21 offset:24576
    v_mfma_f32_16x16x32_bf16 v[160:163], v[140:143], v[112:115], v[160:163]
    ds_read_b64_tr_b16 v[36:37], v130 offset:20480
    ds_read_b128 v[196:199], v21 offset:16384
    v_mfma_f32_16x16x32_bf16 v[164:167], v[136:139], v[76:79], 0
    ds_read_b64_tr_b16 v[38:39], v130 offset:22528
    v_mfma_f32_16x16x32_bf16 v[164:167], v[140:143], v[184:187], v[164:167]
    ds_read_b64_tr_b16 v[136:137], v130 offset:40960
    v_mfma_f32_16x16x32_bf16 v[168:171], v[24:27], v[72:75], 0
    ds_read_b64_tr_b16 v[138:139], v130 offset:43008
    v_mfma_f32_16x16x32_bf16 v[168:171], v[28:31], v[112:115], v[168:171]
    ds_read_b64_tr_b16 v[140:141], v130 offset:45056
    v_mfma_f32_16x16x32_bf16 v[172:175], v[24:27], v[76:79], 0
    ds_read_b64_tr_b16 v[142:143], v130 offset:47104
    v_mfma_f32_16x16x32_bf16 v[172:175], v[28:31], v[184:187], v[172:175]
    ds_read_b64_tr_b16 v[24:25], v131 offset:16384
    s_waitcnt lgkmcnt(5)
    v_mfma_f32_16x16x32_bf16 v[160:163], v[32:35], v[80:83], v[160:163]
    ds_read_b64_tr_b16 v[26:27], v131 offset:18432
    v_mfma_f32_16x16x32_bf16 v[160:163], v[36:39], v[116:119], v[160:163]
    ds_read_b64_tr_b16 v[28:29], v131 offset:20480
    v_mfma_f32_16x16x32_bf16 v[164:167], v[32:35], v[84:87], v[164:167]
    ds_read_b64_tr_b16 v[30:31], v131 offset:22528
    v_mfma_f32_16x16x32_bf16 v[164:167], v[36:39], v[188:191], v[164:167]
    ds_read_b64_tr_b16 v[32:33], v131 offset:40960
    s_waitcnt lgkmcnt(5)
    v_mfma_f32_16x16x32_bf16 v[164:167], v[136:139], v[92:95], v[164:167]
    ds_read_b64_tr_b16 v[34:35], v131 offset:43008
    v_mfma_f32_16x16x32_bf16 v[164:167], v[140:143], v[192:195], v[164:167]
    ds_read_b64_tr_b16 v[36:37], v131 offset:45056
    v_mfma_f32_16x16x32_bf16 v[160:163], v[136:139], v[88:91], v[160:163]
    ds_read_b64_tr_b16 v[38:39], v131 offset:47104
    v_mfma_f32_16x16x32_bf16 v[160:163], v[140:143], v[120:123], v[160:163]
    ds_read_b64_tr_b16 v[136:137], v130 offset:49152
    s_waitcnt lgkmcnt(5)
    v_mfma_f32_16x16x32_bf16 v[168:171], v[24:27], v[80:83], v[168:171]
    ds_read_b64_tr_b16 v[138:139], v130 offset:51200
    v_mfma_f32_16x16x32_bf16 v[168:171], v[28:31], v[116:119], v[168:171]
    ds_read_b64_tr_b16 v[140:141], v128 offset:4096
    v_mfma_f32_16x16x32_bf16 v[172:175], v[24:27], v[84:87], v[172:175]
    ds_read_b64_tr_b16 v[142:143], v128 offset:6144
    v_mfma_f32_16x16x32_bf16 v[172:175], v[28:31], v[188:191], v[172:175]
    ds_read_b64_tr_b16 v[24:25], v131 offset:49152
    s_waitcnt lgkmcnt(5)
    v_mfma_f32_16x16x32_bf16 v[172:175], v[32:35], v[92:95], v[172:175]
    ds_read_b64_tr_b16 v[26:27], v131 offset:51200
    v_mfma_f32_16x16x32_bf16 v[172:175], v[36:39], v[192:195], v[172:175]
    ds_read_b64_tr_b16 v[28:29], v129 offset:4096
    v_mfma_f32_16x16x32_bf16 v[168:171], v[32:35], v[88:91], v[168:171]
    ds_read_b64_tr_b16 v[30:31], v129 offset:6144
    v_mfma_f32_16x16x32_bf16 v[168:171], v[36:39], v[120:123], v[168:171]
    ds_read_b64_tr_b16 v[32:33], v128 offset:8192
    s_waitcnt lgkmcnt(5)
    v_mfma_f32_16x16x32_bf16 v[144:147], v[136:139], v[96:99], v[144:147]
    ds_read_b64_tr_b16 v[34:35], v128 offset:10240
    v_mfma_f32_16x16x32_bf16 v[144:147], v[140:143], v[124:127], v[144:147]
    ds_read_b64_tr_b16 v[36:37], v128 offset:12288
    v_mfma_f32_16x16x32_bf16 v[148:151], v[136:139], v[100:103], v[148:151]
    ds_read_b64_tr_b16 v[38:39], v128 offset:14336
    v_mfma_f32_16x16x32_bf16 v[148:151], v[140:143], v[196:199], v[148:151]
    ds_read_b64_tr_b16 v[136:137], v129 offset:8192
    s_waitcnt lgkmcnt(5)
    v_mfma_f32_16x16x32_bf16 v[152:155], v[24:27], v[96:99], v[152:155]
    ds_read_b64_tr_b16 v[138:139], v129 offset:10240
    v_mfma_f32_16x16x32_bf16 v[152:155], v[28:31], v[124:127], v[152:155]
    ds_read_b64_tr_b16 v[140:141], v129 offset:12288
    v_mfma_f32_16x16x32_bf16 v[156:159], v[24:27], v[100:103], v[156:159]
    ds_read_b64_tr_b16 v[142:143], v129 offset:14336
    v_mfma_f32_16x16x32_bf16 v[156:159], v[28:31], v[196:199], v[156:159]
    v_mul_f32 v12, v44, v44
    v_mul_f32 v13, v45, v45
    v_mul_f32 v14, v46, v46
    v_mul_f32 v15, v47, v47
    v_fmamk_f32 v12, v12, 0xbdd2d3e8, v1
    v_fmamk_f32 v13, v13, 0xbdd2d3e8, v1
    v_fmamk_f32 v14, v14, 0xbdd2d3e8, v1
    v_fmamk_f32 v15, v15, 0xbdd2d3e8, v1
    v_mul_f32 v12, v12, v44
    v_mul_f32 v13, v13, v45
    v_mul_f32 v14, v14, v46
    v_mul_f32 v15, v15, v47
    v_exp_f32 v12, v12
    v_exp_f32 v13, v13
    v_exp_f32 v14, v14
    v_exp_f32 v15, v15
    v_add_f32 v12, 1.0, v12
    v_add_f32 v13, 1.0, v13
    v_add_f32 v14, 1.0, v14
    v_add_f32 v15, 1.0, v15
    v_rcp_f32 v12, v12
    v_rcp_f32 v13, v13
    v_rcp_f32 v14, v14
    v_rcp_f32 v15, v15
    v_mul_f32 v12, v12, v44
    v_mul_f32 v13, v13, v45
    v_mul_f32 v14, v14, v46
    v_mul_f32 v15, v15, v47
    v_cvt_pk_bf16_f32 v108, v12, v13
    v_cvt_pk_bf16_f32 v109, v14, v15
    ds_write_b64 v21, v[104:105] offset:28672
    ds_write_b64 v21, v[108:109] offset:28680
    s_add_u32 m0, s78, 73728
    s_add_u32 s90, s82, 110848
    buffer_load_dwordx4 v20, s[40:43], s90 offen  lds
    s_add_u32 m0, s78, 77824
    s_add_u32 s90, s82, 147712
    buffer_load_dwordx4 v20, s[40:43], s90 offen  lds
    s_add_u32 m0, s78, 90112
    s_add_u32 s90, s82, 184576
    buffer_load_dwordx4 v20, s[40:43], s90 offen  lds
    s_add_u32 m0, s78, 94208
    s_add_u32 s90, s82, 221440
    buffer_load_dwordx4 v20, s[40:43], s90 offen  lds
    s_add_u32 m0, s78, 98304
    s_add_u32 s90, s82, 258304
    buffer_load_dwordx4 v20, s[40:43], s90 offen  lds
    v_mov_b32 v19, 157440
    s_waitcnt vmcnt(5) lgkmcnt(0)
    s_barrier
    ds_read_b64_tr_b16 v[24:25], v128 offset:16384
    v_mfma_f32_16x16x32_bf16 v[160:163], v[32:35], v[96:99], v[160:163]
    ds_read_b64_tr_b16 v[26:27], v128 offset:18432
    ds_read_b64 v[106:107], v21 offset:32776
    v_mfma_f32_16x16x32_bf16 v[160:163], v[36:39], v[124:127], v[160:163]
    ds_read_b64_tr_b16 v[28:29], v129 offset:16384
    ds_read_b64 v[110:111], v21 offset:32768
    v_mfma_f32_16x16x32_bf16 v[164:167], v[32:35], v[100:103], v[164:167]
    ds_read_b64_tr_b16 v[30:31], v129 offset:18432
    ds_read_b128 v[176:179], v19 offset:0
    v_mfma_f32_16x16x32_bf16 v[164:167], v[36:39], v[196:199], v[164:167]
    ds_read_b64_tr_b16 v[32:33], v128 offset:20480
    ds_read_b128 v[180:183], v19 offset:16
    v_mfma_f32_16x16x32_bf16 v[168:171], v[136:139], v[96:99], v[168:171]
    ds_read_b64_tr_b16 v[34:35], v128 offset:22528
    v_mfma_f32_16x16x32_bf16 v[168:171], v[140:143], v[124:127], v[168:171]
    ds_read_b64_tr_b16 v[36:37], v129 offset:20480
    v_mfma_f32_16x16x32_bf16 v[172:175], v[136:139], v[100:103], v[172:175]
    ds_read_b64_tr_b16 v[38:39], v129 offset:22528
    v_mfma_f32_16x16x32_bf16 v[172:175], v[140:143], v[196:199], v[172:175]
    ds_read_b64_tr_b16 v[136:137], v128 offset:24576
    s_waitcnt lgkmcnt(10)
    v_mfma_f32_16x16x32_bf16 v[144:147], v[24:27], v[104:107], v[144:147]
    ds_read_b64_tr_b16 v[138:139], v128 offset:26624
    s_waitcnt lgkmcnt(9)
    v_mfma_f32_16x16x32_bf16 v[148:151], v[24:27], v[108:111], v[148:151]
    ds_read_b64_tr_b16 v[140:141], v128 offset:28672
    s_waitcnt lgkmcnt(9)
    v_mfma_f32_16x16x32_bf16 v[152:155], v[28:31], v[104:107], v[152:155]
    ds_read_b64_tr_b16 v[142:143], v128 offset:30720
    v_mfma_f32_16x16x32_bf16 v[156:159], v[28:31], v[108:111], v[156:159]
    ds_read_b64_tr_b16 v[24:25], v128 offset:32768
    s_waitcnt lgkmcnt(7)
    v_mfma_f32_16x16x32_bf16 v[160:163], v[32:35], v[104:107], v[160:163]
    ds_read_b64_tr_b16 v[26:27], v128 offset:34816
    v_mfma_f32_16x16x32_bf16 v[164:167], v[32:35], v[108:111], v[164:167]
    ds_read_b64_tr_b16 v[28:29], v128 offset:36864
    s_waitcnt lgkmcnt(7)
    v_mfma_f32_16x16x32_bf16 v[168:171], v[36:39], v[104:107], v[168:171]
    ds_read_b64_tr_b16 v[30:31], v128 offset:38912
    v_mfma_f32_16x16x32_bf16 v[172:175], v[36:39], v[108:111], v[172:175]
    ds_read_b64_tr_b16 v[32:33], v128 offset:40960
    s_waitcnt lgkmcnt(5)
    v_mfma_f32_16x16x32_bf16 v[240:243], v[136:139], v[72:75], 0
    ds_read_b64_tr_b16 v[34:35], v128 offset:43008
    v_mfma_f32_16x16x32_bf16 v[240:243], v[140:143], v[112:115], v[240:243]
    ds_read_b64_tr_b16 v[36:37], v128 offset:45056
    v_mfma_f32_16x16x32_bf16 v[244:247], v[136:139], v[76:79], 0
    ds_read_b64_tr_b16 v[38:39], v128 offset:47104
    v_mfma_f32_16x16x32_bf16 v[244:247], v[140:143], v[184:187], v[244:247]
    ds_read_b64_tr_b16 v[136:137], v128 offset:49152
    s_waitcnt lgkmcnt(5)
    v_mfma_f32_16x16x32_bf16 v[244:247], v[24:27], v[84:87], v[244:247]
    ds_read_b64_tr_b16 v[138:139], v128 offset:51200
    v_mfma_f32_16x16x32_bf16 v[244:247], v[28:31], v[188:191], v[244:247]
    ds_read_b64_tr_b16 v[140:141], v128 offset:53248
    v_mfma_f32_16x16x32_bf16 v[240:243], v[24:27], v[80:83], v[240:243]
    ds_read_b64_tr_b16 v[142:143], v128 offset:55296
    v_mfma_f32_16x16x32_bf16 v[240:243], v[28:31], v[116:119], v[240:243]
    ds_read_b64_tr_b16 v[24:25], v129 offset:24576
    s_waitcnt lgkmcnt(5)
    v_mfma_f32_16x16x32_bf16 v[240:243], v[32:35], v[88:91], v[240:243]
    ds_read_b64_tr_b16 v[26:27], v129 offset:26624
    v_mfma_f32_16x16x32_bf16 v[240:243], v[36:39], v[120:123], v[240:243]
    ds_read_b64_tr_b16 v[28:29], v129 offset:28672
    v_mfma_f32_16x16x32_bf16 v[244:247], v[32:35], v[92:95], v[244:247]
    ds_read_b64_tr_b16 v[30:31], v129 offset:30720
    v_mfma_f32_16x16x32_bf16 v[244:247], v[36:39], v[192:195], v[244:247]
    ds_read_b64_tr_b16 v[32:33], v129 offset:32768
    s_waitcnt lgkmcnt(5)
    v_mfma_f32_16x16x32_bf16 v[244:247], v[136:139], v[100:103], v[244:247]
    ds_read_b64_tr_b16 v[34:35], v129 offset:34816
    v_mfma_f32_16x16x32_bf16 v[244:247], v[140:143], v[196:199], v[244:247]
    ds_read_b64_tr_b16 v[36:37], v129 offset:36864
    v_mfma_f32_16x16x32_bf16 v[240:243], v[136:139], v[96:99], v[240:243]
    ds_read_b64_tr_b16 v[38:39], v129 offset:38912
    v_mfma_f32_16x16x32_bf16 v[240:243], v[140:143], v[124:127], v[240:243]
    ds_read_b64_tr_b16 v[136:137], v129 offset:40960
    s_waitcnt lgkmcnt(5)
    v_mfma_f32_16x16x32_bf16 v[248:251], v[24:27], v[72:75], 0
    ds_read_b64_tr_b16 v[138:139], v129 offset:43008
    v_mfma_f32_16x16x32_bf16 v[248:251], v[28:31], v[112:115], v[248:251]
    ds_read_b64_tr_b16 v[140:141], v129 offset:45056
    v_mfma_f32_16x16x32_bf16 v[252:255], v[24:27], v[76:79], 0
    ds_read_b64_tr_b16 v[142:143], v129 offset:47104
    v_mfma_f32_16x16x32_bf16 v[252:255], v[28:31], v[184:187], v[252:255]
    ds_read_b64_tr_b16 v[24:25], v129 offset:49152
    s_waitcnt lgkmcnt(5)
    v_mfma_f32_16x16x32_bf16 v[252:255], v[32:35], v[84:87], v[252:255]
    ds_read_b64_tr_b16 v[26:27], v129 offset:51200
    v_mfma_f32_16x16x32_bf16 v[252:255], v[36:39], v[188:191], v[252:255]
    ds_read_b64_tr_b16 v[28:29], v129 offset:53248
    v_mfma_f32_16x16x32_bf16 v[248:251], v[32:35], v[80:83], v[248:251]
    ds_read_b64_tr_b16 v[30:31], v129 offset:55296
    v_mfma_f32_16x16x32_bf16 v[248:251], v[36:39], v[116:119], v[248:251]
    ds_read_b64_tr_b16 v[32:33], v128 offset:57344
    s_waitcnt lgkmcnt(5)
    v_mfma_f32_16x16x32_bf16 v[248:251], v[136:139], v[88:91], v[248:251]
    ds_read_b64_tr_b16 v[34:35], v128 offset:59392
    v_mfma_f32_16x16x32_bf16 v[248:251], v[140:143], v[120:123], v[248:251]
    ds_read_b64_tr_b16 v[36:37], v129 offset:57344
    v_mfma_f32_16x16x32_bf16 v[252:255], v[136:139], v[92:95], v[252:255]
    ds_read_b64_tr_b16 v[38:39], v129 offset:59392
    v_mfma_f32_16x16x32_bf16 v[252:255], v[140:143], v[192:195], v[252:255]
    s_lshr_b32 s88, s85, 2
    s_or_b32 s88, s88, s72
    v_max3_u32 v176, v176, v177, v178
    v_max3_u32 v179, v179, v180, v181
    s_lshl2_add_u32 s89, s75, s85
    s_lshl_b32 s89, s89, 2
    v_max3_u32 v176, v176, v182, v183
    v_mov_b32 v11, s93
    s_cmp_eq_u32 s88, 0
    s_cselect_b32 s89, s89, 256
    v_max_u32 v176, v176, v179
    s_cmp_lt_u32 s85, 2
    s_cselect_b64 vcc, -1, 0
    s_mov_b32 s88, 0x28000
    v_cndmask_b32 v176, v11, v176, vcc
    v_or_b32 v176, 1, v176
    s_cmp_eq_u32 s89, 8
    s_cselect_b32 s88, s88, 0x4000000
    s_mov_b64 exec, 1
L_h0page1:
    s_cbranch_execz L_probed0
    buffer_store_dword v176, v0, s[48:51], s89 offen sc1
    buffer_store_dword v11, v0, s[44:47], s88 offen sc1
    s_mov_b64 exec, -1
    s_and_b32 s85, s85, 3
    v_mul_f32 v48, v48, v67
    v_mul_f32 v49, v49, v67
    v_mul_f32 v50, v50, v67
    v_mul_f32 v51, v51, v67
    v_mul_f32 v52, v52, v67
    v_mul_f32 v53, v53, v67
    v_mul_f32 v54, v54, v67
    v_mul_f32 v55, v55, v67
    v_cvt_pk_bf16_f32 v200, v48, v49
    v_cvt_pk_bf16_f32 v201, v50, v51
    v_cvt_pk_bf16_f32 v202, v52, v53
    v_cvt_pk_bf16_f32 v203, v54, v55
    ds_write_b64 v68, v[200:201] offset:0
    ds_write_b64 v68, v[202:203] offset:1664
    s_add_u32 m0, s78, 122880
    s_add_u32 s90, s82, 147840
    buffer_load_dwordx4 v20, s[40:43], s90 offen  lds
    v_cvt_pk_bf16_f32 v208, v144, v145
    s_add_u32 m0, s78, 126976
    s_add_u32 s90, s82, 184704
    buffer_load_dwordx4 v20, s[40:43], s90 offen  lds
    v_cvt_pk_bf16_f32 v209, v146, v147
    v_cvt_pk_bf16_f32 v210, v148, v149
    s_add_u32 m0, s78, 131072
    s_add_u32 s90, s82, 221568
    buffer_load_dwordx4 v20, s[40:43], s90 offen  lds
    v_cvt_pk_bf16_f32 v211, v150, v151
    v_cvt_pk_bf16_f32 v212, v152, v153
    s_add_u32 m0, s78, 0
    s_add_u32 s90, s82, 258432
    buffer_load_dwordx4 v20, s[40:43], s90 offen  lds
    v_cvt_pk_bf16_f32 v213, v154, v155
    s_add_u32 m0, s78, 4096
    s_add_u32 s90, s83, 384
    buffer_load_dwordx4 v20, s[40:43], s90 offen  lds
    v_cvt_pk_bf16_f32 v214, v156, v157
    v_cvt_pk_bf16_f32 v215, v158, v159
    v_cvt_pk_bf16_f32 v216, v160, v161
    v_cvt_pk_bf16_f32 v217, v162, v163
    v_cvt_pk_bf16_f32 v218, v164, v165
    v_cvt_pk_bf16_f32 v219, v166, v167
    v_cvt_pk_bf16_f32 v220, v168, v169
    v_cvt_pk_bf16_f32 v221, v170, v171
    v_cvt_pk_bf16_f32 v222, v172, v173
    v_cvt_pk_bf16_f32 v223, v174, v175
    s_add_u32 s91, s86, 524288
    buffer_store_dwordx4 v[208:211], v0, s[44:47], s91 offen sc1
    s_waitcnt vmcnt(8) lgkmcnt(0)
    s_barrier
    ds_read_b64_tr_b16 v[136:137], v128 offset:61440
    v_mfma_f32_16x16x32_bf16 v[252:255], v[24:27], v[100:103], v[252:255]
    ds_read_b64_tr_b16 v[138:139], v128 offset:63488
    v_mfma_f32_16x16x32_bf16 v[252:255], v[28:31], v[196:199], v[252:255]
    ds_read_b64_tr_b16 v[140:141], v130
    v_mfma_f32_16x16x32_bf16 v[248:251], v[24:27], v[96:99], v[248:251]
    ds_read_b64_tr_b16 v[142:143], v130 offset:2048
    v_mfma_f32_16x16x32_bf16 v[248:251], v[28:31], v[124:127], v[248:251]
    ds_read_b64_tr_b16 v[24:25], v130 offset:4096
    v_mfma_f32_16x16x32_bf16 v[240:243], v[32:35], v[104:107], v[240:243]
    ds_read_b64_tr_b16 v[26:27], v130 offset:6144
    v_mfma_f32_16x16x32_bf16 v[244:247], v[32:35], v[108:111], v[244:247]
    ds_read_b64_tr_b16 v[28:29], v130 offset:8192
    v_mfma_f32_16x16x32_bf16 v[248:251], v[36:39], v[104:107], v[248:251]
    ds_read_b64_tr_b16 v[30:31], v130 offset:10240
    v_mfma_f32_16x16x32_bf16 v[252:255], v[36:39], v[108:111], v[252:255]
    ds_read_b64_tr_b16 v[32:33], v130 offset:12288
    s_waitcnt lgkmcnt(5)
    v_mfma_f32_16x16x32_bf16 v[144:147], v[136:139], v[72:75], 0
    ds_read_b64_tr_b16 v[34:35], v130 offset:14336
    v_mfma_f32_16x16x32_bf16 v[144:147], v[140:143], v[112:115], v[144:147]
    ds_read_b64_tr_b16 v[36:37], v130 offset:24576
    v_mfma_f32_16x16x32_bf16 v[148:151], v[136:139], v[76:79], 0
    ds_read_b64_tr_b16 v[38:39], v130 offset:26624
    v_mfma_f32_16x16x32_bf16 v[148:151], v[140:143], v[184:187], v[148:151]
    ds_read_b64_tr_b16 v[136:137], v130 offset:28672
    s_waitcnt lgkmcnt(5)
    v_mfma_f32_16x16x32_bf16 v[148:151], v[24:27], v[84:87], v[148:151]
    ds_read_b64_tr_b16 v[138:139], v130 offset:30720
    v_mfma_f32_16x16x32_bf16 v[148:151], v[28:31], v[188:191], v[148:151]
    ds_read_b64_tr_b16 v[140:141], v130 offset:32768
    v_mfma_f32_16x16x32_bf16 v[144:147], v[24:27], v[80:83], v[144:147]
    ds_read_b64_tr_b16 v[142:143], v130 offset:34816
    v_mfma_f32_16x16x32_bf16 v[144:147], v[28:31], v[116:119], v[144:147]
    ds_read_b64_tr_b16 v[24:25], v129 offset:61440
    s_waitcnt lgkmcnt(5)
    v_mfma_f32_16x16x32_bf16 v[144:147], v[32:35], v[88:91], v[144:147]
    ds_read_b64_tr_b16 v[26:27], v129 offset:63488
    v_mfma_f32_16x16x32_bf16 v[144:147], v[36:39], v[120:123], v[144:147]
    ds_read_b64_tr_b16 v[28:29], v131
    v_mfma_f32_16x16x32_bf16 v[148:151], v[32:35], v[92:95], v[148:151]
    ds_read_b64_tr_b16 v[30:31], v131 offset:2048
    v_mfma_f32_16x16x32_bf16 v[148:151], v[36:39], v[192:195], v[148:151]
    ds_read_b64_tr_b16 v[32:33], v131 offset:4096
    s_waitcnt lgkmcnt(5)
    v_mfma_f32_16x16x32_bf16 v[148:151], v[136:139], v[100:103], v[148:151]
    ds_read_b64_tr_b16 v[34:35], v131 offset:6144
    v_mfma_f32_16x16x32_bf16 v[148:151], v[140:143], v[196:199], v[148:151]
    ds_read_b64_tr_b16 v[36:37], v131 offset:8192
    v_mfma_f32_16x16x32_bf16 v[144:147], v[136:139], v[96:99], v[144:147]
    ds_read_b64_tr_b16 v[38:39], v131 offset:10240
    v_mfma_f32_16x16x32_bf16 v[144:147], v[140:143], v[124:127], v[144:147]
    ds_read_b64_tr_b16 v[136:137], v131 offset:12288
    s_waitcnt lgkmcnt(5)
    v_mfma_f32_16x16x32_bf16 v[152:155], v[24:27], v[72:75], 0
    ds_read_b64_tr_b16 v[138:139], v131 offset:14336
    v_mfma_f32_16x16x32_bf16 v[152:155], v[28:31], v[112:115], v[152:155]
    ds_read_b64_tr_b16 v[140:141], v131 offset:24576
    v_mfma_f32_16x16x32_bf16 v[156:159], v[24:27], v[76:79], 0
    ds_read_b64_tr_b16 v[142:143], v131 offset:26624
    v_mfma_f32_16x16x32_bf16 v[156:159], v[28:31], v[184:187], v[156:159]
    ds_read_b64_tr_b16 v[24:25], v131 offset:28672
    s_waitcnt lgkmcnt(5)
    v_mfma_f32_16x16x32_bf16 v[156:159], v[32:35], v[84:87], v[156:159]
    ds_read_b64_tr_b16 v[26:27], v131 offset:30720
    v_mfma_f32_16x16x32_bf16 v[156:159], v[36:39], v[188:191], v[156:159]
    ds_read_b64_tr_b16 v[28:29], v131 offset:32768
    v_mfma_f32_16x16x32_bf16 v[152:155], v[32:35], v[80:83], v[152:155]
    ds_read_b64_tr_b16 v[30:31], v131 offset:34816
    v_mfma_f32_16x16x32_bf16 v[152:155], v[36:39], v[116:119], v[152:155]
    ds_read_b64_tr_b16 v[32:33], v130 offset:36864
    s_waitcnt lgkmcnt(5)
    v_mfma_f32_16x16x32_bf16 v[152:155], v[136:139], v[88:91], v[152:155]
    ds_read_b64_tr_b16 v[34:35], v130 offset:38912
    v_mfma_f32_16x16x32_bf16 v[152:155], v[140:143], v[120:123], v[152:155]
    ds_read_b64_tr_b16 v[36:37], v131 offset:36864
    v_mfma_f32_16x16x32_bf16 v[156:159], v[136:139], v[92:95], v[156:159]
    ds_read_b64_tr_b16 v[38:39], v131 offset:38912
    v_mfma_f32_16x16x32_bf16 v[156:159], v[140:143], v[192:195], v[156:159]
    s_add_u32 m0, s78, 28672
    s_add_u32 s90, s82, 184832
    buffer_load_dwordx4 v20, s[40:43], s90 offen  lds
    v_and_b32 v69, 1, v65
    v_mad_u32_u24 v69, v69, 36, v66
    v_add_u32 v69, 0, v69
    v_lshrrev_b32 v70, 1, v65
    s_add_u32 m0, s78, 32768
    s_add_u32 s90, s82, 221696
    buffer_load_dwordx4 v20, s[40:43], s90 offen  lds
    v_lshl_add_u32 v70, v70, 4, v69
    ds_read2_b32 v[40:41], v70 offset0:0 offset1:1
    ds_read2_b32 v[42:43], v70 offset0:2 offset1:3
    ds_read_b32 v44, v69 offset:32
    s_add_u32 m0, s78, 36864
    s_add_u32 s90, s82, 258560
    buffer_load_dwordx4 v20, s[40:43], s90 offen  lds
    v_mov_b32 v53, 0x3f80
    v_mov_b32 v54, 0xdddddddd
    v_and_b32 v200, 27, v22
    v_cmp_eq_u32 vcc, 18, v200
    s_add_u32 m0, s78, 40960
    s_add_u32 s90, s83, 512
    buffer_load_dwordx4 v20, s[40:43], s90 offen  lds
    v_mov_b32 v200, 0x3f803f80
    v_cndmask_b32 v56, 0, v200, vcc
    v_cndmask_b32 v57, 0, v200, vcc
    v_cndmask_b32 v58, 0, v200, vcc
    s_add_u32 m0, s78, 45056
    s_add_u32 s90, s82, 640
    buffer_load_dwordx4 v20, s[40:43], s90 offen  lds
    v_cndmask_b32 v59, 0, v200, vcc
    v_cndmask_b32 v60, 0, v200, vcc
    v_cndmask_b32 v61, 0, v200, vcc
    v_cndmask_b32 v62, 0, v200, vcc
    v_cndmask_b32 v63, 0, v200, vcc
    v_mov_b32 v2, v0
    v_lshlrev_b32 v4, 2, v22
    v_lshlrev_b32 v1, 2, v22
    v_and_b32 v200, 31, v22
    v_lshrrev_b32 v3, 5, v22
    v_mul_u32_u24 v3, 288, v3
    v_lshl_add_u32 v3, v200, 4, v3
    s_mov_b32 s92, 0x3ffff
    s_mov_b32 s93, 0x3ffff
    v_cvt_pk_bf16_f32 v224, v240, v241
    v_cvt_pk_bf16_f32 v225, v242, v243
    v_cvt_pk_bf16_f32 v226, v244, v245
    v_cvt_pk_bf16_f32 v227, v246, v247
    v_cvt_pk_bf16_f32 v228, v248, v249
    v_cvt_pk_bf16_f32 v229, v250, v251
    v_cvt_pk_bf16_f32 v230, v252, v253
    v_cvt_pk_bf16_f32 v231, v254, v255
    s_add_u32 s91, s86, 540672
    buffer_store_dwordx4 v[212:215], v0, s[44:47], s91 offen sc1
    s_waitcnt vmcnt(7) lgkmcnt(3)
    s_barrier
    ds_read_b64_tr_b16 v[136:137], v130 offset:40960
    v_mfma_f32_16x16x32_bf16 v[156:159], v[24:27], v[100:103], v[156:159]
    ds_read_b64_tr_b16 v[138:139], v130 offset:43008
    v_mfma_f32_16x16x32_bf16 v[156:159], v[28:31], v[196:199], v[156:159]
    ds_read_b64_tr_b16 v[140:141], v130 offset:45056
    v_mfma_f32_16x16x32_bf16 v[152:155], v[24:27], v[96:99], v[152:155]
    ds_read_b64_tr_b16 v[142:143], v130 offset:47104
    v_mfma_f32_16x16x32_bf16 v[152:155], v[28:31], v[124:127], v[152:155]
    ds_read_b64_tr_b16 v[24:25], v130 offset:49152
    v_mfma_f32_16x16x32_bf16 v[144:147], v[32:35], v[104:107], v[144:147]
    ds_read_b64_tr_b16 v[26:27], v130 offset:51200
    v_mfma_f32_16x16x32_bf16 v[148:151], v[32:35], v[108:111], v[148:151]
    ds_read_b64_tr_b16 v[28:29], v130 offset:53248
    v_mfma_f32_16x16x32_bf16 v[152:155], v[36:39], v[104:107], v[152:155]
    ds_read_b64_tr_b16 v[30:31], v130 offset:55296
    v_mfma_f32_16x16x32_bf16 v[156:159], v[36:39], v[108:111], v[156:159]
    ds_read_b64_tr_b16 v[32:33], v130 offset:57344
    s_waitcnt lgkmcnt(5)
    v_mfma_f32_16x16x32_bf16 v[160:163], v[136:139], v[72:75], 0
    ds_read_b64_tr_b16 v[34:35], v130 offset:59392
    v_mfma_f32_16x16x32_bf16 v[160:163], v[140:143], v[112:115], v[160:163]
    ds_read_b64_tr_b16 v[36:37], v130 offset:61440
    v_mfma_f32_16x16x32_bf16 v[164:167], v[136:139], v[76:79], 0
    ds_read_b64_tr_b16 v[38:39], v130 offset:63488
    v_mfma_f32_16x16x32_bf16 v[164:167], v[140:143], v[184:187], v[164:167]
    ds_read_b64_tr_b16 v[136:137], v132
    s_waitcnt lgkmcnt(5)
    v_mfma_f32_16x16x32_bf16 v[164:167], v[24:27], v[84:87], v[164:167]
    ds_read_b64_tr_b16 v[138:139], v132 offset:2048
    v_mfma_f32_16x16x32_bf16 v[164:167], v[28:31], v[188:191], v[164:167]
    ds_read_b64_tr_b16 v[140:141], v128
    v_mfma_f32_16x16x32_bf16 v[160:163], v[24:27], v[80:83], v[160:163]
    ds_read_b64_tr_b16 v[142:143], v128 offset:2048
    v_mfma_f32_16x16x32_bf16 v[160:163], v[28:31], v[116:119], v[160:163]
    ds_read_b64_tr_b16 v[24:25], v131 offset:40960
    s_waitcnt lgkmcnt(5)
    v_mfma_f32_16x16x32_bf16 v[160:163], v[32:35], v[88:91], v[160:163]
    ds_read_b64_tr_b16 v[26:27], v131 offset:43008
    v_mfma_f32_16x16x32_bf16 v[160:163], v[36:39], v[120:123], v[160:163]
    ds_read_b64_tr_b16 v[28:29], v131 offset:45056
    v_mfma_f32_16x16x32_bf16 v[164:167], v[32:35], v[92:95], v[164:167]
    ds_read_b64_tr_b16 v[30:31], v131 offset:47104
    v_mfma_f32_16x16x32_bf16 v[164:167], v[36:39], v[192:195], v[164:167]
    ds_read_b64_tr_b16 v[32:33], v131 offset:49152
    s_waitcnt lgkmcnt(5)
    v_mfma_f32_16x16x32_bf16 v[164:167], v[136:139], v[100:103], v[164:167]
    ds_read_b64_tr_b16 v[34:35], v131 offset:51200
    v_mfma_f32_16x16x32_bf16 v[164:167], v[140:143], v[196:199], v[164:167]
    ds_read_b64_tr_b16 v[36:37], v131 offset:53248
    v_mfma_f32_16x16x32_bf16 v[160:163], v[136:139], v[96:99], v[160:163]
    ds_read_b64_tr_b16 v[38:39], v131 offset:55296
    v_mfma_f32_16x16x32_bf16 v[160:163], v[140:143], v[124:127], v[160:163]
    ds_read_b64_tr_b16 v[136:137], v131 offset:57344
    s_waitcnt lgkmcnt(5)
    v_mfma_f32_16x16x32_bf16 v[168:171], v[24:27], v[72:75], 0
    ds_read_b64_tr_b16 v[138:139], v131 offset:59392
    v_mfma_f32_16x16x32_bf16 v[168:171], v[28:31], v[112:115], v[168:171]
    ds_read_b64_tr_b16 v[140:141], v131 offset:61440
    v_mfma_f32_16x16x32_bf16 v[172:175], v[24:27], v[76:79], 0
    ds_read_b64_tr_b16 v[142:143], v131 offset:63488
    v_mfma_f32_16x16x32_bf16 v[172:175], v[28:31], v[184:187], v[172:175]
    ds_read_b64_tr_b16 v[24:25], v133
    s_waitcnt lgkmcnt(5)
    v_mfma_f32_16x16x32_bf16 v[172:175], v[32:35], v[84:87], v[172:175]
    ds_read_b64_tr_b16 v[26:27], v133 offset:2048
    v_mfma_f32_16x16x32_bf16 v[172:175], v[36:39], v[188:191], v[172:175]
    ds_read_b64_tr_b16 v[28:29], v129
    v_mfma_f32_16x16x32_bf16 v[168:171], v[32:35], v[80:83], v[168:171]
    ds_read_b64_tr_b16 v[30:31], v129 offset:2048
    v_mfma_f32_16x16x32_bf16 v[168:171], v[36:39], v[116:119], v[168:171]
    ds_read_b64_tr_b16 v[32:33], v128 offset:4096
    s_waitcnt lgkmcnt(5)
    v_mfma_f32_16x16x32_bf16 v[168:171], v[136:139], v[88:91], v[168:171]
    ds_read_b64_tr_b16 v[34:35], v128 offset:6144
    v_mfma_f32_16x16x32_bf16 v[168:171], v[140:143], v[120:123], v[168:171]
    ds_read_b64_tr_b16 v[36:37], v129 offset:4096
    v_mfma_f32_16x16x32_bf16 v[172:175], v[136:139], v[92:95], v[172:175]
    ds_read_b64_tr_b16 v[38:39], v129 offset:6144
    v_mfma_f32_16x16x32_bf16 v[172:175], v[140:143], v[192:195], v[172:175]
    s_add_u32 m0, s78, 69632
    s_add_u32 s90, s82, 221824
    buffer_load_dwordx4 v20, s[40:43], s90 offen  lds
    v_lshlrev_b32 v200, 16, v40
    v_lshlrev_b32 v201, 16, v41
    v_lshlrev_b32 v202, 16, v42
    s_add_u32 m0, s78, 73728
    s_add_u32 s90, s82, 258688
    buffer_load_dwordx4 v20, s[40:43], s90 offen  lds
    v_lshlrev_b32 v203, 16, v43
    v_lshlrev_b32 v204, 16, v44
    v_mul_f32 v23, v40, v40
    s_add_u32 m0, s78, 77824
    s_add_u32 s90, s83, 640
    buffer_load_dwordx4 v20, s[40:43], s90 offen  lds
    v_fmac_f32 v23, v41, v41
    v_fmac_f32 v23, v42, v42
    v_fmac_f32 v23, v43, v43
    s_add_u32 m0, s78, 81920
    s_add_u32 s90, s82, 768
    buffer_load_dwordx4 v20, s[40:43], s90 offen  lds
    v_fmac_f32 v23, v200, v200
    v_fmac_f32 v23, v201, v201
    v_fmac_f32 v23, v202, v202
    s_add_u32 m0, s78, 86016
    s_add_u32 s90, s82, 37632
    buffer_load_dwordx4 v20, s[40:43], s90 offen  lds
    v_fmac_f32 v23, v203, v203
    v_mov_b32 v69, v23
    v_cmp_gt_u32 vcc, 32, v22
    v_mov_b32 v70, 0
    v_permlane32_swap_b32 v69, v23
    v_add_f32 v23, v23, v69
    v_fmac_f32 v23, v44, v44
    v_fmac_f32 v23, v204, v204
    v_cndmask_b32 v46, v44, v70, vcc
    v_cndmask_b32 v44, 0, v44, vcc
    v_cvt_pk_bf16_f32 v232, v144, v145
    v_cvt_pk_bf16_f32 v233, v146, v147
    v_cvt_pk_bf16_f32 v234, v148, v149
    v_cvt_pk_bf16_f32 v235, v150, v151
    v_cvt_pk_bf16_f32 v236, v152, v153
    v_cvt_pk_bf16_f32 v237, v154, v155
    v_cvt_pk_bf16_f32 v238, v156, v157
    v_cvt_pk_bf16_f32 v239, v158, v159
    s_add_u32 s91, s86, 0
    buffer_store_dwordx4 v[216:219], v0, s[44:47], s91 offen sc1
    s_waitcnt vmcnt(8) lgkmcnt(0)
    s_barrier
    ds_read_b64_tr_b16 v[136:137], v128 offset:8192
    v_mfma_f32_16x16x32_bf16 v[172:175], v[24:27], v[100:103], v[172:175]
    ds_read_b64_tr_b16 v[138:139], v128 offset:10240
    v_mfma_f32_16x16x32_bf16 v[172:175], v[28:31], v[196:199], v[172:175]
    ds_read_b64_tr_b16 v[140:141], v128 offset:12288
    v_mfma_f32_16x16x32_bf16 v[168:171], v[24:27], v[96:99], v[168:171]
    ds_read_b64_tr_b16 v[142:143], v128 offset:14336
    v_mfma_f32_16x16x32_bf16 v[168:171], v[28:31], v[124:127], v[168:171]
    ds_read_b64_tr_b16 v[24:25], v128 offset:16384
    v_mfma_f32_16x16x32_bf16 v[160:163], v[32:35], v[104:107], v[160:163]
    ds_read_b64_tr_b16 v[26:27], v128 offset:18432
    v_mfma_f32_16x16x32_bf16 v[164:167], v[32:35], v[108:111], v[164:167]
    ds_read_b64_tr_b16 v[28:29], v128 offset:20480
    v_mfma_f32_16x16x32_bf16 v[168:171], v[36:39], v[104:107], v[168:171]
    ds_read_b64_tr_b16 v[30:31], v128 offset:22528
    v_mfma_f32_16x16x32_bf16 v[172:175], v[36:39], v[108:111], v[172:175]
    ds_read_b64_tr_b16 v[32:33], v128 offset:24576
    s_waitcnt lgkmcnt(5)
    v_mfma_f32_16x16x32_bf16 v[144:147], v[136:139], v[72:75], 0
    ds_read_b64_tr_b16 v[34:35], v128 offset:26624
    v_mfma_f32_16x16x32_bf16 v[144:147], v[140:143], v[112:115], v[144:147]
    ds_read_b64_tr_b16 v[36:37], v128 offset:28672
    v_mfma_f32_16x16x32_bf16 v[148:151], v[136:139], v[76:79], 0
    ds_read_b64_tr_b16 v[38:39], v128 offset:30720
    v_mfma_f32_16x16x32_bf16 v[148:151], v[140:143], v[184:187], v[148:151]
    ds_read_b64_tr_b16 v[136:137], v128 offset:32768
    s_waitcnt lgkmcnt(5)
    v_mfma_f32_16x16x32_bf16 v[148:151], v[24:27], v[84:87], v[148:151]
    ds_read_b64_tr_b16 v[138:139], v128 offset:34816
    v_mfma_f32_16x16x32_bf16 v[148:151], v[28:31], v[188:191], v[148:151]
    ds_read_b64_tr_b16 v[140:141], v128 offset:36864
    v_mfma_f32_16x16x32_bf16 v[144:147], v[24:27], v[80:83], v[144:147]
    ds_read_b64_tr_b16 v[142:143], v128 offset:38912
    v_mfma_f32_16x16x32_bf16 v[144:147], v[28:31], v[116:119], v[144:147]
    ds_read_b64_tr_b16 v[24:25], v129 offset:8192
    s_waitcnt lgkmcnt(5)
    v_mfma_f32_16x16x32_bf16 v[144:147], v[32:35], v[88:91], v[144:147]
    ds_read_b64_tr_b16 v[26:27], v129 offset:10240
    v_mfma_f32_16x16x32_bf16 v[144:147], v[36:39], v[120:123], v[144:147]
    ds_read_b64_tr_b16 v[28:29], v129 offset:12288
    v_mfma_f32_16x16x32_bf16 v[148:151], v[32:35], v[92:95], v[148:151]
    ds_read_b64_tr_b16 v[30:31], v129 offset:14336
    v_mfma_f32_16x16x32_bf16 v[148:151], v[36:39], v[192:195], v[148:151]
    ds_read_b64_tr_b16 v[32:33], v129 offset:16384
    s_waitcnt lgkmcnt(5)
    v_mfma_f32_16x16x32_bf16 v[148:151], v[136:139], v[100:103], v[148:151]
    ds_read_b64_tr_b16 v[34:35], v129 offset:18432
    v_mfma_f32_16x16x32_bf16 v[148:151], v[140:143], v[196:199], v[148:151]
    ds_read_b64_tr_b16 v[36:37], v129 offset:20480
    v_mfma_f32_16x16x32_bf16 v[144:147], v[136:139], v[96:99], v[144:147]
    ds_read_b64_tr_b16 v[38:39], v129 offset:22528
    v_mfma_f32_16x16x32_bf16 v[144:147], v[140:143], v[124:127], v[144:147]
    ds_read_b64_tr_b16 v[136:137], v129 offset:24576
    s_waitcnt lgkmcnt(5)
    v_mfma_f32_16x16x32_bf16 v[152:155], v[24:27], v[72:75], 0
    ds_read_b64_tr_b16 v[138:139], v129 offset:26624
    v_mfma_f32_16x16x32_bf16 v[152:155], v[28:31], v[112:115], v[152:155]
    ds_read_b64_tr_b16 v[140:141], v129 offset:28672
    v_mfma_f32_16x16x32_bf16 v[156:159], v[24:27], v[76:79], 0
    ds_read_b64_tr_b16 v[142:143], v129 offset:30720
    v_mfma_f32_16x16x32_bf16 v[156:159], v[28:31], v[184:187], v[156:159]
    ds_read_b64_tr_b16 v[24:25], v129 offset:32768
    s_waitcnt lgkmcnt(5)
    v_mfma_f32_16x16x32_bf16 v[156:159], v[32:35], v[84:87], v[156:159]
    ds_read_b64_tr_b16 v[26:27], v129 offset:34816
    v_mfma_f32_16x16x32_bf16 v[156:159], v[36:39], v[188:191], v[156:159]
    ds_read_b64_tr_b16 v[28:29], v129 offset:36864
    v_mfma_f32_16x16x32_bf16 v[152:155], v[32:35], v[80:83], v[152:155]
    ds_read_b64_tr_b16 v[30:31], v129 offset:38912
    v_mfma_f32_16x16x32_bf16 v[152:155], v[36:39], v[116:119], v[152:155]
    ds_read_b64_tr_b16 v[32:33], v128 offset:40960
    s_waitcnt lgkmcnt(5)
    v_mfma_f32_16x16x32_bf16 v[152:155], v[136:139], v[88:91], v[152:155]
    ds_read_b64_tr_b16 v[34:35], v128 offset:43008
    v_mfma_f32_16x16x32_bf16 v[152:155], v[140:143], v[120:123], v[152:155]
    ds_read_b64_tr_b16 v[36:37], v129 offset:40960
    v_mfma_f32_16x16x32_bf16 v[156:159], v[136:139], v[92:95], v[156:159]
    ds_read_b64_tr_b16 v[38:39], v129 offset:43008
    v_mfma_f32_16x16x32_bf16 v[156:159], v[140:143], v[192:195], v[156:159]
    s_add_u32 m0, s78, 110592
    s_add_u32 s90, s82, 258816
    buffer_load_dwordx4 v20, s[40:43], s90 offen  lds
    v_cvt_pk_bf16_f32 v240, v160, v161
    s_lshl3_add_u32 s3, s85, s72
    v_cvt_pk_bf16_f32 v241, v162, v163
    s_lshr_b32 s88, s76, 2
    s_add_u32 m0, s78, 114688
    s_add_u32 s90, s83, 768
    buffer_load_dwordx4 v20, s[40:43], s90 offen  lds
    v_cvt_pk_bf16_f32 v242, v164, v165
    s_lshl2_add_u32 s88, s75, s88
    v_cvt_pk_bf16_f32 v243, v166, v167
    s_mul_i32 s88, s88, 589824
    v_cvt_pk_bf16_f32 v244, v168, v169
    s_add_u32 s88, s88, 0x400000
    s_add_u32 m0, s78, 118784
    s_add_u32 s90, s82, 896
    buffer_load_dwordx4 v20, s[40:43], s90 offen  lds
    v_cvt_pk_bf16_f32 v245, v170, v171
    s_lshl_b32 s77, s3, 14
    v_cvt_pk_bf16_f32 v246, v172, v173
    s_add_u32 s77, s77, s88
    s_add_u32 m0, s78, 122880
    s_add_u32 s90, s82, 37760
    buffer_load_dwordx4 v20, s[40:43], s90 offen  lds
    v_cvt_pk_bf16_f32 v247, v174, v175
    s_lshl_b32 s79, s3, 11
    s_add_u32 s91, s86, 16384
    buffer_store_dwordx4 v[220:223], v0, s[44:47], s91 offen sc1
    s_add_u32 s79, s79, s88
    s_add_u32 m0, s78, 159744
    s_min_u32 s90, s78, 1024
    buffer_load_dwordx4 v0, s[64:67], s90 offen lds
    s_add_u32 s79, s79, 524288
    s_add_u32 m0, s78, 126976
    s_add_u32 s90, s82, 74624
    buffer_load_dwordx4 v20, s[40:43], s90 offen  lds
    v_mov_b32 v6, 0
    s_mul_i32 s80, s3, 18432
    v_mov_b32 v7, 0
    s_add_u32 s80, s80, 0x40000
    v_mov_b32 v8, 0
    s_mul_i32 s88, s85, 18432
    v_mov_b32 v9, 0
    s_add_u32 s88, s88, 0xd0000
    v_mov_b32 v10, 0
    s_lshl_b32 s71, s72, 11
    v_mov_b32 v11, 0
    s_add_u32 s81, s88, s71
    v_mov_b32 v12, 0
    s_lshl_b32 s89, s72, 8
    v_mov_b32 v13, 0
    s_add_u32 s60, s88, s89
    v_mov_b32 v14, 0
    s_add_u32 s60, s60, 16384
    v_mov_b32 v15, 0
    s_add_u32 s70, s80, 16384
    v_mov_b32 v16, 0
    s_cmp_lt_u32 s85, 2
    s_cselect_b32 s88, s77, s80
    s_cselect_b32 s80, s80, s77
    s_cselect_b32 s89, s79, s70
    s_cselect_b32 s70, s70, s79
    s_mov_b32 s77, s88
    s_mov_b32 s79, s89
    v_mov_b32 v17, 0
    v_mov_b32 v18, 0
    v_mov_b32 v19, 0
    v_mov_b32 v21, 0
    s_waitcnt vmcnt(10) lgkmcnt(0)
    s_barrier
    ds_read_b64_tr_b16 v[136:137], v128 offset:45056
    v_mfma_f32_16x16x32_bf16 v[156:159], v[24:27], v[100:103], v[156:159]
    ds_read_b64_tr_b16 v[138:139], v128 offset:47104
    v_mfma_f32_16x16x32_bf16 v[156:159], v[28:31], v[196:199], v[156:159]
    ds_read_b64_tr_b16 v[140:141], v128 offset:49152
    v_mfma_f32_16x16x32_bf16 v[152:155], v[24:27], v[96:99], v[152:155]
    ds_read_b64_tr_b16 v[142:143], v128 offset:51200
    v_mfma_f32_16x16x32_bf16 v[152:155], v[28:31], v[124:127], v[152:155]
    ds_read_b64_tr_b16 v[24:25], v128 offset:53248
    v_mfma_f32_16x16x32_bf16 v[144:147], v[32:35], v[104:107], v[144:147]
    ds_read_b64_tr_b16 v[26:27], v128 offset:55296
    v_mfma_f32_16x16x32_bf16 v[148:151], v[32:35], v[108:111], v[148:151]
    ds_read_b64_tr_b16 v[28:29], v128 offset:57344
    v_mfma_f32_16x16x32_bf16 v[152:155], v[36:39], v[104:107], v[152:155]
    ds_read_b64_tr_b16 v[30:31], v128 offset:59392
    v_mfma_f32_16x16x32_bf16 v[156:159], v[36:39], v[108:111], v[156:159]
    ds_read_b64_tr_b16 v[32:33], v128 offset:61440
    s_waitcnt lgkmcnt(5)
    v_mfma_f32_16x16x32_bf16 v[160:163], v[136:139], v[72:75], 0
    ds_read_b64_tr_b16 v[34:35], v128 offset:63488
    v_mfma_f32_16x16x32_bf16 v[160:163], v[140:143], v[112:115], v[160:163]
    ds_read_b64_tr_b16 v[36:37], v130
    v_mfma_f32_16x16x32_bf16 v[164:167], v[136:139], v[76:79], 0
    ds_read_b64_tr_b16 v[38:39], v130 offset:2048
    v_mfma_f32_16x16x32_bf16 v[164:167], v[140:143], v[184:187], v[164:167]
    ds_read_b64_tr_b16 v[136:137], v130 offset:4096
    s_waitcnt lgkmcnt(5)
    v_mfma_f32_16x16x32_bf16 v[164:167], v[24:27], v[84:87], v[164:167]
    ds_read_b64_tr_b16 v[138:139], v130 offset:6144
    v_mfma_f32_16x16x32_bf16 v[164:167], v[28:31], v[188:191], v[164:167]
    ds_read_b64_tr_b16 v[140:141], v130 offset:8192
    v_mfma_f32_16x16x32_bf16 v[160:163], v[24:27], v[80:83], v[160:163]
    ds_read_b64_tr_b16 v[142:143], v130 offset:10240
    v_mfma_f32_16x16x32_bf16 v[160:163], v[28:31], v[116:119], v[160:163]
    ds_read_b64_tr_b16 v[24:25], v129 offset:45056
    s_waitcnt lgkmcnt(5)
    v_mfma_f32_16x16x32_bf16 v[160:163], v[32:35], v[88:91], v[160:163]
    ds_read_b64_tr_b16 v[26:27], v129 offset:47104
    v_mfma_f32_16x16x32_bf16 v[160:163], v[36:39], v[120:123], v[160:163]
    ds_read_b64_tr_b16 v[28:29], v129 offset:49152
    v_mfma_f32_16x16x32_bf16 v[164:167], v[32:35], v[92:95], v[164:167]
    ds_read_b64_tr_b16 v[30:31], v129 offset:51200
    v_mfma_f32_16x16x32_bf16 v[164:167], v[36:39], v[192:195], v[164:167]
    ds_read_b64_tr_b16 v[32:33], v129 offset:53248
    s_waitcnt lgkmcnt(5)
    v_mfma_f32_16x16x32_bf16 v[164:167], v[136:139], v[100:103], v[164:167]
    ds_read_b64_tr_b16 v[34:35], v129 offset:55296
    v_mfma_f32_16x16x32_bf16 v[164:167], v[140:143], v[196:199], v[164:167]
    ds_read_b64_tr_b16 v[36:37], v129 offset:57344
    v_mfma_f32_16x16x32_bf16 v[160:163], v[136:139], v[96:99], v[160:163]
    ds_read_b64_tr_b16 v[38:39], v129 offset:59392
    v_mfma_f32_16x16x32_bf16 v[160:163], v[140:143], v[124:127], v[160:163]
    ds_read_b64_tr_b16 v[136:137], v129 offset:61440
    s_waitcnt lgkmcnt(5)
    v_mfma_f32_16x16x32_bf16 v[168:171], v[24:27], v[72:75], 0
    ds_read_b64_tr_b16 v[138:139], v129 offset:63488
    v_mfma_f32_16x16x32_bf16 v[168:171], v[28:31], v[112:115], v[168:171]
    ds_read_b64_tr_b16 v[140:141], v131
    v_mfma_f32_16x16x32_bf16 v[172:175], v[24:27], v[76:79], 0
    ds_read_b64_tr_b16 v[142:143], v131 offset:2048
    v_mfma_f32_16x16x32_bf16 v[172:175], v[28:31], v[184:187], v[172:175]
    ds_read_b64_tr_b16 v[24:25], v131 offset:4096
    s_waitcnt lgkmcnt(5)
    v_mfma_f32_16x16x32_bf16 v[172:175], v[32:35], v[84:87], v[172:175]
    ds_read_b64_tr_b16 v[26:27], v131 offset:6144
    v_mfma_f32_16x16x32_bf16 v[172:175], v[36:39], v[188:191], v[172:175]
    ds_read_b64_tr_b16 v[28:29], v131 offset:8192
    v_mfma_f32_16x16x32_bf16 v[168:171], v[32:35], v[80:83], v[168:171]
    ds_read_b64_tr_b16 v[30:31], v131 offset:10240
    v_mfma_f32_16x16x32_bf16 v[168:171], v[36:39], v[116:119], v[168:171]
    ds_read_b64_tr_b16 v[32:33], v130 offset:12288
    s_waitcnt lgkmcnt(5)
    v_mfma_f32_16x16x32_bf16 v[168:171], v[136:139], v[88:91], v[168:171]
    ds_read_b64_tr_b16 v[34:35], v130 offset:14336
    v_mfma_f32_16x16x32_bf16 v[168:171], v[140:143], v[120:123], v[168:171]
    ds_read_b64_tr_b16 v[36:37], v131 offset:12288
    v_mfma_f32_16x16x32_bf16 v[172:175], v[136:139], v[92:95], v[172:175]
    ds_read_b64_tr_b16 v[38:39], v131 offset:14336
    v_mfma_f32_16x16x32_bf16 v[172:175], v[140:143], v[192:195], v[172:175]
    v_lshlrev_b32 v205, 2, v22
    buffer_load_dword v204, v205, s[48:51], 0 offen sc1
    s_add_u32 m0, s78, 143360
    s_add_u32 s90, s82, 222080
    buffer_load_dwordx4 v20, s[40:43], s90 offen  lds
    s_lshl3_add_u32 s88, s85, s72
    s_lshr_b32 s89, s76, 2
    s_lshl2_add_u32 s89, s75, s89
    s_lshl_b32 s89, s89, 5
    v_add_u32 v5, s89, v22
    s_lshl_b32 s89, s88, 5
    s_add_u32 m0, s78, 0
    s_add_u32 s90, s82, 258944
    buffer_load_dwordx4 v20, s[40:43], s90 offen  lds
    s_sub_u32 s89, s89, 32
    v_add_u32 v200, s89, v22
    v_cmp_gt_u32 vcc, 32, v22
    v_and_b32 v202, 1, v22
    s_lshl4_add_u32 s89, s85, s72
    s_lshl1_add_u32 s89, s89, 1024
    v_cndmask_b32 v5, v200, v5, vcc
    s_add_u32 m0, s78, 4096
    s_add_u32 s90, s83, 896
    buffer_load_dwordx4 v20, s[40:43], s90 offen  lds
    v_add_u32 v200, s89, v202
    v_cmp_gt_u32 vcc, 48, v22
    s_and_b32 s89, s88, 3
    s_lshl_b32 s89, s89, 5
    s_lshr_b32 s88, s88, 2
    s_add_u32 s89, s89, s88
    s_add_u32 s89, s89, 1152
    v_cndmask_b32 v5, v200, v5, vcc
    v_lshl_add_u32 v200, v202, 7, s89
    v_cmp_gt_u32 vcc, 52, v22
    s_lshl_b32 s89, s85, 5
    s_add_u32 s89, s89, 1160
    v_cndmask_b32 v5, v200, v5, vcc
L_h1page1:
    s_cbranch_execz L_probed1
    v_lshl_add_u32 v200, v202, 7, s89
    v_cmp_gt_u32 vcc, 56, v22
    s_mov_b32 s89, 0x340000
    s_nop 0
    v_cndmask_b32 v5, v200, v5, vcc
    v_lshl_add_u32 v5, v5, 5, s89
    v_cvt_pk_bf16_f32 v248, v144, v145
    v_cvt_pk_bf16_f32 v249, v146, v147
    v_cvt_pk_bf16_f32 v250, v148, v149
    v_cvt_pk_bf16_f32 v251, v150, v151
    v_cvt_pk_bf16_f32 v252, v152, v153
    v_cvt_pk_bf16_f32 v253, v154, v155
    v_cvt_pk_bf16_f32 v254, v156, v157
    v_cvt_pk_bf16_f32 v255, v158, v159
    s_add_u32 s91, s86, 65536
    buffer_store_dwordx4 v[224:227], v0, s[44:47], s91 offen sc1
    s_waitcnt vmcnt(10) lgkmcnt(0)
    s_barrier
    ds_read_b64_tr_b16 v[136:137], v130 offset:16384
    v_mfma_f32_16x16x32_bf16 v[172:175], v[24:27], v[100:103], v[172:175]
    ds_read_b64_tr_b16 v[138:139], v130 offset:18432
    v_mfma_f32_16x16x32_bf16 v[172:175], v[28:31], v[196:199], v[172:175]
    ds_read_b64_tr_b16 v[140:141], v130 offset:20480
    v_mfma_f32_16x16x32_bf16 v[168:171], v[24:27], v[96:99], v[168:171]
    ds_read_b64_tr_b16 v[142:143], v130 offset:22528
    v_mfma_f32_16x16x32_bf16 v[168:171], v[28:31], v[124:127], v[168:171]
    ds_read_b64_tr_b16 v[24:25], v130 offset:24576
    v_mfma_f32_16x16x32_bf16 v[160:163], v[32:35], v[104:107], v[160:163]
    ds_read_b64_tr_b16 v[26:27], v130 offset:26624
    v_mfma_f32_16x16x32_bf16 v[164:167], v[32:35], v[108:111], v[164:167]
    ds_read_b64_tr_b16 v[28:29], v130 offset:28672
    v_mfma_f32_16x16x32_bf16 v[168:171], v[36:39], v[104:107], v[168:171]
    ds_read_b64_tr_b16 v[30:31], v130 offset:30720
    v_mfma_f32_16x16x32_bf16 v[172:175], v[36:39], v[108:111], v[172:175]
    ds_read_b64_tr_b16 v[32:33], v130 offset:32768
    s_waitcnt lgkmcnt(5)
    v_mfma_f32_16x16x32_bf16 v[144:147], v[136:139], v[72:75], 0
    ds_read_b64_tr_b16 v[34:35], v130 offset:34816
    v_mfma_f32_16x16x32_bf16 v[144:147], v[140:143], v[112:115], v[144:147]
    ds_read_b64_tr_b16 v[36:37], v130 offset:36864
    v_mfma_f32_16x16x32_bf16 v[148:151], v[136:139], v[76:79], 0
    ds_read_b64_tr_b16 v[38:39], v130 offset:38912
    v_mfma_f32_16x16x32_bf16 v[148:151], v[140:143], v[184:187], v[148:151]
    ds_read_b64_tr_b16 v[136:137], v130 offset:40960
    s_waitcnt lgkmcnt(5)
    v_mfma_f32_16x16x32_bf16 v[148:151], v[24:27], v[84:87], v[148:151]
    ds_read_b64_tr_b16 v[138:139], v130 offset:43008
    v_mfma_f32_16x16x32_bf16 v[148:151], v[28:31], v[188:191], v[148:151]
    ds_read_b64_tr_b16 v[140:141], v130 offset:45056
    v_mfma_f32_16x16x32_bf16 v[144:147], v[24:27], v[80:83], v[144:147]
    ds_read_b64_tr_b16 v[142:143], v130 offset:47104
    v_mfma_f32_16x16x32_bf16 v[144:147], v[28:31], v[116:119], v[144:147]
    ds_read_b64_tr_b16 v[24:25], v131 offset:16384
    s_waitcnt lgkmcnt(5)
    v_mfma_f32_16x16x32_bf16 v[144:147], v[32:35], v[88:91], v[144:147]
    ds_read_b64_tr_b16 v[26:27], v131 offset:18432
    v_mfma_f32_16x16x32_bf16 v[144:147], v[36:39], v[120:123], v[144:147]
    ds_read_b64_tr_b16 v[28:29], v131 offset:20480
    v_mfma_f32_16x16x32_bf16 v[148:151], v[32:35], v[92:95], v[148:151]
    ds_read_b64_tr_b16 v[30:31], v131 offset:22528
    v_mfma_f32_16x16x32_bf16 v[148:151], v[36:39], v[192:195], v[148:151]
    ds_read_b64_tr_b16 v[32:33], v131 offset:24576
    s_waitcnt lgkmcnt(5)
    v_mfma_f32_16x16x32_bf16 v[148:151], v[136:139], v[100:103], v[148:151]
    ds_read_b64_tr_b16 v[34:35], v131 offset:26624
    v_mfma_f32_16x16x32_bf16 v[148:151], v[140:143], v[196:199], v[148:151]
    ds_read_b64_tr_b16 v[36:37], v131 offset:28672
    v_mfma_f32_16x16x32_bf16 v[144:147], v[136:139], v[96:99], v[144:147]
    ds_read_b64_tr_b16 v[38:39], v131 offset:30720
    v_mfma_f32_16x16x32_bf16 v[144:147], v[140:143], v[124:127], v[144:147]
    ds_read_b64_tr_b16 v[136:137], v131 offset:32768
    s_waitcnt lgkmcnt(5)
    v_mfma_f32_16x16x32_bf16 v[152:155], v[24:27], v[72:75], 0
    ds_read_b64_tr_b16 v[138:139], v131 offset:34816
    v_mfma_f32_16x16x32_bf16 v[152:155], v[28:31], v[112:115], v[152:155]
    ds_read_b64_tr_b16 v[140:141], v131 offset:36864
    v_mfma_f32_16x16x32_bf16 v[156:159], v[24:27], v[76:79], 0
    ds_read_b64_tr_b16 v[142:143], v131 offset:38912
    v_mfma_f32_16x16x32_bf16 v[156:159], v[28:31], v[184:187], v[156:159]
    ds_read_b64_tr_b16 v[24:25], v131 offset:40960
    s_waitcnt lgkmcnt(5)
    v_mfma_f32_16x16x32_bf16 v[156:159], v[32:35], v[84:87], v[156:159]
    ds_read_b64_tr_b16 v[26:27], v131 offset:43008
    v_mfma_f32_16x16x32_bf16 v[156:159], v[36:39], v[188:191], v[156:159]
    ds_read_b64_tr_b16 v[28:29], v131 offset:45056
    v_mfma_f32_16x16x32_bf16 v[152:155], v[32:35], v[80:83], v[152:155]
    ds_read_b64_tr_b16 v[30:31], v131 offset:47104
    v_mfma_f32_16x16x32_bf16 v[152:155], v[36:39], v[116:119], v[152:155]
    ds_read_b64_tr_b16 v[32:33], v130 offset:49152
    s_waitcnt lgkmcnt(5)
    v_mfma_f32_16x16x32_bf16 v[152:155], v[136:139], v[88:91], v[152:155]
    ds_read_b64_tr_b16 v[34:35], v130 offset:51200
    v_mfma_f32_16x16x32_bf16 v[152:155], v[140:143], v[120:123], v[152:155]
    ds_read_b64_tr_b16 v[36:37], v131 offset:49152
    v_mfma_f32_16x16x32_bf16 v[156:159], v[136:139], v[92:95], v[156:159]
    ds_read_b64_tr_b16 v[38:39], v131 offset:51200
    v_mfma_f32_16x16x32_bf16 v[156:159], v[140:143], v[192:195], v[156:159]
    s_waitcnt vmcnt(4)
    v_cmp_eq_u32 vcc, 0, v204
    s_nop 0
    s_cmp_lg_u64 vcc, 0
    s_cbranch_scc1 L_far_43
L_back_44:
    v_readlane_b32 s68, v204, 2
    s_nop 0
    s_andn2_b32 s68, s68, 15
    s_add_u32 m0, s78, 12288
    s_add_u32 s90, s78, 12288
    buffer_load_dwordx4 v0, s[44:47], s90 offen sc1 lds
    v_cvt_pk_bf16_f32 v208, v160, v161
    v_cvt_pk_bf16_f32 v209, v162, v163
    s_add_u32 m0, s78, 20480
    s_add_u32 s90, s78, 20480
    buffer_load_dwordx4 v0, s[44:47], s90 offen sc1 lds
    v_cvt_pk_bf16_f32 v210, v164, v165
    v_cvt_pk_bf16_f32 v211, v166, v167
    v_cvt_pk_bf16_f32 v212, v168, v169
    s_add_u32 m0, s78, 28672
    s_add_u32 s90, s78, 28672
    buffer_load_dwordx4 v0, s[44:47], s90 offen sc1 lds
    v_cvt_pk_bf16_f32 v213, v170, v171
    v_cvt_pk_bf16_f32 v214, v172, v173
    s_add_u32 m0, s78, 36864
    s_add_u32 s90, s78, 36864
    buffer_load_dwordx4 v0, s[44:47], s90 offen sc1 lds
    v_cvt_pk_bf16_f32 v215, v174, v175
    s_add_u32 s91, s86, 81920
    buffer_store_dwordx4 v[228:231], v0, s[44:47], s91 offen sc1
    v_max_u32_dpp v204, v204, v204 row_ror:8 row_mask:0xf bank_mask:0xf
    s_add_u32 m0, s78, 45056
    s_add_u32 s90, s78, 45056
    buffer_load_dwordx4 v0, s[44:47], s90 offen sc1 lds
    v_max_u32_dpp v204, v204, v204 row_ror:4 row_mask:0xf bank_mask:0xf
    v_mov_b32 v200, v204
    s_add_u32 m0, s78, 53248
    s_add_u32 s90, s78, 53248
    buffer_load_dwordx4 v0, s[44:47], s90 offen sc1 lds
    v_permlane32_swap_b32 v200, v204
    v_max_u32 v204, v204, v200
    v_mov_b32 v200, v204
    s_nop 1
    v_permlane16_swap_b32 v200, v204
    v_max_u32 v204, v204, v200
    s_nop 0
    v_readlane_b32 s88, v204, 0
    v_readlane_b32 s89, v204, 1
    s_nop 0
    v_mov_b32 v200, s88
    v_add_f32 v200, s89, v200
    v_mul_f32 v200, v200, v23
    v_sqrt_f32 v200, v200
    v_mov_b32 v201, 0x3c23d70a
    v_fmamk_f32 v200, v200, 0x3f828f5c, v201
    v_mov_b32 v201, 0x42200000
    v_cmp_nle_f32 s[94:95], v200, v201
    v_mov_b32 v201, 0
    v_cvt_pk_bf16_f32 v200, -v200, v201
    v_cmp_gt_u32 vcc, 32, v22
    s_nop 1
    v_cndmask_b32 v45, 0, v200, vcc
    v_cndmask_b32 v47, v200, v201, vcc
    v_mov_b32 v20, 0
    s_waitcnt vmcnt(8) lgkmcnt(0)
    s_barrier
    ds_read_b64_tr_b16 v[136:137], v130 offset:53248
    v_mfma_f32_16x16x32_bf16 v[156:159], v[24:27], v[100:103], v[156:159]
    ds_read_b64_tr_b16 v[138:139], v130 offset:55296
    v_mfma_f32_16x16x32_bf16 v[156:159], v[28:31], v[196:199], v[156:159]
    ds_read_b64_tr_b16 v[140:141], v130 offset:57344
    v_mfma_f32_16x16x32_bf16 v[152:155], v[24:27], v[96:99], v[152:155]
    ds_read_b64_tr_b16 v[142:143], v130 offset:59392
    v_mfma_f32_16x16x32_bf16 v[152:155], v[28:31], v[124:127], v[152:155]
    ds_read_b64_tr_b16 v[24:25], v130 offset:61440
    v_mfma_f32_16x16x32_bf16 v[144:147], v[32:35], v[104:107], v[144:147]
    ds_read_b64_tr_b16 v[26:27], v130 offset:63488
    v_mfma_f32_16x16x32_bf16 v[148:151], v[32:35], v[108:111], v[148:151]
    ds_read_b64_tr_b16 v[28:29], v132
    v_mfma_f32_16x16x32_bf16 v[152:155], v[36:39], v[104:107], v[152:155]
    ds_read_b64_tr_b16 v[30:31], v132 offset:2048
    v_mfma_f32_16x16x32_bf16 v[156:159], v[36:39], v[108:111], v[156:159]
    ds_read_b64_tr_b16 v[32:33], v132 offset:4096
    s_waitcnt lgkmcnt(5)
    v_mfma_f32_16x16x32_bf16 v[160:163], v[136:139], v[72:75], 0
    ds_read_b64_tr_b16 v[34:35], v132 offset:6144
    v_mfma_f32_16x16x32_bf16 v[160:163], v[140:143], v[112:115], v[160:163]
    ds_read_b64_tr_b16 v[36:37], v132 offset:8192
    v_mfma_f32_16x16x32_bf16 v[164:167], v[136:139], v[76:79], 0
    ds_read_b64_tr_b16 v[38:39], v132 offset:10240
    v_mfma_f32_16x16x32_bf16 v[164:167], v[140:143], v[184:187], v[164:167]
    ds_read_b64_tr_b16 v[136:137], v132 offset:12288
    s_waitcnt lgkmcnt(5)
    v_mfma_f32_16x16x32_bf16 v[164:167], v[24:27], v[84:87], v[164:167]
    ds_read_b64_tr_b16 v[138:139], v132 offset:14336
    v_mfma_f32_16x16x32_bf16 v[164:167], v[28:31], v[188:191], v[164:167]
    ds_read_b64_tr_b16 v[140:141], v128
    v_mfma_f32_16x16x32_bf16 v[160:163], v[24:27], v[80:83], v[160:163]
    ds_read_b64_tr_b16 v[142:143], v128 offset:2048
    v_mfma_f32_16x16x32_bf16 v[160:163], v[28:31], v[116:119], v[160:163]
    ds_read_b64_tr_b16 v[24:25], v131 offset:53248
    s_waitcnt lgkmcnt(5)
    v_mfma_f32_16x16x32_bf16 v[160:163], v[32:35], v[88:91], v[160:163]
    ds_read_b64_tr_b16 v[26:27], v131 offset:55296
    v_mfma_f32_16x16x32_bf16 v[160:163], v[36:39], v[120:123], v[160:163]
    ds_read_b64_tr_b16 v[28:29], v131 offset:57344
    v_mfma_f32_16x16x32_bf16 v[164:167], v[32:35], v[92:95], v[164:167]
    ds_read_b64_tr_b16 v[30:31], v131 offset:59392
    v_mfma_f32_16x16x32_bf16 v[164:167], v[36:39], v[192:195], v[164:167]
    ds_read_b64_tr_b16 v[32:33], v131 offset:61440
    s_waitcnt lgkmcnt(5)
    v_mfma_f32_16x16x32_bf16 v[164:167], v[136:139], v[100:103], v[164:167]
    ds_read_b64_tr_b16 v[34:35], v131 offset:63488
    v_mfma_f32_16x16x32_bf16 v[164:167], v[140:143], v[196:199], v[164:167]
    ds_read_b64_tr_b16 v[36:37], v133
    v_mfma_f32_16x16x32_bf16 v[160:163], v[136:139], v[96:99], v[160:163]
    ds_read_b64_tr_b16 v[38:39], v133 offset:2048
    v_mfma_f32_16x16x32_bf16 v[160:163], v[140:143], v[124:127], v[160:163]
    ds_read_b64_tr_b16 v[136:137], v133 offset:4096
    s_waitcnt lgkmcnt(5)
    v_mfma_f32_16x16x32_bf16 v[168:171], v[24:27], v[72:75], 0
    ds_read_b64_tr_b16 v[138:139], v133 offset:6144
    v_mfma_f32_16x16x32_bf16 v[168:171], v[28:31], v[112:115], v[168:171]
    ds_read_b64_tr_b16 v[140:141], v133 offset:8192
    v_mfma_f32_16x16x32_bf16 v[172:175], v[24:27], v[76:79], 0
    ds_read_b64_tr_b16 v[142:143], v133 offset:10240
    v_mfma_f32_16x16x32_bf16 v[172:175], v[28:31], v[184:187], v[172:175]
    ds_read_b64_tr_b16 v[24:25], v133 offset:12288
    s_waitcnt lgkmcnt(5)
    v_mfma_f32_16x16x32_bf16 v[172:175], v[32:35], v[84:87], v[172:175]
    ds_read_b64_tr_b16 v[26:27], v133 offset:14336
    v_mfma_f32_16x16x32_bf16 v[172:175], v[36:39], v[188:191], v[172:175]
    ds_read_b64_tr_b16 v[28:29], v129
    v_mfma_f32_16x16x32_bf16 v[168:171], v[32:35], v[80:83], v[168:171]
    ds_read_b64_tr_b16 v[30:31], v129 offset:2048
    v_mfma_f32_16x16x32_bf16 v[168:171], v[36:39], v[116:119], v[168:171]
    ds_read_b64_tr_b16 v[32:33], v128 offset:4096
    s_waitcnt lgkmcnt(5)
    v_mfma_f32_16x16x32_bf16 v[168:171], v[136:139], v[88:91], v[168:171]
    ds_read_b64_tr_b16 v[34:35], v128 offset:6144
    v_mfma_f32_16x16x32_bf16 v[168:171], v[140:143], v[120:123], v[168:171]
    ds_read_b64_tr_b16 v[36:37], v129 offset:4096
    v_mfma_f32_16x16x32_bf16 v[172:175], v[136:139], v[92:95], v[172:175]
    ds_read_b64_tr_b16 v[38:39], v129 offset:6144
    v_mfma_f32_16x16x32_bf16 v[172:175], v[140:143], v[192:195], v[172:175]
    s_waitcnt lgkmcnt(4)
    v_mfma_f32_16x16x32_bf16 v[172:175], v[24:27], v[100:103], v[172:175]
    v_mfma_f32_16x16x32_bf16 v[172:175], v[28:31], v[196:199], v[172:175]
    v_mfma_f32_16x16x32_bf16 v[168:171], v[24:27], v[96:99], v[168:171]
    v_mfma_f32_16x16x32_bf16 v[168:171], v[28:31], v[124:127], v[168:171]
    s_waitcnt lgkmcnt(2)
    v_mfma_f32_16x16x32_bf16 v[160:163], v[32:35], v[104:107], v[160:163]
    v_mfma_f32_16x16x32_bf16 v[164:167], v[32:35], v[108:111], v[164:167]
    s_waitcnt lgkmcnt(0)
    v_mfma_f32_16x16x32_bf16 v[168:171], v[36:39], v[104:107], v[168:171]
    v_mfma_f32_16x16x32_bf16 v[172:175], v[36:39], v[108:111], v[172:175]
    s_add_u32 m0, s78, 61440
    s_add_u32 s90, s78, 61440
    buffer_load_dwordx4 v0, s[44:47], s90 offen sc1 lds
    s_add_u32 m0, s78, 69632
    s_add_u32 s90, s78, 69632
    buffer_load_dwordx4 v0, s[44:47], s90 offen sc1 lds
    s_add_u32 m0, s78, 77824
    s_add_u32 s90, s78, 77824
    buffer_load_dwordx4 v0, s[44:47], s90 offen sc1 lds
    s_add_u32 m0, s78, 86016
    s_add_u32 s90, s78, 86016
    buffer_load_dwordx4 v0, s[44:47], s90 offen sc1 lds
    s_add_u32 m0, s78, 94208
    s_add_u32 s90, s78, 94208
    buffer_load_dwordx4 v0, s[44:47], s90 offen sc1 lds
    s_add_u32 m0, s78, 102400
    s_add_u32 s90, s78, 102400
    buffer_load_dwordx4 v0, s[44:47], s90 offen sc1 lds
    v_mov_b32 v200, -1
    v_mov_b32 v201, -1
    v_mov_b32 v202, -1
    v_mov_b32 v203, -1
    buffer_store_dwordx4 v[200:203], v0, s[44:47], s87 offen sc1
    s_lshl2_add_u32 s88, s75, s73
    s_mul_i32 s88, s88, 36864
    s_add_u32 s88, s88, 0x100000
    s_sub_u32 s34, s87, s88
    s_lshr_b32 s34, s34, 3
    s_add_u32 s34, s34, s88
    s_add_u32 s34, s34, 32768
    s_mov_b64 exec, 0xff
    buffer_store_dwordx4 v[200:203], v0, s[44:47], s34 offen sc1
    s_mov_b64 exec, -1
    v_cvt_pk_bf16_f32 v216, v144, v145
    v_cvt_pk_bf16_f32 v217, v146, v147
    v_cvt_pk_bf16_f32 v218, v148, v149
    v_cvt_pk_bf16_f32 v219, v150, v151
    v_cvt_pk_bf16_f32 v220, v152, v153
    v_cvt_pk_bf16_f32 v221, v154, v155
    v_cvt_pk_bf16_f32 v222, v156, v157
    v_cvt_pk_bf16_f32 v223, v158, v159
    v_cvt_pk_bf16_f32 v224, v160, v161
    v_cvt_pk_bf16_f32 v225, v162, v163
    v_cvt_pk_bf16_f32 v226, v164, v165
    v_cvt_pk_bf16_f32 v227, v166, v167
    v_cvt_pk_bf16_f32 v228, v168, v169
    v_cvt_pk_bf16_f32 v229, v170, v171
    v_cvt_pk_bf16_f32 v230, v172, v173
    v_cvt_pk_bf16_f32 v231, v174, v175
    s_waitcnt vmcnt(8)
    s_barrier
L_join:
    s_cmp_lg_u64 s[94:95], 0
    s_cbranch_scc1 L_slow
    ds_read_b128 v[48:51], v2 offset:9216
    ds_read_b32 v52, v4 offset:17920
    s_waitcnt lgkmcnt(0)
    v_mfma_f32_32x32x8_bf16 v[64:79], v[52:53], v[44:45], 0
    v_mfma_f32_32x32x16_bf16 v[64:79], v[48:51], v[40:43], v[64:79]
    ds_read_b128 v[48:51], v2 offset:10240
    s_setprio 2
    s_mov_b64 exec, s[92:93]
    ds_read_b128 v[56:59], v3 offset:13312
    ds_read_b128 v[60:63], v3 offset:13888
    s_mov_b64 exec, -1
    s_waitcnt lgkmcnt(2)
    v_mfma_f32_32x32x8_bf16 v[80:95], v[52:53], v[46:47], 0
    v_mfma_f32_32x32x16_bf16 v[80:95], v[48:51], v[40:43], v[80:95]
    ds_read_b128 v[48:51], v2 offset:11264
    ds_read_b32 v52, v4 offset:18176
    s_add_u32 s91, s86, 131072
    buffer_store_dwordx4 v[232:235], v0, s[44:47], s91 offen sc1
    s_setprio 0
    v_exp_f32 v64, v64
    v_exp_f32 v65, v65
    v_exp_f32 v66, v66
    v_exp_f32 v67, v67
    s_setprio 1
    v_exp_f32 v68, v68
    v_exp_f32 v69, v69
    v_exp_f32 v70, v70
    v_exp_f32 v71, v71
    v_exp_f32 v72, v72
    v_exp_f32 v73, v73
    v_exp_f32 v74, v74
    v_exp_f32 v75, v75
    v_exp_f32 v76, v76
    v_exp_f32 v77, v77
    v_exp_f32 v78, v78
    v_exp_f32 v79, v79
    s_waitcnt lgkmcnt(2)
    v_smfmac_f32_32x32x32_bf16 v[6:21], v[56:59], v[64:71], v54
    s_setprio 2
    v_smfmac_f32_32x32x32_bf16 v[6:21], v[60:63], v[72:79], v54
    s_mov_b64 exec, s[92:93]
    ds_read_b128 v[56:59], v3 offset:14464
    ds_read_b128 v[60:63], v3 offset:15040
    s_mov_b64 exec, -1
    s_waitcnt lgkmcnt(2)
    v_mfma_f32_32x32x8_bf16 v[64:79], v[52:53], v[44:45], 0
    v_mfma_f32_32x32x16_bf16 v[64:79], v[48:51], v[40:43], v[64:79]
    ds_read_b128 v[48:51], v2 offset:12288
    s_mul_i32 s90, s74, 0x1000
    s_add_u32 s90, s90, s78
    s_add_u32 m0, s90, 0
    s_add_u32 s90, s90, 0
    buffer_load_dwordx4 v0, s[44:47], s90 offen sc1 lds
    s_setprio 0
    v_exp_f32 v80, v80
    v_exp_f32 v81, v81
    v_exp_f32 v82, v82
    v_exp_f32 v83, v83
    s_setprio 1
    v_exp_f32 v84, v84
    v_exp_f32 v85, v85
    v_exp_f32 v86, v86
    v_exp_f32 v87, v87
    v_exp_f32 v88, v88
    v_exp_f32 v89, v89
    v_exp_f32 v90, v90
    v_exp_f32 v91, v91
    v_exp_f32 v92, v92
    v_exp_f32 v93, v93
    v_exp_f32 v94, v94
    v_exp_f32 v95, v95
    s_waitcnt lgkmcnt(1)
    v_smfmac_f32_32x32x32_bf16 v[6:21], v[56:59], v[80:87], v54
    s_setprio 2
    v_smfmac_f32_32x32x32_bf16 v[6:21], v[60:63], v[88:95], v54
    s_mov_b64 exec, s[92:93]
    ds_read_b128 v[56:59], v3 offset:15616
    ds_read_b128 v[60:63], v3 offset:16192
    s_mov_b64 exec, -1
    s_waitcnt lgkmcnt(2)
    v_mfma_f32_32x32x8_bf16 v[80:95], v[52:53], v[46:47], 0
    v_mfma_f32_32x32x16_bf16 v[80:95], v[48:51], v[40:43], v[80:95]
    ds_read_b128 v[48:51], v2 offset:18432
    ds_read_b32 v52, v4 offset:27136
    s_add_u32 s91, s86, 147456
    buffer_store_dwordx4 v[236:239], v0, s[44:47], s91 offen sc1
    s_setprio 0
    v_exp_f32 v64, v64
    v_exp_f32 v65, v65
    v_exp_f32 v66, v66
    v_exp_f32 v67, v67
    s_setprio 1
    v_exp_f32 v68, v68
    v_exp_f32 v69, v69
    v_exp_f32 v70, v70
    v_exp_f32 v71, v71
    v_exp_f32 v72, v72
    v_exp_f32 v73, v73
    v_exp_f32 v74, v74
    v_exp_f32 v75, v75
    v_exp_f32 v76, v76
    v_exp_f32 v77, v77
    v_exp_f32 v78, v78
    v_exp_f32 v79, v79
    s_waitcnt lgkmcnt(2)
    v_smfmac_f32_32x32x32_bf16 v[6:21], v[56:59], v[64:71], v54
    s_setprio 2
    v_smfmac_f32_32x32x32_bf16 v[6:21], v[60:63], v[72:79], v54
    s_mov_b64 exec, s[92:93]
    ds_read_b128 v[56:59], v3 offset:16768
    ds_read_b128 v[60:63], v3 offset:17344
    s_mov_b64 exec, -1
    s_waitcnt lgkmcnt(2)
    v_mfma_f32_32x32x8_bf16 v[64:79], v[52:53], v[44:45], 0
    v_mfma_f32_32x32x16_bf16 v[64:79], v[48:51], v[40:43], v[64:79]
    ds_read_b128 v[48:51], v2 offset:19456
    s_mul_i32 s90, s74, 0x1000
    s_add_u32 s90, s90, s78
    s_add_u32 m0, s90, 106496
    s_add_u32 s90, s90, 106496
    buffer_load_dwordx4 v0, s[44:47], s90 offen sc1 lds
    s_setprio 0
    v_exp_f32 v80, v80
    v_exp_f32 v81, v81
    v_exp_f32 v82, v82
    v_exp_f32 v83, v83
    s_setprio 1
    v_exp_f32 v84, v84
    v_exp_f32 v85, v85
    v_exp_f32 v86, v86
    v_exp_f32 v87, v87
    v_exp_f32 v88, v88
    v_exp_f32 v89, v89
    v_exp_f32 v90, v90
    v_exp_f32 v91, v91
    v_exp_f32 v92, v92
    v_exp_f32 v93, v93
    v_exp_f32 v94, v94
    v_exp_f32 v95, v95
    s_waitcnt lgkmcnt(1)
    v_smfmac_f32_32x32x32_bf16 v[6:21], v[56:59], v[80:87], v54
    s_setprio 2
    v_smfmac_f32_32x32x32_bf16 v[6:21], v[60:63], v[88:95], v54
    s_mov_b64 exec, s[92:93]
    ds_read_b128 v[56:59], v3 offset:22528
    ds_read_b128 v[60:63], v3 offset:23104
    s_mov_b64 exec, -1
    s_waitcnt lgkmcnt(2)
    v_mfma_f32_32x32x8_bf16 v[80:95], v[52:53], v[46:47], 0
    v_mfma_f32_32x32x16_bf16 v[80:95], v[48:51], v[40:43], v[80:95]
    ds_read_b128 v[48:51], v2 offset:20480
    ds_read_b32 v52, v4 offset:27392
    s_add_u32 s91, s86, 196608
    buffer_store_dwordx4 v[240:243], v0, s[44:47], s91 offen sc1
    s_setprio 0
    v_exp_f32 v64, v64
    v_exp_f32 v65, v65
    v_exp_f32 v66, v66
    v_exp_f32 v67, v67
    s_setprio 1
    v_exp_f32 v68, v68
    v_exp_f32 v69, v69
    v_exp_f32 v70, v70
    v_exp_f32 v71, v71
    v_exp_f32 v72, v72
    v_exp_f32 v73, v73
    v_exp_f32 v74, v74
    v_exp_f32 v75, v75
    v_exp_f32 v76, v76
    v_exp_f32 v77, v77
    v_exp_f32 v78, v78
    v_exp_f32 v79, v79
    s_waitcnt lgkmcnt(2)
    v_smfmac_f32_32x32x32_bf16 v[6:21], v[56:59], v[64:71], v54
    s_setprio 2
    v_smfmac_f32_32x32x32_bf16 v[6:21], v[60:63], v[72:79], v54
    s_mov_b64 exec, s[92:93]
    ds_read_b128 v[56:59], v3 offset:23680
    ds_read_b128 v[60:63], v3 offset:24256
    s_mov_b64 exec, -1
    s_waitcnt lgkmcnt(2)
    v_mfma_f32_32x32x8_bf16 v[64:79], v[52:53], v[44:45], 0
    v_mfma_f32_32x32x16_bf16 v[64:79], v[48:51], v[40:43], v[64:79]
    ds_read_b128 v[48:51], v2 offset:21504
    s_mul_i32 s90, s74, 0x1000
    s_add_u32 s90, s90, s78
    s_add_u32 m0, s90, 114688
    s_add_u32 s90, s90, 114688
    buffer_load_dwordx4 v0, s[44:47], s90 offen sc1 lds
    s_setprio 0
    v_exp_f32 v80, v80
    v_exp_f32 v81, v81
    v_exp_f32 v82, v82
    v_exp_f32 v83, v83
    s_setprio 1
    v_exp_f32 v84, v84
    v_exp_f32 v85, v85
    v_exp_f32 v86, v86
    v_exp_f32 v87, v87
    v_exp_f32 v88, v88
    v_exp_f32 v89, v89
    v_exp_f32 v90, v90
    v_exp_f32 v91, v91
    v_exp_f32 v92, v92
    v_exp_f32 v93, v93
    v_exp_f32 v94, v94
    v_exp_f32 v95, v95
    s_waitcnt lgkmcnt(1)
    v_smfmac_f32_32x32x32_bf16 v[6:21], v[56:59], v[80:87], v54
    s_setprio 2
    v_smfmac_f32_32x32x32_bf16 v[6:21], v[60:63], v[88:95], v54
    s_mov_b64 exec, s[92:93]
    ds_read_b128 v[56:59], v3 offset:24832
    ds_read_b128 v[60:63], v3 offset:25408
    s_mov_b64 exec, -1
    s_waitcnt lgkmcnt(2)
    v_mfma_f32_32x32x8_bf16 v[80:95], v[52:53], v[46:47], 0
    v_mfma_f32_32x32x16_bf16 v[80:95], v[48:51], v[40:43], v[80:95]
    ds_read_b128 v[48:51], v2 offset:27648
    ds_read_b32 v52, v4 offset:36352
    s_add_u32 s91, s86, 212992
    buffer_store_dwordx4 v[244:247], v0, s[44:47], s91 offen sc1
    s_setprio 0
    v_exp_f32 v64, v64
    v_exp_f32 v65, v65
    v_exp_f32 v66, v66
    v_exp_f32 v67, v67
    s_setprio 1
    v_exp_f32 v68, v68
    v_exp_f32 v69, v69
    v_exp_f32 v70, v70
    v_exp_f32 v71, v71
    v_exp_f32 v72, v72
    v_exp_f32 v73, v73
    v_exp_f32 v74, v74
    v_exp_f32 v75, v75
    v_exp_f32 v76, v76
    v_exp_f32 v77, v77
    v_exp_f32 v78, v78
    v_exp_f32 v79, v79
    s_waitcnt lgkmcnt(2)
    v_smfmac_f32_32x32x32_bf16 v[6:21], v[56:59], v[64:71], v54
    s_setprio 2
    v_smfmac_f32_32x32x32_bf16 v[6:21], v[60:63], v[72:79], v54
    s_mov_b64 exec, s[92:93]
    ds_read_b128 v[56:59], v3 offset:25984
    ds_read_b128 v[60:63], v3 offset:26560
    s_mov_b64 exec, -1
    s_waitcnt lgkmcnt(2)
    v_mfma_f32_32x32x8_bf16 v[64:79], v[52:53], v[44:45], 0
    v_mfma_f32_32x32x16_bf16 v[64:79], v[48:51], v[40:43], v[64:79]
    ds_read_b128 v[48:51], v2 offset:28672
    s_mul_i32 s90, s74, 0x1000
    s_add_u32 s90, s90, s78
    s_add_u32 m0, s90, 122880
    s_add_u32 s90, s90, 122880
    buffer_load_dwordx4 v0, s[44:47], s90 offen sc1 lds
    s_setprio 0
    v_exp_f32 v80, v80
    v_exp_f32 v81, v81
    v_exp_f32 v82, v82
    v_exp_f32 v83, v83
    s_setprio 1
    v_exp_f32 v84, v84
    v_exp_f32 v85, v85
    v_exp_f32 v86, v86
    v_exp_f32 v87, v87
    v_exp_f32 v88, v88
    v_exp_f32 v89, v89
    v_exp_f32 v90, v90
    v_exp_f32 v91, v91
    v_exp_f32 v92, v92
    v_exp_f32 v93, v93
    v_exp_f32 v94, v94
    v_exp_f32 v95, v95
    s_waitcnt lgkmcnt(1)
    v_smfmac_f32_32x32x32_bf16 v[6:21], v[56:59], v[80:87], v54
    s_setprio 2
    v_smfmac_f32_32x32x32_bf16 v[6:21], v[60:63], v[88:95], v54
    s_mov_b64 exec, s[92:93]
    ds_read_b128 v[56:59], v3 offset:31744
    ds_read_b128 v[60:63], v3 offset:32320
    s_mov_b64 exec, -1
    s_waitcnt lgkmcnt(2)
    v_mfma_f32_32x32x8_bf16 v[80:95], v[52:53], v[46:47], 0
    v_mfma_f32_32x32x16_bf16 v[80:95], v[48:51], v[40:43], v[80:95]
    ds_read_b128 v[48:51], v2 offset:29696
    ds_read_b32 v52, v4 offset:36608
    s_add_u32 s91, s86, 262144
    buffer_store_dwordx4 v[248:251], v0, s[44:47], s91 offen sc1
    s_setprio 0
    v_exp_f32 v64, v64
    v_exp_f32 v65, v65
    v_exp_f32 v66, v66
    v_exp_f32 v67, v67
    s_setprio 1
    v_exp_f32 v68, v68
    v_exp_f32 v69, v69
    v_exp_f32 v70, v70
    v_exp_f32 v71, v71
    v_exp_f32 v72, v72
    v_exp_f32 v73, v73
    v_exp_f32 v74, v74
    v_exp_f32 v75, v75
    v_exp_f32 v76, v76
    v_exp_f32 v77, v77
    v_exp_f32 v78, v78
    v_exp_f32 v79, v79
    s_waitcnt lgkmcnt(2)
    v_smfmac_f32_32x32x32_bf16 v[6:21], v[56:59], v[64:71], v54
    s_setprio 2
    v_smfmac_f32_32x32x32_bf16 v[6:21], v[60:63], v[72:79], v54
    s_mov_b64 exec, s[92:93]
    ds_read_b128 v[56:59], v3 offset:32896
    ds_read_b128 v[60:63], v3 offset:33472
    s_mov_b64 exec, -1
    s_waitcnt lgkmcnt(2)
    v_mfma_f32_32x32x8_bf16 v[64:79], v[52:53], v[44:45], 0
    v_mfma_f32_32x32x16_bf16 v[64:79], v[48:51], v[40:43], v[64:79]
    ds_read_b128 v[48:51], v2 offset:30720
    s_mul_i32 s90, s74, 0x1000
    s_add_u32 s90, s90, s78
    s_add_u32 m0, s90, 131072
    s_add_u32 s90, s90, 131072
    buffer_load_dwordx4 v0, s[44:47], s90 offen sc1 lds
    s_setprio 0
    v_exp_f32 v80, v80
    v_exp_f32 v81, v81
    v_exp_f32 v82, v82
    v_exp_f32 v83, v83
    s_setprio 1
    v_exp_f32 v84, v84
    v_exp_f32 v85, v85
    v_exp_f32 v86, v86
    v_exp_f32 v87, v87
    v_exp_f32 v88, v88
    v_exp_f32 v89, v89
    v_exp_f32 v90, v90
    v_exp_f32 v91, v91
    v_exp_f32 v92, v92
    v_exp_f32 v93, v93
    v_exp_f32 v94, v94
    v_exp_f32 v95, v95
    s_waitcnt lgkmcnt(1)
    v_smfmac_f32_32x32x32_bf16 v[6:21], v[56:59], v[80:87], v54
    s_setprio 2
    v_smfmac_f32_32x32x32_bf16 v[6:21], v[60:63], v[88:95], v54
    s_mov_b64 exec, s[92:93]
    ds_read_b128 v[56:59], v3 offset:34048
    ds_read_b128 v[60:63], v3 offset:34624
    s_mov_b64 exec, -1
    s_waitcnt lgkmcnt(2)
    v_mfma_f32_32x32x8_bf16 v[80:95], v[52:53], v[46:47], 0
    v_mfma_f32_32x32x16_bf16 v[80:95], v[48:51], v[40:43], v[80:95]
    ds_read_b128 v[48:51], v2 offset:36864
    ds_read_b32 v52, v4 offset:45568
    s_mul_i32 s90, s74, 0x1000
    s_add_u32 s90, s90, s78
    s_add_u32 m0, s90, 139264
L_h0page2:
    s_cbranch_execz L_probed0
    s_add_u32 s90, s90, 139264
    buffer_load_dwordx4 v0, s[44:47], s90 offen sc1 lds
    s_setprio 0
    v_exp_f32 v64, v64
    v_exp_f32 v65, v65
    v_exp_f32 v66, v66
    v_exp_f32 v67, v67
    s_setprio 1
    v_exp_f32 v68, v68
    v_exp_f32 v69, v69
    v_exp_f32 v70, v70
    v_exp_f32 v71, v71
    v_exp_f32 v72, v72
    v_exp_f32 v73, v73
    v_exp_f32 v74, v74
    v_exp_f32 v75, v75
    v_exp_f32 v76, v76
    v_exp_f32 v77, v77
    v_exp_f32 v78, v78
    v_exp_f32 v79, v79
    s_waitcnt lgkmcnt(2)
    v_smfmac_f32_32x32x32_bf16 v[6:21], v[56:59], v[64:71], v54
    s_setprio 2
    v_smfmac_f32_32x32x32_bf16 v[6:21], v[60:63], v[72:79], v54
    s_mov_b64 exec, s[92:93]
    ds_read_b128 v[56:59], v3 offset:35200
    ds_read_b128 v[60:63], v3 offset:35776
    s_mov_b64 exec, -1
    s_waitcnt lgkmcnt(2)
    v_mfma_f32_32x32x8_bf16 v[64:79], v[52:53], v[44:45], 0
    v_mfma_f32_32x32x16_bf16 v[64:79], v[48:51], v[40:43], v[64:79]
    ds_read_b128 v[48:51], v2 offset:37888
    s_add_u32 s91, s86, 278528
    buffer_store_dwordx4 v[252:255], v0, s[44:47], s91 offen sc1
    s_setprio 0
    v_exp_f32 v80, v80
    v_exp_f32 v81, v81
    v_exp_f32 v82, v82
    v_exp_f32 v83, v83
    s_setprio 1
    v_exp_f32 v84, v84
    v_exp_f32 v85, v85
    v_exp_f32 v86, v86
    v_exp_f32 v87, v87
    v_exp_f32 v88, v88
    v_exp_f32 v89, v89
    v_exp_f32 v90, v90
    v_exp_f32 v91, v91
    v_exp_f32 v92, v92
    v_exp_f32 v93, v93
    v_exp_f32 v94, v94
    v_exp_f32 v95, v95
    s_waitcnt lgkmcnt(1)
    v_smfmac_f32_32x32x32_bf16 v[6:21], v[56:59], v[80:87], v54
    s_setprio 2
    v_smfmac_f32_32x32x32_bf16 v[6:21], v[60:63], v[88:95], v54
    s_mov_b64 exec, s[92:93]
    ds_read_b128 v[56:59], v3 offset:40960
    ds_read_b128 v[60:63], v3 offset:41536
    s_mov_b64 exec, -1
    s_waitcnt lgkmcnt(2)
    v_mfma_f32_32x32x8_bf16 v[80:95], v[52:53], v[46:47], 0
    v_mfma_f32_32x32x16_bf16 v[80:95], v[48:51], v[40:43], v[80:95]
    ds_read_b128 v[48:51], v2 offset:38912
    ds_read_b32 v52, v4 offset:45824
    s_setprio 0
    v_exp_f32 v64, v64
    v_exp_f32 v65, v65
    v_exp_f32 v66, v66
    v_exp_f32 v67, v67
    s_setprio 1
    v_exp_f32 v68, v68
    v_exp_f32 v69, v69
    v_exp_f32 v70, v70
    v_exp_f32 v71, v71
    v_exp_f32 v72, v72
    v_exp_f32 v73, v73
    v_exp_f32 v74, v74
    v_exp_f32 v75, v75
    v_exp_f32 v76, v76
    v_exp_f32 v77, v77
    v_exp_f32 v78, v78
    v_exp_f32 v79, v79
    s_waitcnt lgkmcnt(2)
    v_smfmac_f32_32x32x32_bf16 v[6:21], v[56:59], v[64:71], v54
    s_setprio 2
    v_smfmac_f32_32x32x32_bf16 v[6:21], v[60:63], v[72:79], v54
    s_mov_b64 exec, s[92:93]
    ds_read_b128 v[56:59], v3 offset:42112
    ds_read_b128 v[60:63], v3 offset:42688
    s_mov_b64 exec, -1
    s_waitcnt lgkmcnt(2)
    v_mfma_f32_32x32x8_bf16 v[64:79], v[52:53], v[44:45], 0
    v_mfma_f32_32x32x16_bf16 v[64:79], v[48:51], v[40:43], v[64:79]
    ds_read_b128 v[48:51], v2 offset:39936
    s_add_u32 s91, s86, 327680
    buffer_store_dwordx4 v[208:211], v0, s[44:47], s91 offen sc1
    s_setprio 0
    v_exp_f32 v80, v80
    v_exp_f32 v81, v81
    v_exp_f32 v82, v82
    v_exp_f32 v83, v83
    s_setprio 1
    v_exp_f32 v84, v84
    v_exp_f32 v85, v85
    v_exp_f32 v86, v86
    v_exp_f32 v87, v87
    v_exp_f32 v88, v88
    v_exp_f32 v89, v89
    v_exp_f32 v90, v90
    v_exp_f32 v91, v91
    v_exp_f32 v92, v92
    v_exp_f32 v93, v93
    v_exp_f32 v94, v94
    v_exp_f32 v95, v95
    s_waitcnt lgkmcnt(1)
    v_smfmac_f32_32x32x32_bf16 v[6:21], v[56:59], v[80:87], v54
    s_setprio 2
    v_smfmac_f32_32x32x32_bf16 v[6:21], v[60:63], v[88:95], v54
    s_mov_b64 exec, s[92:93]
    ds_read_b128 v[56:59], v3 offset:43264
    ds_read_b128 v[60:63], v3 offset:43840
    s_mov_b64 exec, -1
    s_waitcnt lgkmcnt(2)
    v_mfma_f32_32x32x8_bf16 v[80:95], v[52:53], v[46:47], 0
    v_mfma_f32_32x32x16_bf16 v[80:95], v[48:51], v[40:43], v[80:95]
    ds_read_b128 v[48:51], v2 offset:46080
    ds_read_b32 v52, v4 offset:54784
    s_add_u32 s89, s68, 5
    v_mov_b32 v37, s89
    s_waitcnt vmcnt(6)
    s_bfm_b64 exec, 8, 0
    buffer_store_dword v37, v1, s[44:47], s84 offen sc1
    s_mov_b64 exec, -1
    s_setprio 0
    v_exp_f32 v64, v64
    v_exp_f32 v65, v65
    v_exp_f32 v66, v66
    v_exp_f32 v67, v67
    s_setprio 1
    v_exp_f32 v68, v68
    v_exp_f32 v69, v69
    v_exp_f32 v70, v70
    v_exp_f32 v71, v71
    v_exp_f32 v72, v72
    v_exp_f32 v73, v73
    v_exp_f32 v74, v74
    v_exp_f32 v75, v75
    v_exp_f32 v76, v76
    v_exp_f32 v77, v77
    v_exp_f32 v78, v78
    v_exp_f32 v79, v79
    s_waitcnt lgkmcnt(2)
    v_smfmac_f32_32x32x32_bf16 v[6:21], v[56:59], v[64:71], v54
    s_setprio 2
    v_smfmac_f32_32x32x32_bf16 v[6:21], v[60:63], v[72:79], v54
    s_mov_b64 exec, s[92:93]
    ds_read_b128 v[56:59], v3 offset:44416
    ds_read_b128 v[60:63], v3 offset:44992
    s_mov_b64 exec, -1
    s_waitcnt lgkmcnt(2)
    v_mfma_f32_32x32x8_bf16 v[64:79], v[52:53], v[44:45], 0
    v_mfma_f32_32x32x16_bf16 v[64:79], v[48:51], v[40:43], v[64:79]
    ds_read_b128 v[48:51], v2 offset:47104
    s_add_u32 s91, s86, 344064
    buffer_store_dwordx4 v[212:215], v0, s[44:47], s91 offen sc1
    s_setprio 0
    v_exp_f32 v80, v80
    v_exp_f32 v81, v81
    v_exp_f32 v82, v82
    v_exp_f32 v83, v83
    s_setprio 1
    v_exp_f32 v84, v84
    v_exp_f32 v85, v85
    v_exp_f32 v86, v86
    v_exp_f32 v87, v87
    v_exp_f32 v88, v88
    v_exp_f32 v89, v89
    v_exp_f32 v90, v90
    v_exp_f32 v91, v91
    v_exp_f32 v92, v92
    v_exp_f32 v93, v93
    v_exp_f32 v94, v94
    v_exp_f32 v95, v95
    s_waitcnt lgkmcnt(1)
    v_smfmac_f32_32x32x32_bf16 v[6:21], v[56:59], v[80:87], v54
    s_setprio 2
    v_smfmac_f32_32x32x32_bf16 v[6:21], v[60:63], v[88:95], v54
    s_mov_b64 exec, s[92:93]
    ds_read_b128 v[56:59], v3 offset:50176
    ds_read_b128 v[60:63], v3 offset:50752
    s_mov_b64 exec, -1
    s_waitcnt lgkmcnt(2)
    v_mfma_f32_32x32x8_bf16 v[80:95], v[52:53], v[46:47], 0
    v_mfma_f32_32x32x16_bf16 v[80:95], v[48:51], v[40:43], v[80:95]
    ds_read_b128 v[48:51], v2 offset:48128
    ds_read_b32 v52, v4 offset:55040
    s_setprio 0
    v_exp_f32 v64, v64
    v_exp_f32 v65, v65
    v_exp_f32 v66, v66
    v_exp_f32 v67, v67
    s_setprio 1
    v_exp_f32 v68, v68
    v_exp_f32 v69, v69
    v_exp_f32 v70, v70
    v_exp_f32 v71, v71
    v_exp_f32 v72, v72
    v_exp_f32 v73, v73
    v_exp_f32 v74, v74
    v_exp_f32 v75, v75
    v_exp_f32 v76, v76
    v_exp_f32 v77, v77
    v_exp_f32 v78, v78
    v_exp_f32 v79, v79
    s_waitcnt lgkmcnt(2)
    v_smfmac_f32_32x32x32_bf16 v[6:21], v[56:59], v[64:71], v54
    s_setprio 2
    v_smfmac_f32_32x32x32_bf16 v[6:21], v[60:63], v[72:79], v54
    s_mov_b64 exec, s[92:93]
    ds_read_b128 v[56:59], v3 offset:51328
    ds_read_b128 v[60:63], v3 offset:51904
    s_mov_b64 exec, -1
    s_waitcnt lgkmcnt(2)
    v_mfma_f32_32x32x8_bf16 v[64:79], v[52:53], v[44:45], 0
    v_mfma_f32_32x32x16_bf16 v[64:79], v[48:51], v[40:43], v[64:79]
    ds_read_b128 v[48:51], v2 offset:49152
    s_add_u32 s91, s86, 393216
    buffer_store_dwordx4 v[216:219], v0, s[44:47], s91 offen sc1
    s_cmp_eq_u32 s74, 1
    s_cbranch_scc0 L_skip_59
    s_waitcnt vmcnt(5)
    s_barrier
L_skip_59:
    s_setprio 0
    v_exp_f32 v80, v80
    v_exp_f32 v81, v81
    v_exp_f32 v82, v82
    v_exp_f32 v83, v83
    s_setprio 1
    v_exp_f32 v84, v84
    v_exp_f32 v85, v85
    v_exp_f32 v86, v86
    v_exp_f32 v87, v87
    v_exp_f32 v88, v88
    v_exp_f32 v89, v89
    v_exp_f32 v90, v90
    v_exp_f32 v91, v91
    v_exp_f32 v92, v92
    v_exp_f32 v93, v93
    v_exp_f32 v94, v94
    v_exp_f32 v95, v95
    s_cmp_eq_u32 s74, 0
    s_cbranch_scc0 L_skip_60
    s_waitcnt vmcnt(5)
    s_barrier
L_skip_60:
    s_waitcnt lgkmcnt(1)
    v_smfmac_f32_32x32x32_bf16 v[6:21], v[56:59], v[80:87], v54
    s_setprio 2
    v_smfmac_f32_32x32x32_bf16 v[6:21], v[60:63], v[88:95], v54
    s_mov_b64 exec, s[92:93]
    ds_read_b128 v[56:59], v3 offset:52480
    ds_read_b128 v[60:63], v3 offset:53056
    s_mov_b64 exec, -1
    s_waitcnt lgkmcnt(2)
    v_mfma_f32_32x32x8_bf16 v[80:95], v[52:53], v[46:47], 0
    v_mfma_f32_32x32x16_bf16 v[80:95], v[48:51], v[40:43], v[80:95]
    ds_read_b128 v[48:51], v2 offset:55296
    ds_read_b32 v52, v4 offset:64000
    s_setprio 0
    v_exp_f32 v64, v64
    v_exp_f32 v65, v65
    v_exp_f32 v66, v66
    v_exp_f32 v67, v67
    s_setprio 1
    v_exp_f32 v68, v68
    v_exp_f32 v69, v69
    v_exp_f32 v70, v70
    v_exp_f32 v71, v71
    v_exp_f32 v72, v72
    v_exp_f32 v73, v73
    v_exp_f32 v74, v74
    v_exp_f32 v75, v75
    v_exp_f32 v76, v76
    v_exp_f32 v77, v77
    v_exp_f32 v78, v78
    v_exp_f32 v79, v79
    s_waitcnt lgkmcnt(2)
    v_smfmac_f32_32x32x32_bf16 v[6:21], v[56:59], v[64:71], v54
    s_setprio 2
    v_smfmac_f32_32x32x32_bf16 v[6:21], v[60:63], v[72:79], v54
    s_mov_b64 exec, s[92:93]
    ds_read_b128 v[56:59], v3 offset:53632
    ds_read_b128 v[60:63], v3 offset:54208
    s_mov_b64 exec, -1
    s_waitcnt lgkmcnt(2)
    v_mfma_f32_32x32x8_bf16 v[64:79], v[52:53], v[44:45], 0
    v_mfma_f32_32x32x16_bf16 v[64:79], v[48:51], v[40:43], v[64:79]
    ds_read_b128 v[48:51], v2 offset:56320
    s_add_u32 s91, s86, 409600
    buffer_store_dwordx4 v[220:223], v0, s[44:47], s91 offen sc1
    s_setprio 0
    v_exp_f32 v80, v80
    v_exp_f32 v81, v81
    v_exp_f32 v82, v82
    v_exp_f32 v83, v83
    s_setprio 1
    v_exp_f32 v84, v84
    v_exp_f32 v85, v85
    v_exp_f32 v86, v86
    v_exp_f32 v87, v87
    v_exp_f32 v88, v88
    v_exp_f32 v89, v89
    v_exp_f32 v90, v90
    v_exp_f32 v91, v91
    v_exp_f32 v92, v92
    v_exp_f32 v93, v93
    v_exp_f32 v94, v94
    v_exp_f32 v95, v95
    s_waitcnt lgkmcnt(1)
    v_smfmac_f32_32x32x32_bf16 v[6:21], v[56:59], v[80:87], v54
    s_setprio 2
    v_smfmac_f32_32x32x32_bf16 v[6:21], v[60:63], v[88:95], v54
    s_mov_b64 exec, s[92:93]
    ds_read_b128 v[56:59], v3 offset:59392
    ds_read_b128 v[60:63], v3 offset:59968
    s_mov_b64 exec, -1
    s_waitcnt lgkmcnt(2)
    v_mfma_f32_32x32x8_bf16 v[80:95], v[52:53], v[46:47], 0
    v_mfma_f32_32x32x16_bf16 v[80:95], v[48:51], v[40:43], v[80:95]
    ds_read_b128 v[48:51], v2 offset:57344
    ds_read_b32 v52, v4 offset:64256
    buffer_load_dword v39, v5, s[44:47], 0 offen sc1
    s_setprio 0
    v_exp_f32 v64, v64
    v_exp_f32 v65, v65
    v_exp_f32 v66, v66
    v_exp_f32 v67, v67
    s_setprio 1
    v_exp_f32 v68, v68
    v_exp_f32 v69, v69
    v_exp_f32 v70, v70
    v_exp_f32 v71, v71
    v_exp_f32 v72, v72
    v_exp_f32 v73, v73
    v_exp_f32 v74, v74
    v_exp_f32 v75, v75
    v_exp_f32 v76, v76
    v_exp_f32 v77, v77
    v_exp_f32 v78, v78
    v_exp_f32 v79, v79
    s_waitcnt lgkmcnt(2)
    v_smfmac_f32_32x32x32_bf16 v[6:21], v[56:59], v[64:71], v54
    s_setprio 2
    v_smfmac_f32_32x32x32_bf16 v[6:21], v[60:63], v[72:79], v54
    s_mov_b64 exec, s[92:93]
    ds_read_b128 v[56:59], v3 offset:60544
    ds_read_b128 v[60:63], v3 offset:61120
    s_mov_b64 exec, -1
    s_waitcnt lgkmcnt(2)
    v_mfma_f32_32x32x8_bf16 v[64:79], v[52:53], v[44:45], 0
    v_mfma_f32_32x32x16_bf16 v[64:79], v[48:51], v[40:43], v[64:79]
    ds_read_b128 v[48:51], v2 offset:58368
    s_setprio 0
    v_exp_f32 v80, v80
    v_exp_f32 v81, v81
    v_exp_f32 v82, v82
    v_exp_f32 v83, v83
    s_setprio 1
    v_exp_f32 v84, v84
    v_exp_f32 v85, v85
    v_exp_f32 v86, v86
    v_exp_f32 v87, v87
    v_exp_f32 v88, v88
    v_exp_f32 v89, v89
    v_exp_f32 v90, v90
    v_exp_f32 v91, v91
    v_exp_f32 v92, v92
    v_exp_f32 v93, v93
    v_exp_f32 v94, v94
    v_exp_f32 v95, v95
    s_waitcnt lgkmcnt(1)
    v_smfmac_f32_32x32x32_bf16 v[6:21], v[56:59], v[80:87], v54
    s_setprio 2
    v_smfmac_f32_32x32x32_bf16 v[6:21], v[60:63], v[88:95], v54
    s_mov_b64 exec, s[92:93]
    ds_read_b128 v[56:59], v3 offset:61696
    ds_read_b128 v[60:63], v3 offset:62272
    s_mov_b64 exec, -1
    s_waitcnt lgkmcnt(2)
    v_mfma_f32_32x32x8_bf16 v[80:95], v[52:53], v[46:47], 0
    v_mfma_f32_32x32x16_bf16 v[80:95], v[48:51], v[40:43], v[80:95]
    ds_read_b128 v[48:51], v2 offset:64512
    v_add_u32 v4, 0x11c00, v4
    ds_read_b32 v52, v4 offset:512
    s_add_u32 s91, s86, 458752
    buffer_store_dwordx4 v[224:227], v0, s[44:47], s91 offen sc1
    s_setprio 0
    v_exp_f32 v64, v64
    v_exp_f32 v65, v65
    v_exp_f32 v66, v66
    v_exp_f32 v67, v67
    s_setprio 1
    v_exp_f32 v68, v68
    v_exp_f32 v69, v69
    v_exp_f32 v70, v70
    v_exp_f32 v71, v71
    v_exp_f32 v72, v72
    v_exp_f32 v73, v73
    v_exp_f32 v74, v74
    v_exp_f32 v75, v75
    v_exp_f32 v76, v76
    v_exp_f32 v77, v77
    v_exp_f32 v78, v78
    v_exp_f32 v79, v79
    s_waitcnt lgkmcnt(2)
    v_smfmac_f32_32x32x32_bf16 v[6:21], v[56:59], v[64:71], v54
    s_setprio 2
    v_smfmac_f32_32x32x32_bf16 v[6:21], v[60:63], v[72:79], v54
    s_mov_b64 exec, s[92:93]
    ds_read_b128 v[56:59], v3 offset:62848
    ds_read_b128 v[60:63], v3 offset:63424
    s_mov_b64 exec, -1
    s_waitcnt lgkmcnt(2)
    v_mfma_f32_32x32x8_bf16 v[64:79], v[52:53], v[44:45], 0
    v_mfma_f32_32x32x16_bf16 v[64:79], v[48:51], v[40:43], v[64:79]
    v_add_u32 v2, 0x10000, v2
    ds_read_b128 v[48:51], v2
    s_setprio 0
    v_exp_f32 v80, v80
    v_exp_f32 v81, v81
    v_exp_f32 v82, v82
    v_exp_f32 v83, v83
    s_setprio 1
    v_exp_f32 v84, v84
    v_exp_f32 v85, v85
    v_exp_f32 v86, v86
    v_exp_f32 v87, v87
    v_exp_f32 v88, v88
    v_exp_f32 v89, v89
    v_exp_f32 v90, v90
    v_exp_f32 v91, v91
    v_exp_f32 v92, v92
    v_exp_f32 v93, v93
    v_exp_f32 v94, v94
    v_exp_f32 v95, v95
    s_waitcnt lgkmcnt(1)
    v_smfmac_f32_32x32x32_bf16 v[6:21], v[56:59], v[80:87], v54
    s_setprio 2
    s_add_u32 s89, s68, 5
    s_waitcnt vmcnt(1)
    v_subrev_u32 v39, s89, v39
    v_cmp_lt_u32 vcc, 8, v39
    s_nop 0
    s_cmp_lg_u64 vcc, 0
    s_cbranch_scc1 L_far_53
L_back_54:
    v_smfmac_f32_32x32x32_bf16 v[6:21], v[60:63], v[88:95], v54
    s_mov_b64 exec, s[92:93]
    v_add_u32 v3, 0x10c00, v3
    ds_read_b128 v[56:59], v3
    ds_read_b128 v[60:63], v3 offset:576
    s_mov_b64 exec, -1
    s_waitcnt lgkmcnt(2)
    v_mfma_f32_32x32x8_bf16 v[80:95], v[52:53], v[46:47], 0
    v_mfma_f32_32x32x16_bf16 v[80:95], v[48:51], v[40:43], v[80:95]
    ds_read_b128 v[48:51], v2 offset:1024
    ds_read_b32 v52, v4 offset:768
    s_add_u32 s91, s86, 475136
    buffer_store_dwordx4 v[228:231], v0, s[44:47], s91 offen sc1
    s_setprio 0
    v_exp_f32 v64, v64
    v_exp_f32 v65, v65
    v_exp_f32 v66, v66
    v_exp_f32 v67, v67
    s_setprio 1
    v_exp_f32 v68, v68
    v_exp_f32 v69, v69
    v_exp_f32 v70, v70
    v_exp_f32 v71, v71
    v_exp_f32 v72, v72
    v_exp_f32 v73, v73
    v_exp_f32 v74, v74
    v_exp_f32 v75, v75
    v_exp_f32 v76, v76
    v_exp_f32 v77, v77
    v_exp_f32 v78, v78
    v_exp_f32 v79, v79
    s_waitcnt lgkmcnt(2)
    v_smfmac_f32_32x32x32_bf16 v[6:21], v[56:59], v[64:71], v54
    s_setprio 2
    v_smfmac_f32_32x32x32_bf16 v[6:21], v[60:63], v[72:79], v54
    s_mov_b64 exec, s[92:93]
    ds_read_b128 v[56:59], v3 offset:1152
    ds_read_b128 v[60:63], v3 offset:1728
    s_mov_b64 exec, -1
    s_waitcnt lgkmcnt(2)
    v_mfma_f32_32x32x8_bf16 v[64:79], v[52:53], v[44:45], 0
    v_mfma_f32_32x32x16_bf16 v[64:79], v[48:51], v[40:43], v[64:79]
    ds_read_b128 v[48:51], v2 offset:2048
    buffer_load_dwordx4 v[164:167], v0, s[44:47], s79 offen sc1
    s_setprio 0
    v_exp_f32 v80, v80
    v_exp_f32 v81, v81
    v_exp_f32 v82, v82
    v_exp_f32 v83, v83
    s_setprio 1
    v_exp_f32 v84, v84
    v_exp_f32 v85, v85
    v_exp_f32 v86, v86
    v_exp_f32 v87, v87
    v_exp_f32 v88, v88
    v_exp_f32 v89, v89
    v_exp_f32 v90, v90
    v_exp_f32 v91, v91
    v_exp_f32 v92, v92
    v_exp_f32 v93, v93
    v_exp_f32 v94, v94
    v_exp_f32 v95, v95
    s_waitcnt lgkmcnt(1)
    v_smfmac_f32_32x32x32_bf16 v[6:21], v[56:59], v[80:87], v54
    s_setprio 2
    v_smfmac_f32_32x32x32_bf16 v[6:21], v[60:63], v[88:95], v54
    s_mov_b64 exec, s[92:93]
    ds_read_b128 v[56:59], v3 offset:2304
    ds_read_b128 v[60:63], v3 offset:2880
    s_mov_b64 exec, -1
    s_waitcnt lgkmcnt(2)
    v_mfma_f32_32x32x8_bf16 v[80:95], v[52:53], v[46:47], 0
    v_mfma_f32_32x32x16_bf16 v[80:95], v[48:51], v[40:43], v[80:95]
    ds_read_b128 v[48:51], v2 offset:8192
    ds_read_b32 v52, v4 offset:9728
    buffer_load_dwordx4 v[168:171], v0, s[44:47], s79 offen offset:1024 sc1
    s_setprio 0
    v_exp_f32 v64, v64
    v_exp_f32 v65, v65
    v_exp_f32 v66, v66
    v_exp_f32 v67, v67
    s_setprio 1
    v_exp_f32 v68, v68
    v_exp_f32 v69, v69
    v_exp_f32 v70, v70
    v_exp_f32 v71, v71
    v_exp_f32 v72, v72
    v_exp_f32 v73, v73
    v_exp_f32 v74, v74
    v_exp_f32 v75, v75
    v_exp_f32 v76, v76
    v_exp_f32 v77, v77
    v_exp_f32 v78, v78
    v_exp_f32 v79, v79
    s_waitcnt lgkmcnt(2)
    v_smfmac_f32_32x32x32_bf16 v[6:21], v[56:59], v[64:71], v54
    s_setprio 2
    v_smfmac_f32_32x32x32_bf16 v[6:21], v[60:63], v[72:79], v54
    s_mov_b64 exec, s[92:93]
    ds_read_b128 v[56:59], v3 offset:3456
    ds_read_b128 v[60:63], v3 offset:4032
    s_mov_b64 exec, -1
    s_waitcnt lgkmcnt(2)
    v_mfma_f32_32x32x8_bf16 v[64:79], v[52:53], v[44:45], 0
    v_mfma_f32_32x32x16_bf16 v[64:79], v[48:51], v[40:43], v[64:79]
    ds_read_b128 v[48:51], v2 offset:9216
    s_xor_b32 s90, s71, 0
    s_add_u32 s90, s90, s77
    buffer_load_dwordx4 v[100:103], v0, s[44:47], s90 offen offset:0 sc1
    s_setprio 0
    v_exp_f32 v80, v80
    v_exp_f32 v81, v81
    v_exp_f32 v82, v82
    v_exp_f32 v83, v83
    s_setprio 1
    v_exp_f32 v84, v84
    v_exp_f32 v85, v85
    v_exp_f32 v86, v86
    v_exp_f32 v87, v87
    v_exp_f32 v88, v88
    v_exp_f32 v89, v89
    v_exp_f32 v90, v90
    v_exp_f32 v91, v91
    v_exp_f32 v92, v92
    v_exp_f32 v93, v93
    v_exp_f32 v94, v94
    v_exp_f32 v95, v95
    s_waitcnt lgkmcnt(1)
    v_smfmac_f32_32x32x32_bf16 v[6:21], v[56:59], v[80:87], v54
    s_setprio 2
    v_smfmac_f32_32x32x32_bf16 v[6:21], v[60:63], v[88:95], v54
    s_mov_b64 exec, s[92:93]
    ds_read_b128 v[56:59], v3 offset:9216
    ds_read_b128 v[60:63], v3 offset:9792
    s_mov_b64 exec, -1
    s_waitcnt lgkmcnt(2)
    v_mfma_f32_32x32x8_bf16 v[80:95], v[52:53], v[46:47], 0
    v_mfma_f32_32x32x16_bf16 v[80:95], v[48:51], v[40:43], v[80:95]
    ds_read_b128 v[48:51], v2 offset:10240
    ds_read_b32 v52, v4 offset:9984
    s_xor_b32 s90, s71, 0
    s_add_u32 s90, s90, s77
    buffer_load_dwordx4 v[104:107], v0, s[44:47], s90 offen offset:1024 sc1
    s_setprio 0
    v_exp_f32 v64, v64
    v_exp_f32 v65, v65
    v_exp_f32 v66, v66
    v_exp_f32 v67, v67
    s_setprio 1
    v_exp_f32 v68, v68
    v_exp_f32 v69, v69
    v_exp_f32 v70, v70
    v_exp_f32 v71, v71
    v_exp_f32 v72, v72
    v_exp_f32 v73, v73
    v_exp_f32 v74, v74
    v_exp_f32 v75, v75
    v_exp_f32 v76, v76
    v_exp_f32 v77, v77
    v_exp_f32 v78, v78
    v_exp_f32 v79, v79
    s_waitcnt lgkmcnt(2)
    v_smfmac_f32_32x32x32_bf16 v[6:21], v[56:59], v[64:71], v54
    s_setprio 2
    v_smfmac_f32_32x32x32_bf16 v[6:21], v[60:63], v[72:79], v54
    s_mov_b64 exec, s[92:93]
    ds_read_b128 v[56:59], v3 offset:10368
    ds_read_b128 v[60:63], v3 offset:10944
    s_mov_b64 exec, -1
    s_waitcnt lgkmcnt(2)
    v_mfma_f32_32x32x8_bf16 v[64:79], v[52:53], v[44:45], 0
    v_mfma_f32_32x32x16_bf16 v[64:79], v[48:51], v[40:43], v[64:79]
    ds_read_b128 v[48:51], v2 offset:11264
    s_xor_b32 s90, s71, 2048
    s_add_u32 s90, s90, s77
    buffer_load_dwordx4 v[108:111], v0, s[44:47], s90 offen offset:0 sc1
    s_setprio 0
    v_exp_f32 v80, v80
    v_exp_f32 v81, v81
    v_exp_f32 v82, v82
    v_exp_f32 v83, v83
    s_setprio 1
    v_exp_f32 v84, v84
    v_exp_f32 v85, v85
    v_exp_f32 v86, v86
    v_exp_f32 v87, v87
    v_exp_f32 v88, v88
    v_exp_f32 v89, v89
    v_exp_f32 v90, v90
    v_exp_f32 v91, v91
    v_exp_f32 v92, v92
    v_exp_f32 v93, v93
    v_exp_f32 v94, v94
    v_exp_f32 v95, v95
    s_waitcnt lgkmcnt(1)
    v_smfmac_f32_32x32x32_bf16 v[6:21], v[56:59], v[80:87], v54
    s_setprio 2
    v_smfmac_f32_32x32x32_bf16 v[6:21], v[60:63], v[88:95], v54
    s_mov_b64 exec, s[92:93]
    ds_read_b128 v[56:59], v3 offset:11520
    ds_read_b128 v[60:63], v3 offset:12096
    s_mov_b64 exec, -1
    s_waitcnt lgkmcnt(2)
    v_mfma_f32_32x32x8_bf16 v[80:95], v[52:53], v[46:47], 0
    v_mfma_f32_32x32x16_bf16 v[80:95], v[48:51], v[40:43], v[80:95]
    ds_read_b128 v[48:51], v2 offset:17408
    ds_read_b32 v52, v4 offset:18944
    s_xor_b32 s90, s71, 2048
    s_add_u32 s90, s90, s77
    buffer_load_dwordx4 v[112:115], v0, s[44:47], s90 offen offset:1024 sc1
    s_setprio 0
    v_exp_f32 v64, v64
    v_exp_f32 v65, v65
    v_exp_f32 v66, v66
    v_exp_f32 v67, v67
    s_setprio 1
    v_exp_f32 v68, v68
    v_exp_f32 v69, v69
    v_exp_f32 v70, v70
    v_exp_f32 v71, v71
    v_exp_f32 v72, v72
    v_exp_f32 v73, v73
    v_exp_f32 v74, v74
    v_exp_f32 v75, v75
    v_exp_f32 v76, v76
    v_exp_f32 v77, v77
    v_exp_f32 v78, v78
    v_exp_f32 v79, v79
    s_waitcnt lgkmcnt(2)
    v_smfmac_f32_32x32x32_bf16 v[6:21], v[56:59], v[64:71], v54
    s_setprio 2
    v_smfmac_f32_32x32x32_bf16 v[6:21], v[60:63], v[72:79], v54
    s_mov_b64 exec, s[92:93]
    ds_read_b128 v[56:59], v3 offset:12672
    ds_read_b128 v[60:63], v3 offset:13248
    s_mov_b64 exec, -1
    s_waitcnt lgkmcnt(2)
    v_mfma_f32_32x32x8_bf16 v[64:79], v[52:53], v[44:45], 0
    v_mfma_f32_32x32x16_bf16 v[64:79], v[48:51], v[40:43], v[64:79]
    ds_read_b128 v[48:51], v2 offset:18432
    s_add_u32 s89, s68, 9
    v_mov_b32 v37, s89
    s_waitcnt vmcnt(6)
    s_bfm_b64 exec, 8, 0
    buffer_store_dword v37, v1, s[44:47], s84 offen sc1
    s_mov_b64 exec, -1
    s_setprio 0
    v_exp_f32 v80, v80
    v_exp_f32 v81, v81
    v_exp_f32 v82, v82
    v_exp_f32 v83, v83
    s_setprio 1
    v_exp_f32 v84, v84
    v_exp_f32 v85, v85
    v_exp_f32 v86, v86
    v_exp_f32 v87, v87
    v_exp_f32 v88, v88
    v_exp_f32 v89, v89
    v_exp_f32 v90, v90
    v_exp_f32 v91, v91
    v_exp_f32 v92, v92
    v_exp_f32 v93, v93
    v_exp_f32 v94, v94
    v_exp_f32 v95, v95
    s_waitcnt lgkmcnt(1)
    v_smfmac_f32_32x32x32_bf16 v[6:21], v[56:59], v[80:87], v54
    s_setprio 2
    v_smfmac_f32_32x32x32_bf16 v[6:21], v[60:63], v[88:95], v54
    s_mov_b64 exec, s[92:93]
    ds_read_b128 v[56:59], v3 offset:18432
    ds_read_b128 v[60:63], v3 offset:19008
    s_mov_b64 exec, -1
    s_waitcnt lgkmcnt(2)
    v_mfma_f32_32x32x8_bf16 v[80:95], v[52:53], v[46:47], 0
    v_mfma_f32_32x32x16_bf16 v[80:95], v[48:51], v[40:43], v[80:95]
    ds_read_b128 v[48:51], v2 offset:19456
    ds_read_b32 v52, v4 offset:19200
    s_xor_b32 s90, s71, 4096
    s_add_u32 s90, s90, s77
    buffer_load_dwordx4 v[116:119], v0, s[44:47], s90 offen offset:0 sc1
    s_setprio 0
    v_exp_f32 v64, v64
    v_exp_f32 v65, v65
    v_exp_f32 v66, v66
    v_exp_f32 v67, v67
    s_setprio 1
    v_exp_f32 v68, v68
    v_exp_f32 v69, v69
    v_exp_f32 v70, v70
    v_exp_f32 v71, v71
    v_exp_f32 v72, v72
    v_exp_f32 v73, v73
    v_exp_f32 v74, v74
    v_exp_f32 v75, v75
    v_exp_f32 v76, v76
    v_exp_f32 v77, v77
    v_exp_f32 v78, v78
    v_exp_f32 v79, v79
    s_waitcnt lgkmcnt(2)
    v_smfmac_f32_32x32x32_bf16 v[6:21], v[56:59], v[64:71], v54
    s_setprio 2
    v_smfmac_f32_32x32x32_bf16 v[6:21], v[60:63], v[72:79], v54
    s_mov_b64 exec, s[92:93]
    ds_read_b128 v[56:59], v3 offset:19584
    ds_read_b128 v[60:63], v3 offset:20160
    s_mov_b64 exec, -1
    s_waitcnt lgkmcnt(2)
    v_mfma_f32_32x32x8_bf16 v[64:79], v[52:53], v[44:45], 0
    v_mfma_f32_32x32x16_bf16 v[64:79], v[48:51], v[40:43], v[64:79]
    ds_read_b128 v[48:51], v2 offset:20480
    s_xor_b32 s90, s71, 4096
    s_add_u32 s90, s90, s77
    buffer_load_dwordx4 v[120:123], v0, s[44:47], s90 offen offset:1024 sc1
    s_setprio 0
    v_exp_f32 v80, v80
    v_exp_f32 v81, v81
    v_exp_f32 v82, v82
    v_exp_f32 v83, v83
    s_setprio 1
    v_exp_f32 v84, v84
    v_exp_f32 v85, v85
    v_exp_f32 v86, v86
    v_exp_f32 v87, v87
    v_exp_f32 v88, v88
    v_exp_f32 v89, v89
    v_exp_f32 v90, v90
    v_exp_f32 v91, v91
    v_exp_f32 v92, v92
    v_exp_f32 v93, v93
    v_exp_f32 v94, v94
    v_exp_f32 v95, v95
    s_waitcnt lgkmcnt(1)
    v_smfmac_f32_32x32x32_bf16 v[6:21], v[56:59], v[80:87], v54
    s_setprio 2
    v_smfmac_f32_32x32x32_bf16 v[6:21], v[60:63], v[88:95], v54
    s_mov_b64 exec, s[92:93]
    ds_read_b128 v[56:59], v3 offset:20736
    ds_read_b128 v[60:63], v3 offset:21312
    s_mov_b64 exec, -1
    s_waitcnt lgkmcnt(2)
    v_mfma_f32_32x32x8_bf16 v[80:95], v[52:53], v[46:47], 0
    v_mfma_f32_32x32x16_bf16 v[80:95], v[48:51], v[40:43], v[80:95]
    ds_read_b128 v[48:51], v2 offset:26624
    ds_read_b32 v52, v4 offset:28160
    s_xor_b32 s90, s71, 6144
    s_add_u32 s90, s90, s77
    buffer_load_dwordx4 v[124:127], v0, s[44:47], s90 offen offset:0 sc1
    s_setprio 0
    v_exp_f32 v64, v64
    v_exp_f32 v65, v65
    v_exp_f32 v66, v66
L_h1page2:
    s_cbranch_execz L_probed1
    v_exp_f32 v67, v67
    s_setprio 1
    v_exp_f32 v68, v68
    v_exp_f32 v69, v69
    v_exp_f32 v70, v70
    v_exp_f32 v71, v71
    v_exp_f32 v72, v72
    v_exp_f32 v73, v73
    v_exp_f32 v74, v74
    v_exp_f32 v75, v75
    v_exp_f32 v76, v76
    v_exp_f32 v77, v77
    v_exp_f32 v78, v78
    v_exp_f32 v79, v79
    s_waitcnt lgkmcnt(2)
    v_smfmac_f32_32x32x32_bf16 v[6:21], v[56:59], v[64:71], v54
    s_setprio 2
    v_and_b32 v254, 0xf0, v0
    v_lshrrev_b32 v255, 5, v22
    v_lshl_add_u32 v254, v255, 3, v254
    buffer_load_dwordx2 v[252:253], v254, s[44:47], s60 offen sc1
    v_smfmac_f32_32x32x32_bf16 v[6:21], v[60:63], v[72:79], v54
    s_mov_b64 exec, s[92:93]
    ds_read_b128 v[56:59], v3 offset:21888
    ds_read_b128 v[60:63], v3 offset:22464
    s_mov_b64 exec, -1
    s_waitcnt lgkmcnt(2)
    v_mfma_f32_32x32x8_bf16 v[64:79], v[52:53], v[44:45], 0
    v_mfma_f32_32x32x16_bf16 v[64:79], v[48:51], v[40:43], v[64:79]
    ds_read_b128 v[48:51], v2 offset:27648
    s_xor_b32 s90, s71, 6144
    s_add_u32 s90, s90, s77
    buffer_load_dwordx4 v[128:131], v0, s[44:47], s90 offen offset:1024 sc1
    s_setprio 0
    v_exp_f32 v80, v80
    v_exp_f32 v81, v81
    v_exp_f32 v82, v82
    v_exp_f32 v83, v83
    s_setprio 1
    v_exp_f32 v84, v84
    v_exp_f32 v85, v85
    v_exp_f32 v86, v86
    v_exp_f32 v87, v87
    v_exp_f32 v88, v88
    v_exp_f32 v89, v89
    v_exp_f32 v90, v90
    v_exp_f32 v91, v91
    v_exp_f32 v92, v92
    v_exp_f32 v93, v93
    v_exp_f32 v94, v94
    v_exp_f32 v95, v95
    s_waitcnt lgkmcnt(1)
    v_smfmac_f32_32x32x32_bf16 v[6:21], v[56:59], v[80:87], v54
    s_setprio 2
    v_smfmac_f32_32x32x32_bf16 v[6:21], v[60:63], v[88:95], v54
    s_mov_b64 exec, s[92:93]
    ds_read_b128 v[56:59], v3 offset:27648
    ds_read_b128 v[60:63], v3 offset:28224
    s_mov_b64 exec, -1
    s_waitcnt lgkmcnt(2)
    v_mfma_f32_32x32x8_bf16 v[80:95], v[52:53], v[46:47], 0
    v_mfma_f32_32x32x16_bf16 v[80:95], v[48:51], v[40:43], v[80:95]
    ds_read_b128 v[48:51], v2 offset:28672
    ds_read_b32 v52, v4 offset:28416
    s_xor_b32 s90, s71, 8192
    s_add_u32 s90, s90, s77
    buffer_load_dwordx4 v[132:135], v0, s[44:47], s90 offen offset:0 sc1
    s_setprio 0
    v_exp_f32 v64, v64
    v_exp_f32 v65, v65
    v_exp_f32 v66, v66
    v_exp_f32 v67, v67
    s_setprio 1
    v_exp_f32 v68, v68
    v_exp_f32 v69, v69
    v_exp_f32 v70, v70
    v_exp_f32 v71, v71
    v_exp_f32 v72, v72
    v_exp_f32 v73, v73
    v_exp_f32 v74, v74
    v_exp_f32 v75, v75
    v_exp_f32 v76, v76
    v_exp_f32 v77, v77
    v_exp_f32 v78, v78
    v_exp_f32 v79, v79
    s_waitcnt lgkmcnt(2)
    v_smfmac_f32_32x32x32_bf16 v[6:21], v[56:59], v[64:71], v54
    s_setprio 2
    buffer_load_dwordx4 v[248:251], v0, s[44:47], s81 offen offset:1024 sc1
    v_smfmac_f32_32x32x32_bf16 v[6:21], v[60:63], v[72:79], v54
    s_mov_b64 exec, s[92:93]
    ds_read_b128 v[56:59], v3 offset:28800
    ds_read_b128 v[60:63], v3 offset:29376
    s_mov_b64 exec, -1
    s_waitcnt lgkmcnt(2)
    v_mfma_f32_32x32x8_bf16 v[64:79], v[52:53], v[44:45], 0
    v_mfma_f32_32x32x16_bf16 v[64:79], v[48:51], v[40:43], v[64:79]
    ds_read_b128 v[48:51], v2 offset:29696
    s_xor_b32 s90, s71, 8192
    s_add_u32 s90, s90, s77
    buffer_load_dwordx4 v[136:139], v0, s[44:47], s90 offen offset:1024 sc1
    s_setprio 0
    v_exp_f32 v80, v80
    v_exp_f32 v81, v81
    v_exp_f32 v82, v82
    v_exp_f32 v83, v83
    s_setprio 1
    v_exp_f32 v84, v84
    v_exp_f32 v85, v85
    v_exp_f32 v86, v86
    v_exp_f32 v87, v87
    v_exp_f32 v88, v88
    v_exp_f32 v89, v89
    v_exp_f32 v90, v90
    v_exp_f32 v91, v91
    v_exp_f32 v92, v92
    v_exp_f32 v93, v93
    v_exp_f32 v94, v94
    v_exp_f32 v95, v95
    s_waitcnt lgkmcnt(1)
    v_smfmac_f32_32x32x32_bf16 v[6:21], v[56:59], v[80:87], v54
    s_setprio 2
    v_smfmac_f32_32x32x32_bf16 v[6:21], v[60:63], v[88:95], v54
    s_mov_b64 exec, s[92:93]
    ds_read_b128 v[56:59], v3 offset:29952
    ds_read_b128 v[60:63], v3 offset:30528
    s_mov_b64 exec, -1
    s_waitcnt lgkmcnt(2)
    v_mfma_f32_32x32x8_bf16 v[80:95], v[52:53], v[46:47], 0
    v_mfma_f32_32x32x16_bf16 v[80:95], v[48:51], v[40:43], v[80:95]
    v_add_u32 v2, 0xffff0000, v2
    ds_read_b128 v[48:51], v2
    v_add_u32 v4, 0xffff0400, v4
    ds_read_b32 v52, v4 offset:512
    s_xor_b32 s90, s71, 10240
    s_add_u32 s90, s90, s77
    buffer_load_dwordx4 v[140:143], v0, s[44:47], s90 offen offset:0 sc1
    s_xor_b32 s90, s71, 10240
    s_add_u32 s90, s90, s77
    buffer_load_dwordx4 v[144:147], v0, s[44:47], s90 offen offset:1024 sc1
    s_setprio 0
    v_exp_f32 v64, v64
    v_exp_f32 v65, v65
    v_exp_f32 v66, v66
    v_exp_f32 v67, v67
    s_setprio 1
    v_exp_f32 v68, v68
    v_exp_f32 v69, v69
    v_exp_f32 v70, v70
    v_exp_f32 v71, v71
    v_exp_f32 v72, v72
    v_exp_f32 v73, v73
    v_exp_f32 v74, v74
    v_exp_f32 v75, v75
    v_exp_f32 v76, v76
    v_exp_f32 v77, v77
    v_exp_f32 v78, v78
    v_exp_f32 v79, v79
    s_waitcnt lgkmcnt(2)
    v_smfmac_f32_32x32x32_bf16 v[6:21], v[56:59], v[64:71], v54
    s_setprio 2
    v_smfmac_f32_32x32x32_bf16 v[6:21], v[60:63], v[72:79], v54
    s_mov_b64 exec, s[92:93]
    ds_read_b128 v[56:59], v3 offset:31104
    ds_read_b128 v[60:63], v3 offset:31680
    s_mov_b64 exec, -1
    s_waitcnt lgkmcnt(2)
    v_mfma_f32_32x32x8_bf16 v[64:79], v[52:53], v[44:45], 0
    v_mfma_f32_32x32x16_bf16 v[64:79], v[48:51], v[40:43], v[64:79]
    ds_read_b128 v[48:51], v2 offset:1024
    s_xor_b32 s90, s71, 12288
    s_add_u32 s90, s90, s77
    buffer_load_dwordx4 v[148:151], v0, s[44:47], s90 offen offset:0 sc1
    s_setprio 0
    v_exp_f32 v80, v80
    v_exp_f32 v81, v81
    v_exp_f32 v82, v82
    v_exp_f32 v83, v83
    s_setprio 1
    v_exp_f32 v84, v84
    v_exp_f32 v85, v85
    v_exp_f32 v86, v86
    v_exp_f32 v87, v87
    v_exp_f32 v88, v88
    v_exp_f32 v89, v89
    v_exp_f32 v90, v90
    v_exp_f32 v91, v91
    v_exp_f32 v92, v92
    v_exp_f32 v93, v93
    v_exp_f32 v94, v94
    v_exp_f32 v95, v95
    s_waitcnt lgkmcnt(1)
    v_smfmac_f32_32x32x32_bf16 v[6:21], v[56:59], v[80:87], v54
    s_setprio 2
    v_smfmac_f32_32x32x32_bf16 v[6:21], v[60:63], v[88:95], v54
    s_mov_b64 exec, s[92:93]
    v_add_u32 v3, 0xffff0400, v3
    ds_read_b128 v[56:59], v3
    ds_read_b128 v[60:63], v3 offset:576
    s_mov_b64 exec, -1
    s_waitcnt lgkmcnt(2)
    v_mfma_f32_32x32x8_bf16 v[80:95], v[52:53], v[46:47], 0
    v_mfma_f32_32x32x16_bf16 v[80:95], v[48:51], v[40:43], v[80:95]
    ds_read_b128 v[48:51], v2 offset:2048
    ds_read_b32 v52, v4 offset:768
    s_xor_b32 s90, s71, 12288
    s_add_u32 s90, s90, s77
    buffer_load_dwordx4 v[152:155], v0, s[44:47], s90 offen offset:1024 sc1
    s_xor_b32 s90, s71, 14336
    s_add_u32 s90, s90, s77
    buffer_load_dwordx4 v[156:159], v0, s[44:47], s90 offen offset:0 sc1
    s_setprio 0
    v_exp_f32 v64, v64
    v_exp_f32 v65, v65
    v_exp_f32 v66, v66
    v_exp_f32 v67, v67
    s_setprio 1
    v_exp_f32 v68, v68
    v_exp_f32 v69, v69
    v_exp_f32 v70, v70
    v_exp_f32 v71, v71
    v_exp_f32 v72, v72
    v_exp_f32 v73, v73
    v_exp_f32 v74, v74
    v_exp_f32 v75, v75
    v_exp_f32 v76, v76
    v_exp_f32 v77, v77
    v_exp_f32 v78, v78
    v_exp_f32 v79, v79
    s_waitcnt lgkmcnt(2)
    v_smfmac_f32_32x32x32_bf16 v[6:21], v[56:59], v[64:71], v54
    s_setprio 2
    v_smfmac_f32_32x32x32_bf16 v[6:21], v[60:63], v[72:79], v54
    s_mov_b64 exec, s[92:93]
    ds_read_b128 v[56:59], v3 offset:1152
    ds_read_b128 v[60:63], v3 offset:1728
    s_mov_b64 exec, -1
    s_waitcnt lgkmcnt(2)
    v_mfma_f32_32x32x8_bf16 v[64:79], v[52:53], v[44:45], 0
    v_mfma_f32_32x32x16_bf16 v[64:79], v[48:51], v[40:43], v[64:79]
    ds_read_b128 v[48:51], v2 offset:3072
    buffer_load_dword v39, v5, s[44:47], 0 offen sc1
    s_setprio 0
    v_exp_f32 v80, v80
    v_exp_f32 v81, v81
    v_exp_f32 v82, v82
    v_exp_f32 v83, v83
    s_setprio 1
    v_exp_f32 v84, v84
    v_exp_f32 v85, v85
    v_exp_f32 v86, v86
    v_exp_f32 v87, v87
    v_exp_f32 v88, v88
    v_exp_f32 v89, v89
    v_exp_f32 v90, v90
    v_exp_f32 v91, v91
    v_exp_f32 v92, v92
    v_exp_f32 v93, v93
    v_exp_f32 v94, v94
    v_exp_f32 v95, v95
    s_waitcnt lgkmcnt(1)
    v_smfmac_f32_32x32x32_bf16 v[6:21], v[56:59], v[80:87], v54
    s_setprio 2
    v_smfmac_f32_32x32x32_bf16 v[6:21], v[60:63], v[88:95], v54
    s_mov_b64 exec, s[92:93]
    ds_read_b128 v[56:59], v3 offset:2304
    ds_read_b128 v[60:63], v3 offset:2880
    s_mov_b64 exec, -1
    s_waitcnt lgkmcnt(2)
    v_mfma_f32_32x32x8_bf16 v[80:95], v[52:53], v[46:47], 0
    v_mfma_f32_32x32x16_bf16 v[80:95], v[48:51], v[40:43], v[80:95]
    v_add_u32 v2, 0x18c00, v2
    ds_read_b128 v[48:51], v2
    v_add_u32 v4, 0x18c00, v4
    ds_read_b32 v52, v4 offset:512
    s_xor_b32 s90, s71, 14336
    s_add_u32 s90, s90, s77
    buffer_load_dwordx4 v[160:163], v0, s[44:47], s90 offen offset:1024 sc1
    s_setprio 0
    v_exp_f32 v64, v64
    v_exp_f32 v65, v65
    v_exp_f32 v66, v66
    v_exp_f32 v67, v67
    s_setprio 1
    v_exp_f32 v68, v68
    v_exp_f32 v69, v69
    v_exp_f32 v70, v70
    v_exp_f32 v71, v71
    v_exp_f32 v72, v72
    v_exp_f32 v73, v73
    v_exp_f32 v74, v74
    v_exp_f32 v75, v75
    v_exp_f32 v76, v76
    v_exp_f32 v77, v77
    v_exp_f32 v78, v78
    v_exp_f32 v79, v79
    s_waitcnt lgkmcnt(2)
    v_smfmac_f32_32x32x32_bf16 v[6:21], v[56:59], v[64:71], v54
    s_setprio 2
    s_cmp_lt_u32 s85, 2
    s_cselect_b32 s89, 5, 9
    s_add_u32 s89, s68, s89
    s_waitcnt vmcnt(1)
    v_subrev_u32 v39, s89, v39
    v_cmp_lt_u32 vcc, 8, v39
    s_nop 0
    s_cmp_lg_u32 vcc_lo, 0
    s_cbranch_scc1 L_far_57
L_back_58:
    v_smfmac_f32_32x32x32_bf16 v[6:21], v[60:63], v[72:79], v54
    s_mov_b64 exec, s[92:93]
    ds_read_b128 v[56:59], v3 offset:3456
    ds_read_b128 v[60:63], v3 offset:4032
    s_mov_b64 exec, -1
    s_waitcnt lgkmcnt(2)
    v_mfma_f32_32x32x8_bf16 v[64:79], v[52:53], v[44:45], 0
    v_mfma_f32_32x32x16_bf16 v[64:79], v[48:51], v[40:43], v[64:79]
    ds_read_b128 v[48:51], v2 offset:1024
    buffer_load_dwordx4 v[236:239], v0, s[44:47], s70 offen sc1
    s_setprio 0
    v_exp_f32 v80, v80
    v_exp_f32 v81, v81
    v_exp_f32 v82, v82
    v_exp_f32 v83, v83
    s_setprio 1
    v_exp_f32 v84, v84
    v_exp_f32 v85, v85
    v_exp_f32 v86, v86
    v_exp_f32 v87, v87
    v_exp_f32 v88, v88
    v_exp_f32 v89, v89
    v_exp_f32 v90, v90
    v_exp_f32 v91, v91
    v_exp_f32 v92, v92
    v_exp_f32 v93, v93
    v_exp_f32 v94, v94
    v_exp_f32 v95, v95
    s_waitcnt lgkmcnt(1)
    v_smfmac_f32_32x32x32_bf16 v[6:21], v[56:59], v[80:87], v54
    s_setprio 2
    v_smfmac_f32_32x32x32_bf16 v[6:21], v[60:63], v[88:95], v54
    s_mov_b64 exec, s[92:93]
    v_add_u32 v3, 0x18c00, v3
    ds_read_b128 v[56:59], v3
    ds_read_b128 v[60:63], v3 offset:576
    s_mov_b64 exec, -1
    s_waitcnt lgkmcnt(2)
    v_mfma_f32_32x32x8_bf16 v[80:95], v[52:53], v[46:47], 0
    v_mfma_f32_32x32x16_bf16 v[80:95], v[48:51], v[40:43], v[80:95]
    ds_read_b128 v[48:51], v2 offset:2048
    ds_read_b32 v52, v4 offset:768
    buffer_load_dwordx4 v[240:243], v0, s[44:47], s70 offen offset:1024 sc1
    s_setprio 0
    v_exp_f32 v64, v64
    v_exp_f32 v65, v65
    v_exp_f32 v66, v66
    v_exp_f32 v67, v67
    s_setprio 1
    v_exp_f32 v68, v68
    v_exp_f32 v69, v69
    v_exp_f32 v70, v70
    v_exp_f32 v71, v71
    v_exp_f32 v72, v72
    v_exp_f32 v73, v73
    v_exp_f32 v74, v74
    v_exp_f32 v75, v75
    v_exp_f32 v76, v76
    v_exp_f32 v77, v77
    v_exp_f32 v78, v78
    v_exp_f32 v79, v79
    s_waitcnt lgkmcnt(2)
    v_smfmac_f32_32x32x32_bf16 v[6:21], v[56:59], v[64:71], v54
    s_setprio 2
    v_smfmac_f32_32x32x32_bf16 v[6:21], v[60:63], v[72:79], v54
    s_mov_b64 exec, s[92:93]
    ds_read_b128 v[56:59], v3 offset:1152
    ds_read_b128 v[60:63], v3 offset:1728
    s_mov_b64 exec, -1
    s_waitcnt lgkmcnt(2)
    v_mfma_f32_32x32x8_bf16 v[64:79], v[52:53], v[44:45], 0
    v_mfma_f32_32x32x16_bf16 v[64:79], v[48:51], v[40:43], v[64:79]
    ds_read_b128 v[48:51], v2 offset:3072
    s_xor_b32 s90, s71, 0
    s_add_u32 s90, s90, s80
    buffer_load_dwordx4 v[172:175], v0, s[44:47], s90 offen offset:0 sc1
    s_setprio 0
    v_exp_f32 v80, v80
    v_exp_f32 v81, v81
    v_exp_f32 v82, v82
    v_exp_f32 v83, v83
    s_setprio 1
    v_exp_f32 v84, v84
    v_exp_f32 v85, v85
    v_exp_f32 v86, v86
    v_exp_f32 v87, v87
    v_exp_f32 v88, v88
    v_exp_f32 v89, v89
    v_exp_f32 v90, v90
    v_exp_f32 v91, v91
    v_exp_f32 v92, v92
    v_exp_f32 v93, v93
    v_exp_f32 v94, v94
    v_exp_f32 v95, v95
    s_waitcnt lgkmcnt(1)
    v_smfmac_f32_32x32x32_bf16 v[6:21], v[56:59], v[80:87], v54
    s_setprio 2
    v_smfmac_f32_32x32x32_bf16 v[6:21], v[60:63], v[88:95], v54
    s_mov_b64 exec, s[92:93]
    ds_read_b128 v[56:59], v3 offset:2304
    ds_read_b128 v[60:63], v3 offset:2880
    s_mov_b64 exec, -1
    s_waitcnt lgkmcnt(2)
    v_mfma_f32_32x32x8_bf16 v[80:95], v[52:53], v[46:47], 0
    v_mfma_f32_32x32x16_bf16 v[80:95], v[48:51], v[40:43], v[80:95]
    ds_read_b128 v[48:51], v2 offset:9216
    ds_read_b32 v52, v4 offset:9728
    s_xor_b32 s90, s71, 0
    s_add_u32 s90, s90, s80
    buffer_load_dwordx4 v[176:179], v0, s[44:47], s90 offen offset:1024 sc1
    s_setprio 0
    v_exp_f32 v64, v64
    v_exp_f32 v65, v65
    v_exp_f32 v66, v66
    v_exp_f32 v67, v67
    s_setprio 1
    v_exp_f32 v68, v68
    v_exp_f32 v69, v69
    v_exp_f32 v70, v70
    v_exp_f32 v71, v71
    v_exp_f32 v72, v72
    v_exp_f32 v73, v73
    v_exp_f32 v74, v74
    v_exp_f32 v75, v75
    v_exp_f32 v76, v76
    v_exp_f32 v77, v77
    v_exp_f32 v78, v78
    v_exp_f32 v79, v79
    s_waitcnt lgkmcnt(2)
    v_smfmac_f32_32x32x32_bf16 v[6:21], v[56:59], v[64:71], v54
    s_setprio 2
    v_smfmac_f32_32x32x32_bf16 v[6:21], v[60:63], v[72:79], v54
    s_mov_b64 exec, s[92:93]
    ds_read_b128 v[56:59], v3 offset:3456
    ds_read_b128 v[60:63], v3 offset:4032
    s_mov_b64 exec, -1
    s_waitcnt lgkmcnt(2)
    v_mfma_f32_32x32x8_bf16 v[64:79], v[52:53], v[44:45], 0
    v_mfma_f32_32x32x16_bf16 v[64:79], v[48:51], v[40:43], v[64:79]
    ds_read_b128 v[48:51], v2 offset:10240
    s_xor_b32 s90, s71, 2048
    s_add_u32 s90, s90, s80
    buffer_load_dwordx4 v[180:183], v0, s[44:47], s90 offen offset:0 sc1
    s_setprio 0
    v_exp_f32 v80, v80
    v_exp_f32 v81, v81
    v_exp_f32 v82, v82
    v_exp_f32 v83, v83
    s_setprio 1
    v_exp_f32 v84, v84
    v_exp_f32 v85, v85
    v_exp_f32 v86, v86
    v_exp_f32 v87, v87
    v_exp_f32 v88, v88
    v_exp_f32 v89, v89
    v_exp_f32 v90, v90
    v_exp_f32 v91, v91
    v_exp_f32 v92, v92
    v_exp_f32 v93, v93
    v_exp_f32 v94, v94
    v_exp_f32 v95, v95
    s_waitcnt lgkmcnt(1)
    v_smfmac_f32_32x32x32_bf16 v[6:21], v[56:59], v[80:87], v54
    s_setprio 2
    v_smfmac_f32_32x32x32_bf16 v[6:21], v[60:63], v[88:95], v54
    s_mov_b64 exec, s[92:93]
    ds_read_b128 v[56:59], v3 offset:9216
    ds_read_b128 v[60:63], v3 offset:9792
    s_mov_b64 exec, -1
    s_waitcnt lgkmcnt(2)
    v_mfma_f32_32x32x8_bf16 v[80:95], v[52:53], v[46:47], 0
    v_mfma_f32_32x32x16_bf16 v[80:95], v[48:51], v[40:43], v[80:95]
    ds_read_b128 v[48:51], v2 offset:11264
    ds_read_b32 v52, v4 offset:9984
    s_xor_b32 s90, s71, 2048
    s_add_u32 s90, s90, s80
    buffer_load_dwordx4 v[184:187], v0, s[44:47], s90 offen offset:1024 sc1
    s_setprio 0
    v_exp_f32 v64, v64
    v_exp_f32 v65, v65
    v_exp_f32 v66, v66
    v_exp_f32 v67, v67
    s_setprio 1
    v_exp_f32 v68, v68
    v_exp_f32 v69, v69
    v_exp_f32 v70, v70
    v_exp_f32 v71, v71
    v_exp_f32 v72, v72
    v_exp_f32 v73, v73
    v_exp_f32 v74, v74
    v_exp_f32 v75, v75
    v_exp_f32 v76, v76
    v_exp_f32 v77, v77
    v_exp_f32 v78, v78
    v_exp_f32 v79, v79
    s_waitcnt lgkmcnt(2)
    v_smfmac_f32_32x32x32_bf16 v[6:21], v[56:59], v[64:71], v54
    s_setprio 2
    v_smfmac_f32_32x32x32_bf16 v[6:21], v[60:63], v[72:79], v54
    s_mov_b64 exec, s[92:93]
    ds_read_b128 v[56:59], v3 offset:10368
    ds_read_b128 v[60:63], v3 offset:10944
    s_mov_b64 exec, -1
    s_waitcnt lgkmcnt(2)
    v_mfma_f32_32x32x8_bf16 v[64:79], v[52:53], v[44:45], 0
    v_mfma_f32_32x32x16_bf16 v[64:79], v[48:51], v[40:43], v[64:79]
    ds_read_b128 v[48:51], v2 offset:12288
    s_xor_b32 s90, s71, 4096
    s_add_u32 s90, s90, s80
    buffer_load_dwordx4 v[188:191], v0, s[44:47], s90 offen offset:0 sc1
    s_setprio 0
    v_exp_f32 v80, v80
    v_exp_f32 v81, v81
    v_exp_f32 v82, v82
    v_exp_f32 v83, v83
    s_setprio 1
    v_exp_f32 v84, v84
    v_exp_f32 v85, v85
    v_exp_f32 v86, v86
    v_exp_f32 v87, v87
    v_exp_f32 v88, v88
    v_exp_f32 v89, v89
    v_exp_f32 v90, v90
    v_exp_f32 v91, v91
    v_exp_f32 v92, v92
    v_exp_f32 v93, v93
    v_exp_f32 v94, v94
    v_exp_f32 v95, v95
    s_waitcnt lgkmcnt(1)
    v_smfmac_f32_32x32x32_bf16 v[6:21], v[56:59], v[80:87], v54
    s_setprio 2
    v_smfmac_f32_32x32x32_bf16 v[6:21], v[60:63], v[88:95], v54
    s_mov_b64 exec, s[92:93]
    ds_read_b128 v[56:59], v3 offset:11520
    ds_read_b128 v[60:63], v3 offset:12096
    s_mov_b64 exec, -1
    s_waitcnt lgkmcnt(2)
    v_mfma_f32_32x32x8_bf16 v[80:95], v[52:53], v[46:47], 0
    v_mfma_f32_32x32x16_bf16 v[80:95], v[48:51], v[40:43], v[80:95]
    ds_read_b128 v[48:51], v2 offset:18432
    ds_read_b32 v52, v4 offset:18944
    s_xor_b32 s90, s71, 4096
    s_add_u32 s90, s90, s80
    buffer_load_dwordx4 v[192:195], v0, s[44:47], s90 offen offset:1024 sc1
    s_setprio 0
    v_exp_f32 v64, v64
    v_exp_f32 v65, v65
    v_exp_f32 v66, v66
    v_exp_f32 v67, v67
    s_setprio 1
    v_exp_f32 v68, v68
    v_exp_f32 v69, v69
    v_exp_f32 v70, v70
    v_exp_f32 v71, v71
    v_exp_f32 v72, v72
    v_exp_f32 v73, v73
    v_exp_f32 v74, v74
    v_exp_f32 v75, v75
    v_exp_f32 v76, v76
    v_exp_f32 v77, v77
    v_exp_f32 v78, v78
    v_exp_f32 v79, v79
    s_waitcnt lgkmcnt(2)
    v_smfmac_f32_32x32x32_bf16 v[6:21], v[56:59], v[64:71], v54
    s_setprio 2
    v_smfmac_f32_32x32x32_bf16 v[6:21], v[60:63], v[72:79], v54
    s_mov_b64 exec, s[92:93]
    ds_read_b128 v[56:59], v3 offset:12672
    ds_read_b128 v[60:63], v3 offset:13248
    s_mov_b64 exec, -1
    s_waitcnt lgkmcnt(2)
    v_mfma_f32_32x32x8_bf16 v[64:79], v[52:53], v[44:45], 0
    v_mfma_f32_32x32x16_bf16 v[64:79], v[48:51], v[40:43], v[64:79]
    ds_read_b128 v[48:51], v2 offset:19456
    s_xor_b32 s90, s71, 6144
    s_add_u32 s90, s90, s80
    buffer_load_dwordx4 v[196:199], v0, s[44:47], s90 offen offset:0 sc1
    s_setprio 0
    v_exp_f32 v80, v80
    v_exp_f32 v81, v81
    v_exp_f32 v82, v82
    v_exp_f32 v83, v83
    s_setprio 1
    v_exp_f32 v84, v84
    v_exp_f32 v85, v85
    v_exp_f32 v86, v86
    v_exp_f32 v87, v87
    v_exp_f32 v88, v88
    v_exp_f32 v89, v89
    v_exp_f32 v90, v90
    v_exp_f32 v91, v91
    v_exp_f32 v92, v92
    v_exp_f32 v93, v93
    v_exp_f32 v94, v94
    v_exp_f32 v95, v95
    s_waitcnt lgkmcnt(1)
    v_smfmac_f32_32x32x32_bf16 v[6:21], v[56:59], v[80:87], v54
    s_setprio 2
    v_smfmac_f32_32x32x32_bf16 v[6:21], v[60:63], v[88:95], v54
    s_mov_b64 exec, s[92:93]
    ds_read_b128 v[56:59], v3 offset:18432
    ds_read_b128 v[60:63], v3 offset:19008
    s_mov_b64 exec, -1
    s_waitcnt lgkmcnt(2)
    v_mfma_f32_32x32x8_bf16 v[80:95], v[52:53], v[46:47], 0
    v_mfma_f32_32x32x16_bf16 v[80:95], v[48:51], v[40:43], v[80:95]
    ds_read_b128 v[48:51], v2 offset:20480
    ds_read_b32 v52, v4 offset:19200
    s_xor_b32 s90, s71, 6144
    s_add_u32 s90, s90, s80
    buffer_load_dwordx4 v[200:203], v0, s[44:47], s90 offen offset:1024 sc1
    s_setprio 0
    v_exp_f32 v64, v64
    v_exp_f32 v65, v65
    v_exp_f32 v66, v66
    v_exp_f32 v67, v67
    s_setprio 1
    v_exp_f32 v68, v68
    v_exp_f32 v69, v69
    v_exp_f32 v70, v70
    v_exp_f32 v71, v71
    v_exp_f32 v72, v72
    v_exp_f32 v73, v73
    v_exp_f32 v74, v74
    v_exp_f32 v75, v75
    v_exp_f32 v76, v76
    v_exp_f32 v77, v77
    v_exp_f32 v78, v78
    v_exp_f32 v79, v79
    s_waitcnt lgkmcnt(2)
    v_smfmac_f32_32x32x32_bf16 v[6:21], v[56:59], v[64:71], v54
    s_setprio 2
    v_smfmac_f32_32x32x32_bf16 v[6:21], v[60:63], v[72:79], v54
    s_mov_b64 exec, s[92:93]
    ds_read_b128 v[56:59], v3 offset:19584
    ds_read_b128 v[60:63], v3 offset:20160
    s_mov_b64 exec, -1
    s_waitcnt lgkmcnt(2)
    v_mfma_f32_32x32x8_bf16 v[64:79], v[52:53], v[44:45], 0
    v_mfma_f32_32x32x16_bf16 v[64:79], v[48:51], v[40:43], v[64:79]
    ds_read_b128 v[48:51], v2 offset:21504
    s_xor_b32 s90, s71, 8192
    s_add_u32 s90, s90, s80
    buffer_load_dwordx4 v[204:207], v0, s[44:47], s90 offen offset:0 sc1
    s_setprio 0
    v_exp_f32 v80, v80
    v_exp_f32 v81, v81
    v_exp_f32 v82, v82
    v_exp_f32 v83, v83
    s_setprio 1
    v_exp_f32 v84, v84
    v_exp_f32 v85, v85
    v_exp_f32 v86, v86
    v_exp_f32 v87, v87
    v_exp_f32 v88, v88
    v_exp_f32 v89, v89
    v_exp_f32 v90, v90
    v_exp_f32 v91, v91
    v_exp_f32 v92, v92
    v_exp_f32 v93, v93
    v_exp_f32 v94, v94
    v_exp_f32 v95, v95
    s_waitcnt lgkmcnt(1)
    v_smfmac_f32_32x32x32_bf16 v[6:21], v[56:59], v[80:87], v54
    s_setprio 2
    v_smfmac_f32_32x32x32_bf16 v[6:21], v[60:63], v[88:95], v54
    s_mov_b64 exec, s[92:93]
    ds_read_b128 v[56:59], v3 offset:20736
    ds_read_b128 v[60:63], v3 offset:21312
    s_mov_b64 exec, -1
    s_waitcnt lgkmcnt(2)
    v_mfma_f32_32x32x8_bf16 v[80:95], v[52:53], v[46:47], 0
    v_mfma_f32_32x32x16_bf16 v[80:95], v[48:51], v[40:43], v[80:95]
    ds_read_b128 v[48:51], v2 offset:27648
    ds_read_b32 v52, v4 offset:28160
    s_xor_b32 s90, s71, 8192
    s_add_u32 s90, s90, s80
    buffer_load_dwordx4 v[208:211], v0, s[44:47], s90 offen offset:1024 sc1
    s_setprio 0
    v_exp_f32 v64, v64
    v_exp_f32 v65, v65
    v_exp_f32 v66, v66
    v_exp_f32 v67, v67
    s_setprio 1
    v_exp_f32 v68, v68
    v_exp_f32 v69, v69
    v_exp_f32 v70, v70
    v_exp_f32 v71, v71
    v_exp_f32 v72, v72
    v_exp_f32 v73, v73
    v_exp_f32 v74, v74
    v_exp_f32 v75, v75
    v_exp_f32 v76, v76
    v_exp_f32 v77, v77
    v_exp_f32 v78, v78
    v_exp_f32 v79, v79
    s_waitcnt lgkmcnt(2)
    v_smfmac_f32_32x32x32_bf16 v[6:21], v[56:59], v[64:71], v54
    s_setprio 2
    v_smfmac_f32_32x32x32_bf16 v[6:21], v[60:63], v[72:79], v54
    s_mov_b64 exec, s[92:93]
    ds_read_b128 v[56:59], v3 offset:21888
    ds_read_b128 v[60:63], v3 offset:22464
    s_mov_b64 exec, -1
    s_waitcnt lgkmcnt(2)
    v_mfma_f32_32x32x8_bf16 v[64:79], v[52:53], v[44:45], 0
    v_mfma_f32_32x32x16_bf16 v[64:79], v[48:51], v[40:43], v[64:79]
    ds_read_b128 v[48:51], v2 offset:28672
    s_xor_b32 s90, s71, 10240
    s_add_u32 s90, s90, s80
    buffer_load_dwordx4 v[212:215], v0, s[44:47], s90 offen offset:0 sc1
    s_setprio 0
    v_exp_f32 v80, v80
    v_exp_f32 v81, v81
    v_exp_f32 v82, v82
    v_exp_f32 v83, v83
    s_setprio 1
    v_exp_f32 v84, v84
    v_exp_f32 v85, v85
    v_exp_f32 v86, v86
    v_exp_f32 v87, v87
    v_exp_f32 v88, v88
    v_exp_f32 v89, v89
    v_exp_f32 v90, v90
    v_exp_f32 v91, v91
    v_exp_f32 v92, v92
    v_exp_f32 v93, v93
    v_exp_f32 v94, v94
    v_exp_f32 v95, v95
    s_waitcnt lgkmcnt(1)
    v_smfmac_f32_32x32x32_bf16 v[6:21], v[56:59], v[80:87], v54
    s_setprio 2
    v_smfmac_f32_32x32x32_bf16 v[6:21], v[60:63], v[88:95], v54
    s_mov_b64 exec, s[92:93]
    ds_read_b128 v[56:59], v3 offset:27648
    ds_read_b128 v[60:63], v3 offset:28224
    s_mov_b64 exec, -1
    s_waitcnt lgkmcnt(2)
    v_mfma_f32_32x32x8_bf16 v[80:95], v[52:53], v[46:47], 0
    v_mfma_f32_32x32x16_bf16 v[80:95], v[48:51], v[40:43], v[80:95]
    ds_read_b128 v[48:51], v2 offset:29696
    ds_read_b32 v52, v4 offset:28416
    s_xor_b32 s90, s71, 10240
    s_add_u32 s90, s90, s80
    buffer_load_dwordx4 v[216:219], v0, s[44:47], s90 offen offset:1024 sc1
    s_setprio 0
    v_exp_f32 v64, v64
    v_exp_f32 v65, v65
    v_exp_f32 v66, v66
    v_exp_f32 v67, v67
    s_setprio 1
    v_exp_f32 v68, v68
    v_exp_f32 v69, v69
    v_exp_f32 v70, v70
    v_exp_f32 v71, v71
    v_exp_f32 v72, v72
    v_exp_f32 v73, v73
    v_exp_f32 v74, v74
    v_exp_f32 v75, v75
    v_exp_f32 v76, v76
    v_exp_f32 v77, v77
    v_exp_f32 v78, v78
    v_exp_f32 v79, v79
    s_waitcnt lgkmcnt(2)
    v_smfmac_f32_32x32x32_bf16 v[6:21], v[56:59], v[64:71], v54
    s_setprio 2
    v_smfmac_f32_32x32x32_bf16 v[6:21], v[60:63], v[72:79], v54
    s_mov_b64 exec, s[92:93]
    ds_read_b128 v[56:59], v3 offset:28800
    ds_read_b128 v[60:63], v3 offset:29376
    s_mov_b64 exec, -1
    s_waitcnt lgkmcnt(2)
    v_mfma_f32_32x32x8_bf16 v[64:79], v[52:53], v[44:45], 0
    v_mfma_f32_32x32x16_bf16 v[64:79], v[48:51], v[40:43], v[64:79]
    ds_read_b128 v[48:51], v2 offset:30720
    s_xor_b32 s90, s71, 12288
    s_add_u32 s90, s90, s80
    buffer_load_dwordx4 v[220:223], v0, s[44:47], s90 offen offset:0 sc1
    s_setprio 0
    v_exp_f32 v80, v80
    v_exp_f32 v81, v81
    v_exp_f32 v82, v82
    v_exp_f32 v83, v83
    s_setprio 1
    v_exp_f32 v84, v84
    v_exp_f32 v85, v85
    v_exp_f32 v86, v86
    v_exp_f32 v87, v87
L_h0page3:
    s_cbranch_execz L_probed0
    v_exp_f32 v88, v88
    v_exp_f32 v89, v89
    v_exp_f32 v90, v90
    v_exp_f32 v91, v91
    v_exp_f32 v92, v92
    v_exp_f32 v93, v93
    v_exp_f32 v94, v94
    v_exp_f32 v95, v95
    s_waitcnt lgkmcnt(1)
    v_smfmac_f32_32x32x32_bf16 v[6:21], v[56:59], v[80:87], v54
    s_setprio 2
    v_smfmac_f32_32x32x32_bf16 v[6:21], v[60:63], v[88:95], v54
    s_mov_b64 exec, s[92:93]
    ds_read_b128 v[56:59], v3 offset:29952
    ds_read_b128 v[60:63], v3 offset:30528
    s_mov_b64 exec, -1
    s_waitcnt lgkmcnt(2)
    v_mfma_f32_32x32x8_bf16 v[80:95], v[52:53], v[46:47], 0
    v_mfma_f32_32x32x16_bf16 v[80:95], v[48:51], v[40:43], v[80:95]
    ds_read_b128 v[48:51], v2 offset:36864
    ds_read_b32 v52, v4 offset:37376
    s_xor_b32 s90, s71, 12288
    s_add_u32 s90, s90, s80
    buffer_load_dwordx4 v[224:227], v0, s[44:47], s90 offen offset:1024 sc1
    s_setprio 0
    v_exp_f32 v64, v64
    v_exp_f32 v65, v65
    v_exp_f32 v66, v66
    v_exp_f32 v67, v67
    s_setprio 1
    v_exp_f32 v68, v68
    v_exp_f32 v69, v69
    v_exp_f32 v70, v70
    v_exp_f32 v71, v71
    v_exp_f32 v72, v72
    v_exp_f32 v73, v73
    v_exp_f32 v74, v74
    v_exp_f32 v75, v75
    v_exp_f32 v76, v76
    v_exp_f32 v77, v77
    v_exp_f32 v78, v78
    v_exp_f32 v79, v79
    s_waitcnt lgkmcnt(2)
    v_smfmac_f32_32x32x32_bf16 v[6:21], v[56:59], v[64:71], v54
    s_setprio 2
    v_smfmac_f32_32x32x32_bf16 v[6:21], v[60:63], v[72:79], v54
    s_mov_b64 exec, s[92:93]
    ds_read_b128 v[56:59], v3 offset:31104
    ds_read_b128 v[60:63], v3 offset:31680
    s_mov_b64 exec, -1
    s_waitcnt lgkmcnt(2)
    v_mfma_f32_32x32x8_bf16 v[64:79], v[52:53], v[44:45], 0
    v_mfma_f32_32x32x16_bf16 v[64:79], v[48:51], v[40:43], v[64:79]
    ds_read_b128 v[48:51], v2 offset:37888
    s_xor_b32 s90, s71, 14336
    s_add_u32 s90, s90, s80
    buffer_load_dwordx4 v[228:231], v0, s[44:47], s90 offen offset:0 sc1
    s_setprio 0
    v_exp_f32 v80, v80
    v_exp_f32 v81, v81
    v_exp_f32 v82, v82
    v_exp_f32 v83, v83
    s_setprio 1
    v_exp_f32 v84, v84
    v_exp_f32 v85, v85
    v_exp_f32 v86, v86
    v_exp_f32 v87, v87
    v_exp_f32 v88, v88
    v_exp_f32 v89, v89
    v_exp_f32 v90, v90
    v_exp_f32 v91, v91
    v_exp_f32 v92, v92
    v_exp_f32 v93, v93
    v_exp_f32 v94, v94
    v_exp_f32 v95, v95
    s_waitcnt lgkmcnt(1)
    v_smfmac_f32_32x32x32_bf16 v[6:21], v[56:59], v[80:87], v54
    s_setprio 2
    v_smfmac_f32_32x32x32_bf16 v[6:21], v[60:63], v[88:95], v54
    s_mov_b64 exec, s[92:93]
    ds_read_b128 v[56:59], v3 offset:36864
    ds_read_b128 v[60:63], v3 offset:37440
    s_mov_b64 exec, -1
    s_waitcnt lgkmcnt(2)
    v_mfma_f32_32x32x8_bf16 v[80:95], v[52:53], v[46:47], 0
    v_mfma_f32_32x32x16_bf16 v[80:95], v[48:51], v[40:43], v[80:95]
    ds_read_b128 v[48:51], v2 offset:38912
    ds_read_b32 v52, v4 offset:37632
    buffer_load_dwordx4 v[244:247], v0, s[44:47], s81 offen sc1
    s_setprio 0
    v_exp_f32 v64, v64
    v_exp_f32 v65, v65
    v_exp_f32 v66, v66
    v_exp_f32 v67, v67
    s_setprio 1
    v_exp_f32 v68, v68
    v_exp_f32 v69, v69
    v_exp_f32 v70, v70
    v_exp_f32 v71, v71
    v_exp_f32 v72, v72
    v_exp_f32 v73, v73
    v_exp_f32 v74, v74
    v_exp_f32 v75, v75
    v_exp_f32 v76, v76
    v_exp_f32 v77, v77
    v_exp_f32 v78, v78
    v_exp_f32 v79, v79
    s_waitcnt lgkmcnt(2)
    v_smfmac_f32_32x32x32_bf16 v[6:21], v[56:59], v[64:71], v54
    s_setprio 2
    v_smfmac_f32_32x32x32_bf16 v[6:21], v[60:63], v[72:79], v54
    s_mov_b64 exec, s[92:93]
    ds_read_b128 v[56:59], v3 offset:38016
    ds_read_b128 v[60:63], v3 offset:38592
    s_mov_b64 exec, -1
    s_waitcnt lgkmcnt(2)
    v_mfma_f32_32x32x8_bf16 v[64:79], v[52:53], v[44:45], 0
    v_mfma_f32_32x32x16_bf16 v[64:79], v[48:51], v[40:43], v[64:79]
    ds_read_b128 v[48:51], v2 offset:39936
    s_xor_b32 s90, s71, 14336
    s_add_u32 s90, s90, s80
    buffer_load_dwordx4 v[232:235], v0, s[44:47], s90 offen offset:1024 sc1
    s_setprio 0
    v_exp_f32 v80, v80
    v_exp_f32 v81, v81
    v_exp_f32 v82, v82
    v_exp_f32 v83, v83
    s_setprio 1
    v_exp_f32 v84, v84
    v_exp_f32 v85, v85
    v_exp_f32 v86, v86
    v_exp_f32 v87, v87
    v_exp_f32 v88, v88
    v_exp_f32 v89, v89
    v_exp_f32 v90, v90
    v_exp_f32 v91, v91
    v_exp_f32 v92, v92
    v_exp_f32 v93, v93
    v_exp_f32 v94, v94
    v_exp_f32 v95, v95
    s_waitcnt lgkmcnt(1)
    v_smfmac_f32_32x32x32_bf16 v[6:21], v[56:59], v[80:87], v54
    s_setprio 2
    v_smfmac_f32_32x32x32_bf16 v[6:21], v[60:63], v[88:95], v54
    s_mov_b64 exec, s[92:93]
    ds_read_b128 v[56:59], v3 offset:39168
    ds_read_b128 v[60:63], v3 offset:39744
    s_mov_b64 exec, -1
    s_waitcnt lgkmcnt(2)
    v_mfma_f32_32x32x8_bf16 v[80:95], v[52:53], v[46:47], 0
    v_mfma_f32_32x32x16_bf16 v[80:95], v[48:51], v[40:43], v[80:95]
    s_setprio 0
    v_exp_f32 v64, v64
    v_exp_f32 v65, v65
    v_exp_f32 v66, v66
    v_exp_f32 v67, v67
    s_setprio 1
    v_exp_f32 v68, v68
    v_exp_f32 v69, v69
    v_exp_f32 v70, v70
    v_exp_f32 v71, v71
    v_exp_f32 v72, v72
    v_exp_f32 v73, v73
    v_exp_f32 v74, v74
    v_exp_f32 v75, v75
    v_exp_f32 v76, v76
    v_exp_f32 v77, v77
    v_exp_f32 v78, v78
    v_exp_f32 v79, v79
    s_waitcnt lgkmcnt(0)
    v_smfmac_f32_32x32x32_bf16 v[6:21], v[56:59], v[64:71], v54
    s_setprio 2
    v_smfmac_f32_32x32x32_bf16 v[6:21], v[60:63], v[72:79], v54
    s_mov_b64 exec, s[92:93]
    ds_read_b128 v[56:59], v3 offset:40320
    ds_read_b128 v[60:63], v3 offset:40896
    s_mov_b64 exec, -1
    s_setprio 0
    v_exp_f32 v80, v80
    v_exp_f32 v81, v81
    v_exp_f32 v82, v82
    v_exp_f32 v83, v83
    s_setprio 1
    v_exp_f32 v84, v84
    v_exp_f32 v85, v85
    v_exp_f32 v86, v86
    v_exp_f32 v87, v87
    v_exp_f32 v88, v88
    v_exp_f32 v89, v89
    v_exp_f32 v90, v90
    v_exp_f32 v91, v91
    v_exp_f32 v92, v92
    v_exp_f32 v93, v93
    v_exp_f32 v94, v94
    v_exp_f32 v95, v95
    s_waitcnt lgkmcnt(0)
    v_smfmac_f32_32x32x32_bf16 v[6:21], v[56:59], v[80:87], v54
    s_setprio 2
    v_smfmac_f32_32x32x32_bf16 v[6:21], v[60:63], v[88:95], v54
L_att_done:
L_h0page4:
    s_cbranch_execz L_probed0
    v_and_b32 v34, 15, v22
    v_lshrrev_b32 v35, 4, v22
    v_lshlrev_b32 v36, 3, v34
    v_lshl_add_u32 v36, v35, 2, v36
    s_lshr_b32 s88, s76, 2
    s_lshl2_add_u32 s88, s75, s88
    s_mul_i32 s88, s88, 36864
    s_add_u32 s88, s88, 0x100000
    s_lshl_b32 s89, s72, 9
    s_lshl3_add_u32 s90, s89, s88
    s_add_u32 s91, s89, s88
    s_add_u32 s91, s91, 32768
    v_rcp_f32 v16, v16
    s_nop 0
    v_mul_f32 v6, v6, v16
    v_mul_f32 v7, v7, v16
    v_mul_f32 v8, v8, v16
    v_mul_f32 v9, v9, v16
    v_mul_f32 v10, v10, v16
    v_mul_f32 v11, v11, v16
    v_mul_f32 v12, v12, v16
    v_mul_f32 v13, v13, v16
    v_cvt_pk_bf16_f32 v18, v6, v7
    v_cvt_pk_bf16_f32 v19, v8, v9
    v_cvt_pk_bf16_f32 v20, v10, v11
    v_cvt_pk_bf16_f32 v21, v12, v13
    buffer_store_dwordx4 v[18:21], v0, s[44:47], s87 offen sc1
    v_mul_f32 v14, v14, v16
    v_mul_f32 v15, v15, v16
    v_cvt_pk_bf16_f32 v17, v14, v15
    s_mov_b32 exec_hi, 0
    buffer_store_dword v17, v36, s[44:47], s34 offen sc1
    s_mov_b64 exec, -1
    s_setprio 0
    s_lshl_b32 s88, s85, 5
    s_add_u32 s88, s88, 160768
    v_lshl_add_u32 v37, v35, 3, s88
    s_lshl3_add_u32 s89, s85, s72
    s_lshl_b32 s89, s89, 5
    s_add_u32 s89, s89, 159744
    v_lshl_add_u32 v36, v35, 3, s89
    s_lshr_b32 s89, s76, 2
    s_lshl_b32 s89, s89, 7
    s_add_u32 s89, s89, 158848
    v_lshl_add_u32 v4, v34, 2, s89
    ds_read_b64 v[96:97], v36
    ds_read_b64 v[98:99], v37
    ds_read2_b32 v[2:3], v4 offset0:0 offset1:16
    v_lshrrev_b32 v36, 2, v34
    v_and_b32 v37, 1, v35
    v_lshlrev_b32 v37, 1, v37
    v_cmp_eq_u32 vcc, v36, v37
    v_mov_b32 v4, 0x3f80
    v_add_u32 v37, 1, v37
    v_cndmask_b32 v24, 0, v4, vcc
    v_cndmask_b32 v29, 0, v4, vcc
    v_cmp_eq_u32 vcc, v36, v37
    v_and_b32 v36, 3, v34
    v_mul_u32_u24 v32, 0x5555, v36
    v_cndmask_b32 v26, 0, v4, vcc
    v_cndmask_b32 v31, 0, v4, vcc
    v_cmp_eq_u32 vcc, 1, v37
    v_mov_b32 v25, 0
    v_mov_b32 v27, 0
    v_mov_b32 v28, 0
    v_mov_b32 v30, 0
    v_lshlrev_b32 v4, 3, v22
    s_cmp_eq_u32 s72, 0
    s_cselect_b32 s88, -1, 0
    s_barrier
    s_cmp_lt_u32 s85, 2
    s_cbranch_scc0 L_fin2
    s_waitcnt lgkmcnt(2)
    v_lshlrev_b32 v64, 16, v96
    v_and_b32 v65, 0xffff0000, v96
    v_lshlrev_b32 v66, 16, v97
    v_and_b32 v67, 0xffff0000, v97
    v_lshlrev_b32 v68, 16, v96
    v_and_b32 v69, 0xffff0000, v96
    v_lshlrev_b32 v70, 16, v97
    v_and_b32 v71, 0xffff0000, v97
    v_smfmac_f32_16x16x64_bf16 v[64:67], v[24:27], v[100:107], v32
    s_waitcnt lgkmcnt(1)
    v_and_b32 v98, s88, v98
    v_and_b32 v99, s88, v99
    v_smfmac_f32_16x16x64_bf16 v[68:71], v[28:31], v[100:107], v32
    v_lshlrev_b32 v80, 16, v98
    v_and_b32 v81, 0xffff0000, v98
    v_smfmac_f32_16x16x64_bf16 v[64:67], v[24:27], v[108:115], v32
    v_lshlrev_b32 v82, 16, v99
    v_and_b32 v83, 0xffff0000, v99
    v_smfmac_f32_16x16x64_bf16 v[68:71], v[28:31], v[108:115], v32
    v_lshlrev_b32 v84, 16, v98
    v_and_b32 v85, 0xffff0000, v98
    v_smfmac_f32_16x16x64_bf16 v[64:67], v[24:27], v[116:123], v32
    v_lshlrev_b32 v86, 16, v99
    v_and_b32 v87, 0xffff0000, v99
    v_smfmac_f32_16x16x64_bf16 v[68:71], v[28:31], v[116:123], v32
    v_cndmask_b32 v254, v252, v25, vcc
    v_cndmask_b32 v255, v253, v25, vcc
    v_smfmac_f32_16x16x64_bf16 v[64:67], v[24:27], v[124:131], v32
    v_cndmask_b32 v252, 0, v252, vcc
    v_cndmask_b32 v253, 0, v253, vcc
    v_smfmac_f32_16x16x64_bf16 v[68:71], v[28:31], v[124:131], v32
    s_waitcnt lgkmcnt(0)
    v_sub_f32 v58, 1.0, v2
    v_sub_f32 v59, 1.0, v3
    v_smfmac_f32_16x16x64_bf16 v[64:67], v[24:27], v[132:139], v32
    s_lshl_b32 s89, s72, 12
    v_add_u32 v5, s89, v0
    v_smfmac_f32_16x16x64_bf16 v[68:71], v[28:31], v[132:139], v32
    s_mul_i32 s89, s72, 640
    v_add_u32 v6, s89, v4
    v_smfmac_f32_16x16x64_bf16 v[64:67], v[24:27], v[140:147], v32
    v_mul_u32_u24 v38, 640, v35
    v_lshl_add_u32 v38, v34, 3, v38
    v_smfmac_f32_16x16x64_bf16 v[68:71], v[28:31], v[140:147], v32
    v_mul_u32_u24 v39, 272, v34
    v_lshl_add_u32 v39, v35, 3, v39
    s_waitcnt vmcnt(0)
    buffer_load_dwordx4 v[40:43], v0, s[44:47], s90 offen offset:0 sc1
    buffer_load_dwordx4 v[44:47], v0, s[44:47], s90 offen offset:1024 sc1
    buffer_load_dwordx4 v[48:51], v0, s[44:47], s90 offen offset:2048 sc1
    buffer_load_dwordx4 v[52:55], v0, s[44:47], s90 offen offset:3072 sc1
    buffer_load_dwordx2 v[56:57], v4, s[44:47], s91 offen sc1
    v_smfmac_f32_16x16x64_bf16 v[64:67], v[24:27], v[148:155], v32
    s_lshl_b32 s89, s72, 5
    v_add_u32 v39, s89, v39
    v_smfmac_f32_16x16x64_bf16 v[68:71], v[28:31], v[148:155], v32
    v_lshl_add_u32 v1, v35, 5, v0
    s_mul_i32 s89, s72, 2304
    v_smfmac_f32_16x16x64_bf16 v[64:67], v[24:27], v[156:163], v32
    v_add_u32 v1, s89, v1
    s_lshl_b32 s89, s72, 2
    v_smfmac_f32_16x16x64_bf16 v[68:71], v[28:31], v[156:163], v32
    v_add_u32 v9, s89, v35
    v_mul_u32_u24 v7, 272, v9
    v_smfmac_f32_16x16x64_bf16 v[80:83], v[24:27], v[164:171], v32
    v_lshl_add_u32 v7, v34, 4, v7
    s_mul_i32 s89, s74, 18
    v_smfmac_f32_16x16x64_bf16 v[84:87], v[28:31], v[164:171], v32
    s_add_u32 s89, s89, s73
    s_lshl_b32 s89, s89, 6
    s_add_u32 s89, s89, 51200
    v_lshrrev_b32 v8, 2, v34
    v_mul_u32_u24 v8, 272, v8
    v_lshl_add_u32 v8, v34, 2, v8
    v_lshl_add_u32 v8, v35, 4, v8
    v_add_u32 v8, s89, v8
    v_mul_u32_u24 v9, 1152, v9
    v_lshl_add_u32 v10, v34, 1, v9
    v_lshl_add_u32 v9, v34, 4, v9
    s_lshr_b32 s88, s76, 2
    s_lshl2_add_u32 s88, s75, s88
    s_mul_i32 s88, s88, 36864
    s_lshl_b32 s89, s85, 5
    s_add_u32 s61, s88, s89
    s_lshl3_add_u32 s88, s89, s88
    v_xor_b32 v11, 0x1000, v5
    v_xor_b32 v12, 0x2000, v5
    v_xor_b32 v13, 0x3000, v5
    v_xor_b32 v14, 0x4000, v5
    v_xor_b32 v15, 0x5000, v5
    v_xor_b32 v16, 0x6000, v5
    v_xor_b32 v17, 0x7000, v5
    v_mul_f32 v64, v64, v58
    v_mul_f32 v65, v65, v58
    v_mul_f32 v66, v66, v58
    v_mul_f32 v67, v67, v58
    v_mul_f32 v68, v68, v59
    v_mul_f32 v69, v69, v59
    v_mul_f32 v70, v70, v59
    v_mul_f32 v71, v71, v59
    v_mul_f32 v80, v80, v58
    v_mul_f32 v81, v81, v58
    v_mul_f32 v82, v82, v58
    v_mul_f32 v83, v83, v58
    v_mul_f32 v84, v84, v59
    v_mul_f32 v85, v85, v59
    v_mul_f32 v86, v86, v59
    v_mul_f32 v87, v87, v59
    s_waitcnt vmcnt(4)
    v_max3_u32 v36, v40, v41, v42
    s_waitcnt vmcnt(3)
    v_max3_u32 v37, v43, v44, v45
    v_max3_u32 v36, v36, v46, v47
    s_waitcnt vmcnt(2)
    v_max3_u32 v37, v37, v48, v49
    v_max3_u32 v36, v36, v50, v51
    s_waitcnt vmcnt(1)
    v_max3_u32 v37, v37, v52, v53
    v_max3_u32 v36, v36, v54, v55
    s_waitcnt vmcnt(0)
    v_max3_u32 v37, v37, v56, v57
    v_max_u32 v36, v36, v37
    v_cmp_eq_u32 vcc, -1, v36
    s_nop 0
    s_cmp_lg_u64 vcc, 0
    s_cbranch_scc0 L_skip_66
    s_mov_b32 s3, 0x40000
L_spin_65:
    buffer_load_dwordx4 v[40:43], v0, s[44:47], s90 offen offset:0 sc1
    buffer_load_dwordx4 v[44:47], v0, s[44:47], s90 offen offset:1024 sc1
    buffer_load_dwordx4 v[48:51], v0, s[44:47], s90 offen offset:2048 sc1
    buffer_load_dwordx4 v[52:55], v0, s[44:47], s90 offen offset:3072 sc1
    buffer_load_dwordx2 v[56:57], v4, s[44:47], s91 offen sc1
    s_waitcnt vmcnt(0)
    v_max3_u32 v36, v40, v41, v42
    v_max3_u32 v37, v43, v44, v45
    v_max3_u32 v36, v36, v46, v47
    v_max3_u32 v37, v37, v48, v49
    v_max3_u32 v36, v36, v50, v51
    v_max3_u32 v37, v37, v52, v53
    v_max3_u32 v36, v36, v54, v55
    v_max3_u32 v37, v37, v56, v57
    v_max_u32 v36, v36, v37
    v_cmp_eq_u32 vcc, -1, v36
    s_nop 1
    s_cmp_eq_u64 vcc, 0
    s_cbranch_scc1 L_ok_64
    s_sub_u32 s3, s3, 1
    s_cmp_lg_u32 s3, 0
    s_cbranch_scc1 L_spin_65
L_ok_64:
L_skip_66:
    v_mfma_f32_16x16x16_bf16 v[88:91], v[252:253], v[56:57], 0
    v_mfma_f32_16x16x16_bf16 v[92:95], v[254:255], v[56:57], 0
    v_mfma_f32_16x16x32_bf16 v[88:91], v[244:247], v[40:43], v[88:91]
    v_mfma_f32_16x16x32_bf16 v[92:95], v[244:247], v[44:47], v[92:95]
    v_mfma_f32_16x16x32_bf16 v[88:91], v[248:251], v[48:51], v[88:91]
    v_mfma_f32_16x16x32_bf16 v[92:95], v[248:251], v[52:55], v[92:95]
    ds_write_b128 v5, v[40:43] offset:0
    v_mfma_f32_16x16x32_bf16 v[72:75], v[172:175], v[40:43], 0
    ds_write_b128 v5, v[44:47] offset:1024
    v_mfma_f32_16x16x32_bf16 v[76:79], v[172:175], v[44:47], 0
    ds_write_b128 v5, v[48:51] offset:2048
    v_mfma_f32_16x16x32_bf16 v[72:75], v[176:179], v[48:51], v[72:75]
    ds_write_b128 v5, v[52:55] offset:3072
    v_mfma_f32_16x16x32_bf16 v[76:79], v[176:179], v[52:55], v[76:79]
    ds_write_b64 v6, v[56:57] offset:32768
    v_fmac_f32 v80, v88, v2
    v_fmac_f32 v81, v89, v2
    v_fmac_f32 v82, v90, v2
    v_fmac_f32 v83, v91, v2
    ds_write_b128 v1, v[80:83] offset:51200
    v_fmac_f32 v84, v92, v3
    v_fmac_f32 v85, v93, v3
    v_fmac_f32 v86, v94, v3
    v_fmac_f32 v87, v95, v3
    ds_write_b128 v1, v[84:87] offset:52352
    s_setprio 3
    s_waitcnt lgkmcnt(0)
    s_barrier
    ds_read2st64_b32 v[80:81], v8 offset0:0 offset1:9
    ds_read2st64_b32 v[82:83], v8 offset0:18 offset1:27
    ds_read2st64_b32 v[84:85], v8 offset0:36 offset1:45
    ds_read2st64_b32 v[86:87], v8 offset0:54 offset1:63
    ds_read_b128 v[100:103], v11 offset:0
    ds_read_b128 v[104:107], v11 offset:1024
    ds_read_b128 v[108:111], v11 offset:2048
    ds_read_b128 v[112:115], v11 offset:3072
    s_waitcnt lgkmcnt(7)
    v_add_f32 v80, v80, v81
    s_waitcnt lgkmcnt(6)
    v_add_f32 v82, v82, v83
    s_waitcnt lgkmcnt(5)
    v_add_f32 v84, v84, v85
    s_waitcnt lgkmcnt(4)
    v_add_f32 v86, v86, v87
    v_add_f32 v80, v80, v82
    v_add_f32 v84, v84, v86
    v_add_f32 v80, v80, v84
    v_cvt_pk_bf16_f32 v80, v80, v80
    buffer_store_short v80, v10, s[52:55], s61 offen offset:1024 sc1
    s_waitcnt lgkmcnt(2)
    v_mfma_f32_16x16x32_bf16 v[72:75], v[180:183], v[100:103], v[72:75]
    ds_read_b128 v[100:103], v12 offset:0
    v_mfma_f32_16x16x32_bf16 v[76:79], v[180:183], v[104:107], v[76:79]
    ds_read_b128 v[104:107], v12 offset:1024
    s_waitcnt lgkmcnt(2)
    v_mfma_f32_16x16x32_bf16 v[72:75], v[184:187], v[108:111], v[72:75]
    ds_read_b128 v[108:111], v12 offset:2048
    v_mfma_f32_16x16x32_bf16 v[76:79], v[184:187], v[112:115], v[76:79]
    ds_read_b128 v[112:115], v12 offset:3072
    s_waitcnt lgkmcnt(2)
    v_mfma_f32_16x16x32_bf16 v[72:75], v[188:191], v[100:103], v[72:75]
    ds_read_b128 v[100:103], v13 offset:0
    v_mfma_f32_16x16x32_bf16 v[76:79], v[188:191], v[104:107], v[76:79]
    ds_read_b128 v[104:107], v13 offset:1024
    s_waitcnt lgkmcnt(2)
    v_mfma_f32_16x16x32_bf16 v[72:75], v[192:195], v[108:111], v[72:75]
    ds_read_b128 v[108:111], v13 offset:2048
    v_mfma_f32_16x16x32_bf16 v[76:79], v[192:195], v[112:115], v[76:79]
    ds_read_b128 v[112:115], v13 offset:3072
    s_setprio 2
    s_waitcnt lgkmcnt(2)
    v_mfma_f32_16x16x32_bf16 v[72:75], v[196:199], v[100:103], v[72:75]
    ds_read_b128 v[100:103], v14 offset:0
    v_mfma_f32_16x16x32_bf16 v[76:79], v[196:199], v[104:107], v[76:79]
    ds_read_b128 v[104:107], v14 offset:1024
    s_waitcnt lgkmcnt(2)
    v_mfma_f32_16x16x32_bf16 v[72:75], v[200:203], v[108:111], v[72:75]
    ds_read_b128 v[108:111], v14 offset:2048
    v_mfma_f32_16x16x32_bf16 v[76:79], v[200:203], v[112:115], v[76:79]
    ds_read_b128 v[112:115], v14 offset:3072
    s_waitcnt lgkmcnt(2)
    v_mfma_f32_16x16x32_bf16 v[72:75], v[204:207], v[100:103], v[72:75]
    ds_read_b128 v[100:103], v15 offset:0
    v_mfma_f32_16x16x32_bf16 v[76:79], v[204:207], v[104:107], v[76:79]
    ds_read_b128 v[104:107], v15 offset:1024
    s_waitcnt lgkmcnt(2)
    v_mfma_f32_16x16x32_bf16 v[72:75], v[208:211], v[108:111], v[72:75]
    ds_read_b128 v[108:111], v15 offset:2048
    v_mfma_f32_16x16x32_bf16 v[76:79], v[208:211], v[112:115], v[76:79]
    ds_read_b128 v[112:115], v15 offset:3072
    s_setprio 1
    s_waitcnt lgkmcnt(2)
    v_mfma_f32_16x16x32_bf16 v[72:75], v[212:215], v[100:103], v[72:75]
    ds_read_b128 v[100:103], v16 offset:0
    v_mfma_f32_16x16x32_bf16 v[76:79], v[212:215], v[104:107], v[76:79]
    ds_read_b128 v[104:107], v16 offset:1024
    s_waitcnt lgkmcnt(2)
    v_mfma_f32_16x16x32_bf16 v[72:75], v[216:219], v[108:111], v[72:75]
    ds_read_b128 v[108:111], v16 offset:2048
    v_mfma_f32_16x16x32_bf16 v[76:79], v[216:219], v[112:115], v[76:79]
    ds_read_b128 v[112:115], v16 offset:3072
    s_waitcnt lgkmcnt(2)
    v_mfma_f32_16x16x32_bf16 v[72:75], v[220:223], v[100:103], v[72:75]
    ds_read_b128 v[100:103], v17 offset:0
    v_mfma_f32_16x16x32_bf16 v[76:79], v[220:223], v[104:107], v[76:79]
    ds_read_b128 v[104:107], v17 offset:1024
    s_waitcnt lgkmcnt(2)
    v_mfma_f32_16x16x32_bf16 v[72:75], v[224:227], v[108:111], v[72:75]
    ds_read_b128 v[108:111], v17 offset:2048
    v_mfma_f32_16x16x32_bf16 v[76:79], v[224:227], v[112:115], v[76:79]
    ds_read_b128 v[112:115], v17 offset:3072
    s_setprio 0
    s_waitcnt lgkmcnt(2)
    v_mfma_f32_16x16x32_bf16 v[72:75], v[228:231], v[100:103], v[72:75]
    ds_read_b64 v[100:101], v38 offset:32768
    ds_read_b64 v[102:103], v38 offset:33024
    v_mfma_f32_16x16x32_bf16 v[76:79], v[228:231], v[104:107], v[76:79]
    ds_read_b64 v[104:105], v38 offset:32896
    ds_read_b64 v[106:107], v38 offset:33152
    s_waitcnt lgkmcnt(4)
    v_mfma_f32_16x16x32_bf16 v[72:75], v[232:235], v[108:111], v[72:75]
    ds_read_b64 v[108:109], v38 offset:35328
    ds_read_b64 v[110:111], v38 offset:35584
    v_mfma_f32_16x16x32_bf16 v[76:79], v[232:235], v[112:115], v[76:79]
    ds_read_b64 v[112:113], v38 offset:35456
    ds_read_b64 v[114:115], v38 offset:35712
    s_waitcnt lgkmcnt(4)
    v_mfma_f32_16x16x32_bf16 v[72:75], v[236:239], v[100:103], v[72:75]
    v_mfma_f32_16x16x32_bf16 v[76:79], v[236:239], v[104:107], v[76:79]
    s_waitcnt lgkmcnt(0)
    v_mfma_f32_16x16x32_bf16 v[72:75], v[240:243], v[108:111], v[72:75]
    v_mfma_f32_16x16x32_bf16 v[76:79], v[240:243], v[112:115], v[76:79]
    s_nop 6
    v_fmac_f32 v64, v72, v2
    v_fmac_f32 v65, v73, v2
    v_fmac_f32 v66, v74, v2
    v_fmac_f32 v67, v75, v2
    v_cvt_pk_bf16_f32 v72, v64, v65
    v_cvt_pk_bf16_f32 v73, v66, v67
    ds_write_b64 v39, v[72:73] offset:40960
    v_fmac_f32 v68, v76, v3
    v_fmac_f32 v69, v77, v3
    v_fmac_f32 v70, v78, v3
    v_fmac_f32 v71, v79, v3
    v_cvt_pk_bf16_f32 v76, v68, v69
    v_cvt_pk_bf16_f32 v77, v70, v71
    ds_write_b64 v39, v[76:77] offset:45312
    s_waitcnt lgkmcnt(0)
    s_barrier
    ds_read_b128 v[40:43], v7 offset:40960
    s_waitcnt lgkmcnt(0)
    buffer_store_dwordx4 v[40:43], v9, s[52:55], s88 offen sc1 nt
    s_endpgm
L_fin2:
L_h1page4:
    s_cbranch_execz L_probed1
    s_waitcnt lgkmcnt(2)
    v_lshlrev_b32 v64, 16, v96
    v_and_b32 v65, 0xffff0000, v96
    v_lshlrev_b32 v66, 16, v97
    v_and_b32 v67, 0xffff0000, v97
    v_lshlrev_b32 v68, 16, v96
    v_and_b32 v69, 0xffff0000, v96
    v_lshlrev_b32 v70, 16, v97
    v_and_b32 v71, 0xffff0000, v97
    s_waitcnt vmcnt(17)
    v_smfmac_f32_16x16x64_bf16 v[64:67], v[24:27], v[172:179], v32
    s_waitcnt lgkmcnt(1)
    v_and_b32 v98, s88, v98
    v_and_b32 v99, s88, v99
    v_smfmac_f32_16x16x64_bf16 v[68:71], v[28:31], v[172:179], v32
    v_lshlrev_b32 v80, 16, v98
    v_and_b32 v81, 0xffff0000, v98
    s_waitcnt vmcnt(15)
    v_smfmac_f32_16x16x64_bf16 v[64:67], v[24:27], v[180:187], v32
    v_lshlrev_b32 v82, 16, v99
    v_and_b32 v83, 0xffff0000, v99
    v_smfmac_f32_16x16x64_bf16 v[68:71], v[28:31], v[180:187], v32
    v_lshlrev_b32 v84, 16, v98
    v_and_b32 v85, 0xffff0000, v98
    s_waitcnt vmcnt(13)
    v_smfmac_f32_16x16x64_bf16 v[64:67], v[24:27], v[188:195], v32
    v_lshlrev_b32 v86, 16, v99
    v_and_b32 v87, 0xffff0000, v99
    v_smfmac_f32_16x16x64_bf16 v[68:71], v[28:31], v[188:195], v32
    v_cndmask_b32 v254, v252, v25, vcc
    v_cndmask_b32 v255, v253, v25, vcc
    s_waitcnt vmcnt(11)
    v_smfmac_f32_16x16x64_bf16 v[64:67], v[24:27], v[196:203], v32
    v_cndmask_b32 v252, 0, v252, vcc
    v_cndmask_b32 v253, 0, v253, vcc
    v_smfmac_f32_16x16x64_bf16 v[68:71], v[28:31], v[196:203], v32
    s_waitcnt lgkmcnt(0)
    v_sub_f32 v58, 1.0, v2
    v_sub_f32 v59, 1.0, v3
    s_waitcnt vmcnt(9)
    v_smfmac_f32_16x16x64_bf16 v[64:67], v[24:27], v[204:211], v32
    s_lshl_b32 s89, s72, 12
    v_add_u32 v5, s89, v0
    v_smfmac_f32_16x16x64_bf16 v[68:71], v[28:31], v[204:211], v32
    s_mul_i32 s89, s72, 640
    v_add_u32 v6, s89, v4
    s_waitcnt vmcnt(7)
    v_smfmac_f32_16x16x64_bf16 v[64:67], v[24:27], v[212:219], v32
    v_mul_u32_u24 v38, 640, v35
    v_lshl_add_u32 v38, v34, 3, v38
    v_smfmac_f32_16x16x64_bf16 v[68:71], v[28:31], v[212:219], v32
    v_mul_u32_u24 v39, 272, v34
    v_lshl_add_u32 v39, v35, 3, v39
    s_waitcnt vmcnt(0)
    buffer_load_dwordx4 v[40:43], v0, s[44:47], s90 offen offset:0 sc1
    buffer_load_dwordx4 v[44:47], v0, s[44:47], s90 offen offset:1024 sc1
    buffer_load_dwordx4 v[48:51], v0, s[44:47], s90 offen offset:2048 sc1
    buffer_load_dwordx4 v[52:55], v0, s[44:47], s90 offen offset:3072 sc1
    buffer_load_dwordx2 v[56:57], v4, s[44:47], s91 offen sc1
    v_smfmac_f32_16x16x64_bf16 v[64:67], v[24:27], v[220:227], v32
    s_lshl_b32 s89, s72, 5
    v_add_u32 v39, s89, v39
    v_smfmac_f32_16x16x64_bf16 v[68:71], v[28:31], v[220:227], v32
    v_lshl_add_u32 v1, v35, 5, v0
    s_mul_i32 s89, s72, 2304
    v_smfmac_f32_16x16x64_bf16 v[64:67], v[24:27], v[228:235], v32
    v_add_u32 v1, s89, v1
    s_lshl_b32 s89, s72, 2
    v_smfmac_f32_16x16x64_bf16 v[68:71], v[28:31], v[228:235], v32
    v_add_u32 v9, s89, v35
    v_mul_u32_u24 v7, 272, v9
    v_smfmac_f32_16x16x64_bf16 v[80:83], v[24:27], v[236:243], v32
    v_lshl_add_u32 v7, v34, 4, v7
    s_mul_i32 s89, s74, 18
    v_smfmac_f32_16x16x64_bf16 v[84:87], v[28:31], v[236:243], v32
    s_add_u32 s89, s89, s73
    s_lshl_b32 s89, s89, 6
    s_add_u32 s89, s89, 51200
    v_lshrrev_b32 v8, 2, v34
    v_mul_u32_u24 v8, 272, v8
    v_lshl_add_u32 v8, v34, 2, v8
    v_lshl_add_u32 v8, v35, 4, v8
    v_add_u32 v8, s89, v8
    v_mul_u32_u24 v9, 1152, v9
    v_lshl_add_u32 v10, v34, 1, v9
    v_lshl_add_u32 v9, v34, 4, v9
    s_lshr_b32 s88, s76, 2
    s_lshl2_add_u32 s88, s75, s88
    s_mul_i32 s88, s88, 36864
    s_lshl_b32 s89, s85, 5
    s_add_u32 s61, s88, s89
    s_lshl3_add_u32 s88, s89, s88
    v_xor_b32 v11, 0x1000, v5
    v_xor_b32 v12, 0x2000, v5
    v_xor_b32 v13, 0x3000, v5
    v_xor_b32 v14, 0x4000, v5
    v_xor_b32 v15, 0x5000, v5
    v_xor_b32 v16, 0x6000, v5
    v_xor_b32 v17, 0x7000, v5
    v_mul_f32 v64, v64, v58
    v_mul_f32 v65, v65, v58
    v_mul_f32 v66, v66, v58
    v_mul_f32 v67, v67, v58
    v_mul_f32 v68, v68, v59
    v_mul_f32 v69, v69, v59
    v_mul_f32 v70, v70, v59
    v_mul_f32 v71, v71, v59
    v_mul_f32 v80, v80, v58
    v_mul_f32 v81, v81, v58
    v_mul_f32 v82, v82, v58
    v_mul_f32 v83, v83, v58
    v_mul_f32 v84, v84, v59
    v_mul_f32 v85, v85, v59
    v_mul_f32 v86, v86, v59
    v_mul_f32 v87, v87, v59
    s_waitcnt vmcnt(4)
    v_max3_u32 v36, v40, v41, v42
    s_waitcnt vmcnt(3)
    v_max3_u32 v37, v43, v44, v45
    v_max3_u32 v36, v36, v46, v47
    s_waitcnt vmcnt(2)
    v_max3_u32 v37, v37, v48, v49
    v_max3_u32 v36, v36, v50, v51
    s_waitcnt vmcnt(1)
    v_max3_u32 v37, v37, v52, v53
    v_max3_u32 v36, v36, v54, v55
    s_waitcnt vmcnt(0)
    v_max3_u32 v37, v37, v56, v57
    v_max_u32 v36, v36, v37
    v_cmp_eq_u32 vcc, -1, v36
    s_nop 0
    s_cmp_lg_u64 vcc, 0
    s_cbranch_scc0 L_skip_69
    s_mov_b32 s3, 0x40000
L_spin_68:
    buffer_load_dwordx4 v[40:43], v0, s[44:47], s90 offen offset:0 sc1
    buffer_load_dwordx4 v[44:47], v0, s[44:47], s90 offen offset:1024 sc1
L_h1page3:
    s_cbranch_execz L_probed1
    buffer_load_dwordx4 v[48:51], v0, s[44:47], s90 offen offset:2048 sc1
    buffer_load_dwordx4 v[52:55], v0, s[44:47], s90 offen offset:3072 sc1
    buffer_load_dwordx2 v[56:57], v4, s[44:47], s91 offen sc1
    s_waitcnt vmcnt(0)
    v_max3_u32 v36, v40, v41, v42
    v_max3_u32 v37, v43, v44, v45
    v_max3_u32 v36, v36, v46, v47
    v_max3_u32 v37, v37, v48, v49
    v_max3_u32 v36, v36, v50, v51
    v_max3_u32 v37, v37, v52, v53
    v_max3_u32 v36, v36, v54, v55
    v_max3_u32 v37, v37, v56, v57
    v_max_u32 v36, v36, v37
    v_cmp_eq_u32 vcc, -1, v36
    s_nop 1
    s_cmp_eq_u64 vcc, 0
    s_cbranch_scc1 L_ok_67
    s_sub_u32 s3, s3, 1
    s_cmp_lg_u32 s3, 0
    s_cbranch_scc1 L_spin_68
L_ok_67:
L_skip_69:
    v_mfma_f32_16x16x16_bf16 v[88:91], v[252:253], v[56:57], 0
    v_mfma_f32_16x16x16_bf16 v[92:95], v[254:255], v[56:57], 0
    v_mfma_f32_16x16x32_bf16 v[88:91], v[244:247], v[40:43], v[88:91]
    v_mfma_f32_16x16x32_bf16 v[92:95], v[244:247], v[44:47], v[92:95]
    v_mfma_f32_16x16x32_bf16 v[88:91], v[248:251], v[48:51], v[88:91]
    v_mfma_f32_16x16x32_bf16 v[92:95], v[248:251], v[52:55], v[92:95]
    ds_write_b128 v5, v[40:43] offset:0
    v_mfma_f32_16x16x32_bf16 v[72:75], v[100:103], v[40:43], 0
    ds_write_b128 v5, v[44:47] offset:1024
    v_mfma_f32_16x16x32_bf16 v[76:79], v[100:103], v[44:47], 0
    ds_write_b128 v5, v[48:51] offset:2048
    v_mfma_f32_16x16x32_bf16 v[72:75], v[104:107], v[48:51], v[72:75]
    ds_write_b128 v5, v[52:55] offset:3072
    v_mfma_f32_16x16x32_bf16 v[76:79], v[104:107], v[52:55], v[76:79]
    ds_write_b64 v6, v[56:57] offset:32768
    v_fmac_f32 v80, v88, v2
    v_fmac_f32 v81, v89, v2
    v_fmac_f32 v82, v90, v2
    v_fmac_f32 v83, v91, v2
    ds_write_b128 v1, v[80:83] offset:51200
    v_fmac_f32 v84, v92, v3
    v_fmac_f32 v85, v93, v3
    v_fmac_f32 v86, v94, v3
    v_fmac_f32 v87, v95, v3
    ds_write_b128 v1, v[84:87] offset:52352
    s_setprio 3
    s_waitcnt lgkmcnt(0)
    s_barrier
    ds_read2st64_b32 v[80:81], v8 offset0:0 offset1:9
    ds_read2st64_b32 v[82:83], v8 offset0:18 offset1:27
    ds_read2st64_b32 v[84:85], v8 offset0:36 offset1:45
    ds_read2st64_b32 v[86:87], v8 offset0:54 offset1:63
    ds_read_b128 v[172:175], v11 offset:0
    ds_read_b128 v[176:179], v11 offset:1024
    ds_read_b128 v[180:183], v11 offset:2048
    ds_read_b128 v[184:187], v11 offset:3072
    s_waitcnt lgkmcnt(7)
    v_add_f32 v80, v80, v81
    s_waitcnt lgkmcnt(6)
    v_add_f32 v82, v82, v83
    s_waitcnt lgkmcnt(5)
    v_add_f32 v84, v84, v85
    s_waitcnt lgkmcnt(4)
    v_add_f32 v86, v86, v87
    v_add_f32 v80, v80, v82
    v_add_f32 v84, v84, v86
    v_add_f32 v80, v80, v84
    v_cvt_pk_bf16_f32 v80, v80, v80
    buffer_store_short v80, v10, s[52:55], s61 offen offset:1024 sc1
    s_waitcnt lgkmcnt(2)
    v_mfma_f32_16x16x32_bf16 v[72:75], v[108:111], v[172:175], v[72:75]
    ds_read_b128 v[172:175], v12 offset:0
    v_mfma_f32_16x16x32_bf16 v[76:79], v[108:111], v[176:179], v[76:79]
    ds_read_b128 v[176:179], v12 offset:1024
    s_waitcnt lgkmcnt(2)
    v_mfma_f32_16x16x32_bf16 v[72:75], v[112:115], v[180:183], v[72:75]
    ds_read_b128 v[180:183], v12 offset:2048
    v_mfma_f32_16x16x32_bf16 v[76:79], v[112:115], v[184:187], v[76:79]
    ds_read_b128 v[184:187], v12 offset:3072
    s_waitcnt lgkmcnt(2)
    v_mfma_f32_16x16x32_bf16 v[72:75], v[116:119], v[172:175], v[72:75]
    ds_read_b128 v[172:175], v13 offset:0
    v_mfma_f32_16x16x32_bf16 v[76:79], v[116:119], v[176:179], v[76:79]
    ds_read_b128 v[176:179], v13 offset:1024
    s_waitcnt lgkmcnt(2)
    v_mfma_f32_16x16x32_bf16 v[72:75], v[120:123], v[180:183], v[72:75]
    ds_read_b128 v[180:183], v13 offset:2048
    v_mfma_f32_16x16x32_bf16 v[76:79], v[120:123], v[184:187], v[76:79]
    ds_read_b128 v[184:187], v13 offset:3072
    s_setprio 2
    s_waitcnt lgkmcnt(2)
    v_mfma_f32_16x16x32_bf16 v[72:75], v[124:127], v[172:175], v[72:75]
    ds_read_b128 v[172:175], v14 offset:0
    v_mfma_f32_16x16x32_bf16 v[76:79], v[124:127], v[176:179], v[76:79]
    ds_read_b128 v[176:179], v14 offset:1024
    s_waitcnt lgkmcnt(2)
    v_mfma_f32_16x16x32_bf16 v[72:75], v[128:131], v[180:183], v[72:75]
    ds_read_b128 v[180:183], v14 offset:2048
    v_mfma_f32_16x16x32_bf16 v[76:79], v[128:131], v[184:187], v[76:79]
    ds_read_b128 v[184:187], v14 offset:3072
    s_waitcnt lgkmcnt(2)
    v_mfma_f32_16x16x32_bf16 v[72:75], v[132:135], v[172:175], v[72:75]
    ds_read_b128 v[172:175], v15 offset:0
    v_mfma_f32_16x16x32_bf16 v[76:79], v[132:135], v[176:179], v[76:79]
    ds_read_b128 v[176:179], v15 offset:1024
    s_waitcnt lgkmcnt(2)
    v_mfma_f32_16x16x32_bf16 v[72:75], v[136:139], v[180:183], v[72:75]
    ds_read_b128 v[180:183], v15 offset:2048
    v_mfma_f32_16x16x32_bf16 v[76:79], v[136:139], v[184:187], v[76:79]
    ds_read_b128 v[184:187], v15 offset:3072
    s_setprio 1
    s_waitcnt lgkmcnt(2)
    v_mfma_f32_16x16x32_bf16 v[72:75], v[140:143], v[172:175], v[72:75]
    ds_read_b128 v[172:175], v16 offset:0
    v_mfma_f32_16x16x32_bf16 v[76:79], v[140:143], v[176:179], v[76:79]
    ds_read_b128 v[176:179], v16 offset:1024
    s_waitcnt lgkmcnt(2)
    v_mfma_f32_16x16x32_bf16 v[72:75], v[144:147], v[180:183], v[72:75]
    ds_read_b128 v[180:183], v16 offset:2048
    v_mfma_f32_16x16x32_bf16 v[76:79], v[144:147], v[184:187], v[76:79]
    ds_read_b128 v[184:187], v16 offset:3072
    s_waitcnt lgkmcnt(2)
    v_mfma_f32_16x16x32_bf16 v[72:75], v[148:151], v[172:175], v[72:75]
    ds_read_b128 v[172:175], v17 offset:0
    v_mfma_f32_16x16x32_bf16 v[76:79], v[148:151], v[176:179], v[76:79]
    ds_read_b128 v[176:179], v17 offset:1024
    s_waitcnt lgkmcnt(2)
    v_mfma_f32_16x16x32_bf16 v[72:75], v[152:155], v[180:183], v[72:75]
    ds_read_b128 v[180:183], v17 offset:2048
    v_mfma_f32_16x16x32_bf16 v[76:79], v[152:155], v[184:187], v[76:79]
    ds_read_b128 v[184:187], v17 offset:3072
    s_setprio 0
    s_waitcnt lgkmcnt(2)
    v_mfma_f32_16x16x32_bf16 v[72:75], v[156:159], v[172:175], v[72:75]
    ds_read_b64 v[172:173], v38 offset:32768
    ds_read_b64 v[174:175], v38 offset:33024
    v_mfma_f32_16x16x32_bf16 v[76:79], v[156:159], v[176:179], v[76:79]
    ds_read_b64 v[176:177], v38 offset:32896
    ds_read_b64 v[178:179], v38 offset:33152
    s_waitcnt lgkmcnt(4)
    v_mfma_f32_16x16x32_bf16 v[72:75], v[160:163], v[180:183], v[72:75]
    ds_read_b64 v[180:181], v38 offset:35328
    ds_read_b64 v[182:183], v38 offset:35584
    v_mfma_f32_16x16x32_bf16 v[76:79], v[160:163], v[184:187], v[76:79]
    ds_read_b64 v[184:185], v38 offset:35456
    ds_read_b64 v[186:187], v38 offset:35712
    s_waitcnt lgkmcnt(4)
    v_mfma_f32_16x16x32_bf16 v[72:75], v[164:167], v[172:175], v[72:75]
    v_mfma_f32_16x16x32_bf16 v[76:79], v[164:167], v[176:179], v[76:79]
    s_waitcnt lgkmcnt(0)
    v_mfma_f32_16x16x32_bf16 v[72:75], v[168:171], v[180:183], v[72:75]
    v_mfma_f32_16x16x32_bf16 v[76:79], v[168:171], v[184:187], v[76:79]
    s_nop 6
    v_fmac_f32 v64, v72, v2
    v_fmac_f32 v65, v73, v2
    v_fmac_f32 v66, v74, v2
    v_fmac_f32 v67, v75, v2
    v_cvt_pk_bf16_f32 v72, v64, v65
    v_cvt_pk_bf16_f32 v73, v66, v67
    ds_write_b64 v39, v[72:73] offset:40960
    v_fmac_f32 v68, v76, v3
    v_fmac_f32 v69, v77, v3
    v_fmac_f32 v70, v78, v3
    v_fmac_f32 v71, v79, v3
    v_cvt_pk_bf16_f32 v76, v68, v69
    v_cvt_pk_bf16_f32 v77, v70, v71
    ds_write_b64 v39, v[76:77] offset:45312
    s_waitcnt lgkmcnt(0)
    s_barrier
    ds_read_b128 v[40:43], v7 offset:40960
    s_waitcnt lgkmcnt(0)
    buffer_store_dwordx4 v[40:43], v9, s[52:55], s88 offen sc1 nt
L_out:
L_end:
    s_endpgm
L_far_21:
    s_mov_b32 s3, 0x40000
L_spin_20:
    buffer_load_dword v204, v205, s[48:51], 0 offen sc1
    s_waitcnt vmcnt(0)
    v_cmp_eq_u32 vcc, 0, v204
    s_nop 1
    s_cmp_eq_u64 vcc, 0
    s_cbranch_scc1 L_ok_19
    s_sub_u32 s3, s3, 1
    s_cmp_lg_u32 s3, 0
    s_cbranch_scc1 L_spin_20
L_ok_19:
    s_branch L_back_22
L_far_43:
    s_mov_b32 s3, 0x40000
L_spin_42:
    buffer_load_dword v204, v205, s[48:51], 0 offen sc1
    s_waitcnt vmcnt(0)
    v_cmp_eq_u32 vcc, 0, v204
    s_nop 1
    s_cmp_eq_u64 vcc, 0
    s_cbranch_scc1 L_ok_41
    s_sub_u32 s3, s3, 1
    s_cmp_lg_u32 s3, 0
    s_cbranch_scc1 L_spin_42
L_ok_41:
    s_branch L_back_44
L_far_53:
    s_mov_b32 s3, 0x40000
L_spin_52:
    buffer_load_dword v39, v5, s[44:47], 0 offen sc1
    s_waitcnt vmcnt(0)
    v_subrev_u32 v39, s89, v39
    v_cmp_lt_u32 vcc, 8, v39
    s_nop 1
    s_cmp_eq_u64 vcc, 0
    s_cbranch_scc1 L_ok_51
    s_sub_u32 s3, s3, 1
    s_cmp_lg_u32 s3, 0
    s_cbranch_scc1 L_spin_52
L_ok_51:
    s_branch L_back_54
L_far_57:
    s_mov_b32 s3, 0x40000
L_spin_56:
    buffer_load_dword v39, v5, s[44:47], 0 offen sc1
    s_waitcnt vmcnt(0)
    v_subrev_u32 v39, s89, v39
    v_cmp_lt_u32 vcc, 8, v39
    s_nop 1
    s_cmp_eq_u32 vcc_lo, 0
    s_cbranch_scc1 L_ok_55
    s_sub_u32 s3, s3, 1
    s_cmp_lg_u32 s3, 0
    s_cbranch_scc1 L_spin_56
L_ok_55:
    s_branch L_back_58
L_far_72:
    s_mov_b32 s3, 0x40000
L_spin_71:
    buffer_load_dword v39, v5, s[44:47], 0 offen sc1
    s_waitcnt vmcnt(0)
    v_subrev_u32 v39, s89, v39
    v_cmp_lt_u32 vcc, 8, v39
    s_nop 1
    s_cmp_eq_u64 vcc, 0
    s_cbranch_scc1 L_ok_70
    s_sub_u32 s3, s3, 1
    s_cmp_lg_u32 s3, 0
    s_cbranch_scc1 L_spin_71
L_ok_70:
    s_branch L_back_73
L_far_76:
    s_mov_b32 s3, 0x40000
L_spin_75:
    buffer_load_dword v39, v5, s[44:47], 0 offen sc1
    s_waitcnt vmcnt(0)
    v_subrev_u32 v39, s89, v39
    v_cmp_lt_u32 vcc, 8, v39
    s_nop 1
    s_cmp_eq_u32 vcc_lo, 0
    s_cbranch_scc1 L_ok_74
    s_sub_u32 s3, s3, 1
    s_cmp_lg_u32 s3, 0
    s_cbranch_scc1 L_spin_75
L_ok_74:
    s_branch L_back_77
L_slow:
    s_mul_i32 s90, s74, 0x1000
    s_add_u32 s90, s90, s78
    s_add_u32 m0, s90, 0
    s_add_u32 s90, s90, 0
    buffer_load_dwordx4 v0, s[44:47], s90 offen sc1 lds
    s_mul_i32 s90, s74, 0x1000
    s_add_u32 s90, s90, s78
    s_add_u32 m0, s90, 106496
    s_add_u32 s90, s90, 106496
    buffer_load_dwordx4 v0, s[44:47], s90 offen sc1 lds
    s_mul_i32 s90, s74, 0x1000
    s_add_u32 s90, s90, s78
    s_add_u32 m0, s90, 114688
    s_add_u32 s90, s90, 114688
    buffer_load_dwordx4 v0, s[44:47], s90 offen sc1 lds
    s_mul_i32 s90, s74, 0x1000
    s_add_u32 s90, s90, s78
    s_add_u32 m0, s90, 122880
    s_add_u32 s90, s90, 122880
    buffer_load_dwordx4 v0, s[44:47], s90 offen sc1 lds
    s_mul_i32 s90, s74, 0x1000
    s_add_u32 s90, s90, s78
    s_add_u32 m0, s90, 131072
    s_add_u32 s90, s90, 131072
    buffer_load_dwordx4 v0, s[44:47], s90 offen sc1 lds
    s_mul_i32 s90, s74, 0x1000
    s_add_u32 s90, s90, s78
    s_add_u32 m0, s90, 139264
    s_add_u32 s90, s90, 139264
    buffer_load_dwordx4 v0, s[44:47], s90 offen sc1 lds
    s_add_u32 s91, s86, 131072
    buffer_store_dwordx4 v[232:235], v0, s[44:47], s91 offen sc1
    s_add_u32 s91, s86, 147456
    buffer_store_dwordx4 v[236:239], v0, s[44:47], s91 offen sc1
    s_add_u32 s91, s86, 196608
    buffer_store_dwordx4 v[240:243], v0, s[44:47], s91 offen sc1
    s_add_u32 s91, s86, 212992
    buffer_store_dwordx4 v[244:247], v0, s[44:47], s91 offen sc1
    s_add_u32 s91, s86, 262144
    buffer_store_dwordx4 v[248:251], v0, s[44:47], s91 offen sc1
    s_add_u32 s91, s86, 278528
    buffer_store_dwordx4 v[252:255], v0, s[44:47], s91 offen sc1
    s_add_u32 s91, s86, 327680
    buffer_store_dwordx4 v[208:211], v0, s[44:47], s91 offen sc1
    s_add_u32 s91, s86, 344064
    buffer_store_dwordx4 v[212:215], v0, s[44:47], s91 offen sc1
    s_add_u32 s91, s86, 393216
    buffer_store_dwordx4 v[216:219], v0, s[44:47], s91 offen sc1
    s_add_u32 s91, s86, 409600
    buffer_store_dwordx4 v[220:223], v0, s[44:47], s91 offen sc1
    s_add_u32 s91, s86, 458752
    buffer_store_dwordx4 v[224:227], v0, s[44:47], s91 offen sc1
    s_add_u32 s91, s86, 475136
    buffer_store_dwordx4 v[228:231], v0, s[44:47], s91 offen sc1
    s_waitcnt vmcnt(0) lgkmcnt(0)
    s_barrier
    s_add_u32 s89, s68, 9
    v_mov_b32 v37, s89
    s_bfm_b64 exec, 8, 0
    buffer_store_dword v37, v1, s[44:47], s84 offen sc1
    s_mov_b64 exec, -1
    v_mov_b32 v45, 0
    v_mov_b32 v47, 0
    v_mov_b32 v38, 0xff800000
    s_mov_b32 s88, 16
L_slow1:
    ds_read_b128 v[48:51], v2 offset:0
    ds_read_b32 v52, v4 offset:8704
    s_waitcnt lgkmcnt(0)
    v_mfma_f32_32x32x8_bf16 v[64:79], v[52:53], v[44:45], 0
    v_mfma_f32_32x32x16_bf16 v[64:79], v[48:51], v[40:43], v[64:79]
    s_nop 15
    v_max3_f32 v38, v38, v64, v65
    v_max3_f32 v38, v38, v66, v67
    v_max3_f32 v38, v38, v68, v69
    v_max3_f32 v38, v38, v70, v71
    v_max3_f32 v38, v38, v72, v73
    v_max3_f32 v38, v38, v74, v75
    v_max3_f32 v38, v38, v76, v77
    v_max3_f32 v38, v38, v78, v79
    ds_read_b128 v[48:51], v2 offset:1024
    ds_read_b32 v52, v4 offset:8704
    s_waitcnt lgkmcnt(0)
    v_mfma_f32_32x32x8_bf16 v[64:79], v[52:53], v[46:47], 0
    v_mfma_f32_32x32x16_bf16 v[64:79], v[48:51], v[40:43], v[64:79]
    s_nop 15
    v_max3_f32 v38, v38, v64, v65
    v_max3_f32 v38, v38, v66, v67
    v_max3_f32 v38, v38, v68, v69
    v_max3_f32 v38, v38, v70, v71
    v_max3_f32 v38, v38, v72, v73
    v_max3_f32 v38, v38, v74, v75
    v_max3_f32 v38, v38, v76, v77
    v_max3_f32 v38, v38, v78, v79
    ds_read_b128 v[48:51], v2 offset:2048
    ds_read_b32 v52, v4 offset:8960
    s_waitcnt lgkmcnt(0)
    v_mfma_f32_32x32x8_bf16 v[64:79], v[52:53], v[44:45], 0
    v_mfma_f32_32x32x16_bf16 v[64:79], v[48:51], v[40:43], v[64:79]
    s_nop 15
    v_max3_f32 v38, v38, v64, v65
    v_max3_f32 v38, v38, v66, v67
    v_max3_f32 v38, v38, v68, v69
    v_max3_f32 v38, v38, v70, v71
    v_max3_f32 v38, v38, v72, v73
    v_max3_f32 v38, v38, v74, v75
    v_max3_f32 v38, v38, v76, v77
    v_max3_f32 v38, v38, v78, v79
    ds_read_b128 v[48:51], v2 offset:3072
    ds_read_b32 v52, v4 offset:8960
    s_waitcnt lgkmcnt(0)
    v_mfma_f32_32x32x8_bf16 v[64:79], v[52:53], v[46:47], 0
    v_mfma_f32_32x32x16_bf16 v[64:79], v[48:51], v[40:43], v[64:79]
    s_nop 15
    v_max3_f32 v38, v38, v64, v65
    v_max3_f32 v38, v38, v66, v67
    v_max3_f32 v38, v38, v68, v69
    v_max3_f32 v38, v38, v70, v71
    v_max3_f32 v38, v38, v72, v73
    v_max3_f32 v38, v38, v74, v75
    v_max3_f32 v38, v38, v76, v77
    v_max3_f32 v38, v38, v78, v79
    v_add_u32 v2, 9216, v2
    v_add_u32 v3, 9216, v3
    v_add_u32 v4, 9216, v4
    s_sub_u32 s88, s88, 1
    s_cmp_lg_u32 s88, 0
    s_cbranch_scc1 L_slow1
    v_mov_b32 v39, v38
    s_nop 1
    v_permlane32_swap_b32 v39, v38
    s_nop 1
    v_max_f32 v38, v38, v39
    v_subrev_u32 v2, 147456, v2
    v_subrev_u32 v3, 147456, v3
    v_subrev_u32 v4, 147456, v4
    s_mov_b32 s88, 16
L_slow2:
    s_mov_b64 exec, s[92:93]
    ds_read_b128 v[56:59], v3 offset:4096
    ds_read_b128 v[60:63], v3 offset:4672
    s_mov_b64 exec, -1
    ds_read_b128 v[48:51], v2 offset:0
    ds_read_b32 v52, v4 offset:8704
    s_waitcnt lgkmcnt(0)
    v_mfma_f32_32x32x8_bf16 v[64:79], v[52:53], v[44:45], 0
    v_mfma_f32_32x32x16_bf16 v[64:79], v[48:51], v[40:43], v[64:79]
    s_nop 15
    v_sub_f32 v64, v64, v38
    v_sub_f32 v65, v65, v38
    v_sub_f32 v66, v66, v38
    v_sub_f32 v67, v67, v38
    v_sub_f32 v68, v68, v38
    v_sub_f32 v69, v69, v38
    v_sub_f32 v70, v70, v38
    v_sub_f32 v71, v71, v38
    v_sub_f32 v72, v72, v38
    v_sub_f32 v73, v73, v38
    v_sub_f32 v74, v74, v38
    v_sub_f32 v75, v75, v38
    v_sub_f32 v76, v76, v38
    v_sub_f32 v77, v77, v38
    v_sub_f32 v78, v78, v38
    v_sub_f32 v79, v79, v38
    v_exp_f32 v64, v64
    v_exp_f32 v65, v65
    v_exp_f32 v66, v66
    v_exp_f32 v67, v67
    v_exp_f32 v68, v68
    v_exp_f32 v69, v69
    v_exp_f32 v70, v70
    v_exp_f32 v71, v71
    v_exp_f32 v72, v72
    v_exp_f32 v73, v73
    v_exp_f32 v74, v74
    v_exp_f32 v75, v75
    v_exp_f32 v76, v76
    v_exp_f32 v77, v77
    v_exp_f32 v78, v78
    v_exp_f32 v79, v79
    s_nop 1
    v_smfmac_f32_32x32x32_bf16 v[6:21], v[56:59], v[64:71], v54
    v_smfmac_f32_32x32x32_bf16 v[6:21], v[60:63], v[72:79], v54
    s_nop 3
    s_mov_b64 exec, s[92:93]
    ds_read_b128 v[56:59], v3 offset:5248
    ds_read_b128 v[60:63], v3 offset:5824
    s_mov_b64 exec, -1
    ds_read_b128 v[48:51], v2 offset:1024
    ds_read_b32 v52, v4 offset:8704
    s_waitcnt lgkmcnt(0)
    v_mfma_f32_32x32x8_bf16 v[64:79], v[52:53], v[46:47], 0
    v_mfma_f32_32x32x16_bf16 v[64:79], v[48:51], v[40:43], v[64:79]
    s_nop 15
    v_sub_f32 v64, v64, v38
    v_sub_f32 v65, v65, v38
    v_sub_f32 v66, v66, v38
    v_sub_f32 v67, v67, v38
    v_sub_f32 v68, v68, v38
    v_sub_f32 v69, v69, v38
    v_sub_f32 v70, v70, v38
    v_sub_f32 v71, v71, v38
    v_sub_f32 v72, v72, v38
    v_sub_f32 v73, v73, v38
    v_sub_f32 v74, v74, v38
    v_sub_f32 v75, v75, v38
    v_sub_f32 v76, v76, v38
    v_sub_f32 v77, v77, v38
    v_sub_f32 v78, v78, v38
    v_sub_f32 v79, v79, v38
    v_exp_f32 v64, v64
    v_exp_f32 v65, v65
    v_exp_f32 v66, v66
    v_exp_f32 v67, v67
    v_exp_f32 v68, v68
    v_exp_f32 v69, v69
    v_exp_f32 v70, v70
    v_exp_f32 v71, v71
    v_exp_f32 v72, v72
    v_exp_f32 v73, v73
    v_exp_f32 v74, v74
    v_exp_f32 v75, v75
    v_exp_f32 v76, v76
    v_exp_f32 v77, v77
    v_exp_f32 v78, v78
    v_exp_f32 v79, v79
    s_nop 1
    v_smfmac_f32_32x32x32_bf16 v[6:21], v[56:59], v[64:71], v54
    v_smfmac_f32_32x32x32_bf16 v[6:21], v[60:63], v[72:79], v54
    s_nop 3
    s_mov_b64 exec, s[92:93]
    ds_read_b128 v[56:59], v3 offset:6400
    ds_read_b128 v[60:63], v3 offset:6976
    s_mov_b64 exec, -1
    ds_read_b128 v[48:51], v2 offset:2048
    ds_read_b32 v52, v4 offset:8960
    s_waitcnt lgkmcnt(0)
    v_mfma_f32_32x32x8_bf16 v[64:79], v[52:53], v[44:45], 0
    v_mfma_f32_32x32x16_bf16 v[64:79], v[48:51], v[40:43], v[64:79]
    s_nop 15
    v_sub_f32 v64, v64, v38
    v_sub_f32 v65, v65, v38
    v_sub_f32 v66, v66, v38
    v_sub_f32 v67, v67, v38
    v_sub_f32 v68, v68, v38
    v_sub_f32 v69, v69, v38
    v_sub_f32 v70, v70, v38
    v_sub_f32 v71, v71, v38
    v_sub_f32 v72, v72, v38
    v_sub_f32 v73, v73, v38
    v_sub_f32 v74, v74, v38
    v_sub_f32 v75, v75, v38
    v_sub_f32 v76, v76, v38
    v_sub_f32 v77, v77, v38
    v_sub_f32 v78, v78, v38
    v_sub_f32 v79, v79, v38
    v_exp_f32 v64, v64
    v_exp_f32 v65, v65
    v_exp_f32 v66, v66
    v_exp_f32 v67, v67
    v_exp_f32 v68, v68
    v_exp_f32 v69, v69
    v_exp_f32 v70, v70
    v_exp_f32 v71, v71
    v_exp_f32 v72, v72
    v_exp_f32 v73, v73
    v_exp_f32 v74, v74
    v_exp_f32 v75, v75
    v_exp_f32 v76, v76
    v_exp_f32 v77, v77
    v_exp_f32 v78, v78
    v_exp_f32 v79, v79
    s_nop 1
    v_smfmac_f32_32x32x32_bf16 v[6:21], v[56:59], v[64:71], v54
    v_smfmac_f32_32x32x32_bf16 v[6:21], v[60:63], v[72:79], v54
    s_nop 3
    s_mov_b64 exec, s[92:93]
    ds_read_b128 v[56:59], v3 offset:7552
    ds_read_b128 v[60:63], v3 offset:8128
    s_mov_b64 exec, -1
    ds_read_b128 v[48:51], v2 offset:3072
    ds_read_b32 v52, v4 offset:8960
    s_waitcnt lgkmcnt(0)
    v_mfma_f32_32x32x8_bf16 v[64:79], v[52:53], v[46:47], 0
    v_mfma_f32_32x32x16_bf16 v[64:79], v[48:51], v[40:43], v[64:79]
    s_nop 15
    v_sub_f32 v64, v64, v38
    v_sub_f32 v65, v65, v38
    v_sub_f32 v66, v66, v38
    v_sub_f32 v67, v67, v38
    v_sub_f32 v68, v68, v38
    v_sub_f32 v69, v69, v38
    v_sub_f32 v70, v70, v38
    v_sub_f32 v71, v71, v38
    v_sub_f32 v72, v72, v38
    v_sub_f32 v73, v73, v38
    v_sub_f32 v74, v74, v38
    v_sub_f32 v75, v75, v38
    v_sub_f32 v76, v76, v38
    v_sub_f32 v77, v77, v38
    v_sub_f32 v78, v78, v38
    v_sub_f32 v79, v79, v38
    v_exp_f32 v64, v64
    v_exp_f32 v65, v65
    v_exp_f32 v66, v66
    v_exp_f32 v67, v67
    v_exp_f32 v68, v68
    v_exp_f32 v69, v69
    v_exp_f32 v70, v70
    v_exp_f32 v71, v71
    v_exp_f32 v72, v72
    v_exp_f32 v73, v73
    v_exp_f32 v74, v74
    v_exp_f32 v75, v75
    v_exp_f32 v76, v76
    v_exp_f32 v77, v77
    v_exp_f32 v78, v78
    v_exp_f32 v79, v79
    s_nop 1
    v_smfmac_f32_32x32x32_bf16 v[6:21], v[56:59], v[64:71], v54
    v_smfmac_f32_32x32x32_bf16 v[6:21], v[60:63], v[72:79], v54
    s_nop 3
    v_add_u32 v2, 9216, v2
    v_add_u32 v3, 9216, v3
    v_add_u32 v4, 9216, v4
    s_sub_u32 s88, s88, 1
    s_cmp_lg_u32 s88, 0
    s_cbranch_scc1 L_slow2
    buffer_load_dword v39, v5, s[44:47], 0 offen sc1
    s_add_u32 s89, s68, 5
    s_waitcnt vmcnt(0)
    v_subrev_u32 v39, s89, v39
    v_cmp_lt_u32 vcc, 8, v39
    s_nop 0
    s_cmp_lg_u64 vcc, 0
    s_cbranch_scc1 L_far_72
L_back_73:
    buffer_load_dword v39, v5, s[44:47], 0 offen sc1
    s_cmp_lt_u32 s85, 2
    s_cselect_b32 s89, 9, 9
    s_add_u32 s89, s68, s89
    s_waitcnt vmcnt(0)
    v_subrev_u32 v39, s89, v39
    v_cmp_lt_u32 vcc, 8, v39
    s_nop 0
    s_cmp_lg_u32 vcc_lo, 0
    s_cbranch_scc1 L_far_76
L_back_77:
    buffer_load_dwordx4 v[164:167], v0, s[44:47], s79 offen sc1
    buffer_load_dwordx4 v[168:171], v0, s[44:47], s79 offen offset:1024 sc1
    s_xor_b32 s90, s71, 0
    s_add_u32 s90, s90, s77
    buffer_load_dwordx4 v[100:103], v0, s[44:47], s90 offen offset:0 sc1
    s_xor_b32 s90, s71, 0
    s_add_u32 s90, s90, s77
    buffer_load_dwordx4 v[104:107], v0, s[44:47], s90 offen offset:1024 sc1
    s_xor_b32 s90, s71, 2048
    s_add_u32 s90, s90, s77
    buffer_load_dwordx4 v[108:111], v0, s[44:47], s90 offen offset:0 sc1
    s_xor_b32 s90, s71, 2048
    s_add_u32 s90, s90, s77
    buffer_load_dwordx4 v[112:115], v0, s[44:47], s90 offen offset:1024 sc1
    s_xor_b32 s90, s71, 4096
    s_add_u32 s90, s90, s77
    buffer_load_dwordx4 v[116:119], v0, s[44:47], s90 offen offset:0 sc1
    s_xor_b32 s90, s71, 4096
    s_add_u32 s90, s90, s77
    buffer_load_dwordx4 v[120:123], v0, s[44:47], s90 offen offset:1024 sc1
    s_xor_b32 s90, s71, 6144
    s_add_u32 s90, s90, s77
    buffer_load_dwordx4 v[124:127], v0, s[44:47], s90 offen offset:0 sc1
    s_xor_b32 s90, s71, 6144
    s_add_u32 s90, s90, s77
    buffer_load_dwordx4 v[128:131], v0, s[44:47], s90 offen offset:1024 sc1
    s_xor_b32 s90, s71, 8192
    s_add_u32 s90, s90, s77
    buffer_load_dwordx4 v[132:135], v0, s[44:47], s90 offen offset:0 sc1
    s_xor_b32 s90, s71, 8192
    s_add_u32 s90, s90, s77
    buffer_load_dwordx4 v[136:139], v0, s[44:47], s90 offen offset:1024 sc1
    s_xor_b32 s90, s71, 10240
    s_add_u32 s90, s90, s77
    buffer_load_dwordx4 v[140:143], v0, s[44:47], s90 offen offset:0 sc1
    s_xor_b32 s90, s71, 10240
    s_add_u32 s90, s90, s77
    buffer_load_dwordx4 v[144:147], v0, s[44:47], s90 offen offset:1024 sc1
    s_xor_b32 s90, s71, 12288
    s_add_u32 s90, s90, s77
    buffer_load_dwordx4 v[148:151], v0, s[44:47], s90 offen offset:0 sc1
    s_xor_b32 s90, s71, 12288
    s_add_u32 s90, s90, s77
    buffer_load_dwordx4 v[152:155], v0, s[44:47], s90 offen offset:1024 sc1
    s_xor_b32 s90, s71, 14336
    s_add_u32 s90, s90, s77
    buffer_load_dwordx4 v[156:159], v0, s[44:47], s90 offen offset:0 sc1
    s_xor_b32 s90, s71, 14336
    s_add_u32 s90, s90, s77
    buffer_load_dwordx4 v[160:163], v0, s[44:47], s90 offen offset:1024 sc1
    buffer_load_dwordx4 v[236:239], v0, s[44:47], s70 offen sc1
    buffer_load_dwordx4 v[240:243], v0, s[44:47], s70 offen offset:1024 sc1
    s_xor_b32 s90, s71, 0
    s_add_u32 s90, s90, s80
    buffer_load_dwordx4 v[172:175], v0, s[44:47], s90 offen offset:0 sc1
    s_xor_b32 s90, s71, 0
    s_add_u32 s90, s90, s80
    buffer_load_dwordx4 v[176:179], v0, s[44:47], s90 offen offset:1024 sc1
    s_xor_b32 s90, s71, 2048
    s_add_u32 s90, s90, s80
    buffer_load_dwordx4 v[180:183], v0, s[44:47], s90 offen offset:0 sc1
    s_xor_b32 s90, s71, 2048
    s_add_u32 s90, s90, s80
    buffer_load_dwordx4 v[184:187], v0, s[44:47], s90 offen offset:1024 sc1
    s_xor_b32 s90, s71, 4096
    s_add_u32 s90, s90, s80
    buffer_load_dwordx4 v[188:191], v0, s[44:47], s90 offen offset:0 sc1
    s_xor_b32 s90, s71, 4096
    s_add_u32 s90, s90, s80
    buffer_load_dwordx4 v[192:195], v0, s[44:47], s90 offen offset:1024 sc1
    s_xor_b32 s90, s71, 6144
    s_add_u32 s90, s90, s80
    buffer_load_dwordx4 v[196:199], v0, s[44:47], s90 offen offset:0 sc1
    s_xor_b32 s90, s71, 6144
    s_add_u32 s90, s90, s80
    buffer_load_dwordx4 v[200:203], v0, s[44:47], s90 offen offset:1024 sc1
    s_xor_b32 s90, s71, 8192
    s_add_u32 s90, s90, s80
    buffer_load_dwordx4 v[204:207], v0, s[44:47], s90 offen offset:0 sc1
    s_xor_b32 s90, s71, 8192
    s_add_u32 s90, s90, s80
    buffer_load_dwordx4 v[208:211], v0, s[44:47], s90 offen offset:1024 sc1
    s_xor_b32 s90, s71, 10240
    s_add_u32 s90, s90, s80
    buffer_load_dwordx4 v[212:215], v0, s[44:47], s90 offen offset:0 sc1
    s_xor_b32 s90, s71, 10240
    s_add_u32 s90, s90, s80
    buffer_load_dwordx4 v[216:219], v0, s[44:47], s90 offen offset:1024 sc1
    s_xor_b32 s90, s71, 12288
    s_add_u32 s90, s90, s80
    buffer_load_dwordx4 v[220:223], v0, s[44:47], s90 offen offset:0 sc1
    s_xor_b32 s90, s71, 12288
    s_add_u32 s90, s90, s80
    buffer_load_dwordx4 v[224:227], v0, s[44:47], s90 offen offset:1024 sc1
    s_xor_b32 s90, s71, 14336
    s_add_u32 s90, s90, s80
    buffer_load_dwordx4 v[228:231], v0, s[44:47], s90 offen offset:0 sc1
    s_xor_b32 s90, s71, 14336
    s_add_u32 s90, s90, s80
    buffer_load_dwordx4 v[232:235], v0, s[44:47], s90 offen offset:1024 sc1
    buffer_load_dwordx4 v[244:247], v0, s[44:47], s81 offen sc1
    buffer_load_dwordx4 v[248:251], v0, s[44:47], s81 offen offset:1024 sc1
    v_and_b32 v254, 0xf0, v0
    v_lshrrev_b32 v255, 5, v22
    v_lshl_add_u32 v254, v255, 3, v254
    buffer_load_dwordx2 v[252:253], v254, s[44:47], s60 offen sc1
    s_waitcnt vmcnt(0) lgkmcnt(0)
    s_nop 15
    s_branch L_att_done
L_pad:
.if L_pad - L_half1 < 64512
    .fill (64512 - (L_pad - L_half1)) / 4, 4, 0xbf810000
.endif
.section .rodata,"a"
.p2align 6
.amdhsa_kernel gated_mix__grouped_kv_mqa__dense_activation_gelu__prompt_kernel
  .amdhsa_next_free_vgpr 256
  .amdhsa_next_free_sgpr 102
  .amdhsa_accum_offset 256
  .amdhsa_group_segment_fixed_size 0
  .amdhsa_kernarg_size 112
  .amdhsa_user_sgpr_count 2
  .amdhsa_user_sgpr_kernarg_segment_ptr 1
  .amdhsa_system_sgpr_workgroup_id_x 1
.end_amdhsa_kernel
```
